```python
import torch

def _softmax(x, axis=-1):
    return torch.softmax(x, dim=axis)
def _gelu(x):
    return torch.nn.functional.gelu(x, approximate="tanh")
def _silu(x):
    return torch.nn.functional.silu(x)
def _sigmoid(x):
    return torch.sigmoid(x)
def _layernorm(x, axis=-1, eps=1e-5):
    m = x.mean(dim=axis, keepdim=True)
    v = x.var(dim=axis, keepdim=True, unbiased=False)
    return (x - m) / torch.sqrt(v + eps)
def _scatter_add(tgt, idx, src, axis=0):
    return tgt.clone().index_add_(axis, idx, src)
def _segment_sum(src, seg, n):
    out = torch.zeros((n,) + src.shape[1:], dtype=src.dtype)
    return out.index_add_(0, seg, src)
def _pad(x, pw):
    flat = tuple(v for pair in reversed(pw) for v in pair)
    return torch.nn.functional.pad(x, flat)

kernel_name = 'gated_mix__grouped_kv_mqa__linear_attn_block__prompt'

def setup_inputs():

    _w = (lambda a: (lambda t: t.to(torch.bfloat16) if t.is_floating_point() else t)(torch.as_tensor(a)))
    def _A_setup():
        B, S, D, H = 1, 2048, 576, 32
        Dh = D // H
        return {
            "x": _w((lambda *s: torch.randn(*s, dtype=torch.bfloat16) * 0.05)(B, S, D)),
            "wq": _w((lambda *s: torch.randn(*s, dtype=torch.bfloat16) * 1.6)(D, H * Dh)),
            "wk": _w((lambda *s: torch.randn(*s, dtype=torch.bfloat16) * 1.6)(D, Dh)),
            "wv": _w((lambda *s: torch.randn(*s, dtype=torch.bfloat16) * 0.05)(D, Dh)),
            "wo": _w((lambda *s: torch.randn(*s, dtype=torch.bfloat16) * 0.05)(H * Dh, D)),
        }
    _A_in = _A_setup()

    def _B_setup():
        B, S, D = 1, 2048, 576
        return {
            "x": _w((lambda *s: torch.randn(*s, dtype=torch.bfloat16) * 0.05)(B, S, D)),
            "wqkv": _w((lambda *s: torch.randn(*s, dtype=torch.bfloat16) * 1.6)(D, 3 * D)),
            "wo": _w((lambda *s: torch.randn(*s, dtype=torch.bfloat16) * 0.05)(D, D)),
        }
    _B_in = _B_setup()

    return {
        "A_x": _A_in["x"],
        "A_wq": _A_in["wq"],
        "A_wk": _A_in["wk"],
        "A_wv": _A_in["wv"],
        "A_wo": _A_in["wo"],
        "B_x": _B_in["x"],
        "B_wqkv": _B_in["wqkv"],
        "B_wo": _B_in["wo"],
        "gate_w": _w((lambda *s: torch.randn(*s, dtype=torch.bfloat16) * 0.05)(576) * 16.0),
    }

def reference(A_x, A_wq, A_wk, A_wv, A_wo, B_x, B_wqkv, B_wo, gate_w):
    def _A_ref(x, wq, wk, wv, wo):
        B, S, D = x.shape
        H = 32
        Dh = D // H
        q = (lambda x, *d: x.permute(*d))((x @ wq).reshape(B, S, H, Dh), 0, 2, 1, 3)
        k = x @ wk
        v = x @ wv
        scores = torch.einsum("bhqd,bkd->bhqk", q, k) * (Dh ** -0.5)
        p = _softmax(scores, axis=-1)
        o = torch.einsum("bhqk,bkd->bhqd", p, v)
        return (lambda x, *d: x.permute(*d))(o, 0, 2, 1, 3).reshape(B, S, H * Dh) @ wo

    def _B_ref(x, wqkv, wo):
        B, S, D = x.shape
        H = 32; Dh = D // H
        qkv = (lambda x, *d: x.permute(*d))((x @ wqkv).reshape(B, S, 3, H, Dh), 2, 0, 3, 1, 4)
        q, k, v = qkv[0], qkv[1], qkv[2]
        phi = lambda t: torch.where(t > 0, t + 1, torch.exp(t)) + 1e-6
        pq, pk = phi(q), phi(k)
        kv = torch.einsum("bhsd,bhse->bhde", pk, v)
        z = torch.einsum("bhsd->bhd", pk)
        num = torch.einsum("bhqd,bhde->bhqe", pq, kv)
        den = torch.einsum("bhqd,bhd->bhq", pq, z)[..., None] + 1e-6
        o = num / den
        return (lambda x, *d: x.permute(*d))(o, 0, 2, 1, 3).reshape(B, S, D) @ wo

    x = A_x
    g = _sigmoid((x * gate_w).sum(-1, keepdims=True))
    a = _A_ref(x, A_wq, A_wk, A_wv, A_wo)
    b = _B_ref(x, B_wqkv, B_wo)
    return g * a + (1 - g) * b
```

```asm
; @launch grid=(256,1,1) block=(512,1,1) lds=163840
.amdgcn_target "amdgcn-amd-amdhsa--gfx950"
.text
.globl gated_mix__grouped_kv_mqa__linear_attn_block__prompt_kernel
.p2align 8
.type gated_mix__grouped_kv_mqa__linear_attn_block__prompt_kernel,@function
gated_mix__grouped_kv_mqa__linear_attn_block__prompt_kernel:

    s_cmp_ge_u32 s2, 256
    s_cbranch_scc1 L_f1_end
    s_load_dwordx16 s[40:55], s[0:1], 0
    s_load_dwordx2 s[56:57], s[0:1], 64
    s_load_dwordx2 s[4:5], s[0:1], 88
    s_load_dwordx2 s[6:7], s[0:1], 80
    v_and_b32 v1, 63, v0
    v_lshrrev_b32 v20, 6, v0
    v_and_b32 v2, 15, v0
    v_readfirstlane_b32 s8, v20
    v_lshrrev_b32 v3, 4, v1
    s_and_b32 s9, s2, 7
    s_lshr_b32 s10, s2, 3
    s_and_b32 s12, s10, 3
    s_add_u32 s15, s10, 24
    s_and_b32 s15, s15, 31
    s_and_b32 s16, s9, 1
    s_lshl_b32 s16, s16, 5
    s_lshr_b32 s17, s9, 1
    s_lshl_b32 s17, s17, 3
    s_add_u32 s16, s16, s17
    s_lshr_b32 s17, s10, 2
    s_add_u32 s11, s16, s17
    s_lshr_b32 s13, s8, 2
    s_and_b32 s14, s8, 3
    s_lshr_b32 s71, s15, 3
    s_cmp_eq_u32 s71, 0
    s_cbranch_scc1 L_f2_bq
    s_and_b32 s16, s9, 1
    s_lshl_b32 s16, s16, 3
    s_and_b32 s69, s15, 7
    s_add_u32 s69, s69, s16
    s_lshr_b32 s19, s15, 3
    s_lshr_b32 s17, s9, 1
    s_lshl_b32 s18, s17, 1
    s_add_u32 s18, s18, s19
    s_sub_u32 s18, s18, 1
    s_add_u32 s20, s19, 1
    s_and_b32 s20, s20, 3
    s_cmp_lt_u32 s20, 2
    s_cselect_b32 s70, s17, s18
    s_lshl_b32 s96, s8, 11
    s_lshl_b32 s97, s8, 11
    s_and_b32 s98, s8, 1
    s_lshl_b32 s98, s98, 10
    s_mov_b32 s99, 0
    v_lshrrev_b32 v20, 3, v1
    v_and_b32 v21, 7, v1
    s_lshl_b32 s16, s8, 4
    v_add_u32 v22, 0, v20
    v_add_u32 v22, s16, v22
    v_add_u32 v23, 0, v3
    v_xor_b32 v23, v23, v21
    v_lshlrev_b32 v23, 4, v23
    v_mul_u32_u24 v22, 1152, v22
    v_add_u32 v134, v22, v23
    v_add_u32 v22, 8, v20
    v_add_u32 v22, s16, v22
    v_add_u32 v23, 4, v3
    v_xor_b32 v23, v23, v21
    v_lshlrev_b32 v23, 4, v23
    v_mul_u32_u24 v22, 1152, v22
    v_add_u32 v135, v22, v23
    s_lshr_b32 s19, s15, 3
    s_mul_i32 s16, s70, 288
    s_mul_i32 s17, s70, 144
    s_add_u32 s17, s17, 1152
    s_add_u32 s20, s19, 1
    s_and_b32 s20, s20, 3
    s_cmp_lt_u32 s20, 2
    s_cselect_b32 s66, s16, s17
    s_cselect_b32 s67, 0, 1008
    s_mov_b32 s68, 3456
    s_cmp_eq_u32 s19, 3
    s_cselect_b32 s68, 1152, s68
    s_lshl_b32 s101, s68, 6
    s_lshl_b32 s16, s8, 7
    s_add_u32 s16, s16, 0
    v_add_u32 v20, s16, v1
    v_mul_u32_u24 v21, 3641, v20
    v_lshrrev_b32 v21, 16, v21
    v_mad_i32_i24 v22, v21, -16, v20
    v_mad_i32_i24 v22, v21, -2, v22
    v_and_b32 v23, 0x23, v21
    v_bfe_u32 v24, v21, 2, 2
    v_lshl_add_u32 v23, v24, 3, v23
    v_bfe_u32 v24, v21, 4, 1
    v_lshl_add_u32 v23, v24, 2, v23
    v_mul_lo_u32 v23, v23, s68
    v_lshlrev_b32 v24, 4, v22
    v_add_u32 v23, v23, v24
    v_add_u32 v23, s66, v23
    v_cmp_lt_u32 vcc, 8, v22
    v_add_u32 v24, s67, v23
    s_nop 0
    v_cndmask_b32 v136, v23, v24, vcc
    s_lshl_b32 s16, s8, 7
    s_add_u32 s16, s16, 64
    v_add_u32 v20, s16, v1
    v_mul_u32_u24 v21, 3641, v20
    v_lshrrev_b32 v21, 16, v21
    v_mad_i32_i24 v22, v21, -16, v20
    v_mad_i32_i24 v22, v21, -2, v22
    v_and_b32 v23, 0x23, v21
    v_bfe_u32 v24, v21, 2, 2
    v_lshl_add_u32 v23, v24, 3, v23
    v_bfe_u32 v24, v21, 4, 1
    v_lshl_add_u32 v23, v24, 2, v23
    v_mul_lo_u32 v23, v23, s68
    v_lshlrev_b32 v24, 4, v22
    v_add_u32 v23, v23, v24
    v_add_u32 v23, s66, v23
    v_cmp_lt_u32 vcc, 8, v22
    v_add_u32 v24, s67, v23
    s_nop 0
    v_cndmask_b32 v143, v23, v24, vcc
    s_and_b32 s16, s8, 1
    s_lshl_b32 s16, s16, 6
    s_add_u32 s16, s16, 1024
    v_add_u32 v20, s16, v1
    v_mul_u32_u24 v21, 3641, v20
    v_lshrrev_b32 v21, 16, v21
    v_mad_i32_i24 v22, v21, -16, v20
    v_mad_i32_i24 v22, v21, -2, v22
    v_and_b32 v23, 0x23, v21
    v_bfe_u32 v24, v21, 2, 2
    v_lshl_add_u32 v23, v24, 3, v23
    v_bfe_u32 v24, v21, 4, 1
    v_lshl_add_u32 v23, v24, 2, v23
    v_mul_lo_u32 v23, v23, s68
    v_lshlrev_b32 v24, 4, v22
    v_add_u32 v23, v23, v24
    v_add_u32 v23, s66, v23
    v_cmp_lt_u32 vcc, 8, v22
    v_add_u32 v24, s67, v23
    s_nop 0
    v_cndmask_b32 v144, v23, v24, vcc
    v_lshrrev_b32 v21, 1, v2
    v_xor_b32 v20, v3, v21
    v_lshlrev_b32 v20, 4, v20
    v_lshl_add_u32 v20, v2, 7, v20
    s_lshl_b32 s16, s14, 12
    v_add_u32 v137, s16, v20
    v_xor_b32 v138, 64, v137
    v_lshrrev_b32 v20, 2, v2
    v_lshl_add_u32 v20, v3, 2, v20
    v_and_b32 v21, 3, v2
    v_lshlrev_b32 v21, 3, v21
    v_mul_u32_u24 v139, 288, v20
    v_add_u32 v139, v139, v21
    v_add_u32 v139, 16384, v139
    s_waitcnt lgkmcnt(0)
    s_cmp_lg_u32 s2, 0
    s_cbranch_scc1 L_f1_nononce
    s_cmp_lg_u32 s8, 0
    s_cbranch_scc1 L_f1_nononce
    s_memrealtime s[18:19]
    s_waitcnt lgkmcnt(0)
    s_or_b32 s18, s18, 1
    v_mov_b32 v20, 0
    v_mov_b32 v21, s18
    s_mov_b32 exec_lo, 1
    s_mov_b32 exec_hi, 0
    global_store_dword v20, v21, s[6:7] sc1
    s_mov_b64 exec, -1
L_f1_nononce:
    s_mov_b64 s[22:23], s[48:49]
    s_mul_i32 s16, s69, 147456
    s_add_u32 s17, s40, s16
    s_addc_u32 s18, s41, 0
    s_mov_b32 s44, s17
    s_and_b32 s45, s18, 0xffff
    s_mov_b32 s46, 147456
    s_mov_b32 s47, 0x20000
    s_lshr_b32 s71, s15, 3
    s_cmp_eq_u32 s71, 3
    s_cselect_b32 s17, s42, s52
    s_cselect_b32 s18, s43, s53
    s_mov_b32 s48, s17
    s_and_b32 s49, s18, 0xffff
    s_mov_b32 s50, 1990656
    s_mov_b32 s51, 0x20000
    s_cmp_eq_u32 s71, 3
    s_cselect_b32 s50, 663552, s50
    s_mov_b32 s100, 0
    s_add_u32 m0, s96, 0
    s_nop 0
    buffer_load_dwordx4 v134, s[44:47], s99 offen lds
    s_add_u32 m0, s96, 1024
    s_nop 0
    buffer_load_dwordx4 v135, s[44:47], s99 offen lds
    s_add_u32 m0, s97, 16384
    s_nop 0
    buffer_load_dwordx4 v136, s[48:51], s100 offen lds
    s_add_u32 m0, s97, 17408
    s_nop 0
    buffer_load_dwordx4 v143, s[48:51], s100 offen lds
    s_add_u32 m0, s98, 32768
    s_cmp_lt_u32 s8, 2
    s_cbranch_scc0 L_B_ex1
    buffer_load_dwordx4 v144, s[48:51], s100 offen lds
L_B_ex1:
    s_add_u32 s99, s99, 128
    s_add_u32 s100, s100, s101
    s_barrier
    s_add_u32 m0, s96, 34816
    s_nop 0
    buffer_load_dwordx4 v134, s[44:47], s99 offen lds
    s_add_u32 m0, s96, 35840
    s_nop 0
    buffer_load_dwordx4 v135, s[44:47], s99 offen lds
    s_add_u32 m0, s97, 51200
    s_nop 0
    buffer_load_dwordx4 v136, s[48:51], s100 offen lds
    s_add_u32 m0, s97, 52224
    s_nop 0
    buffer_load_dwordx4 v143, s[48:51], s100 offen lds
    s_add_u32 m0, s98, 67584
    s_cmp_lt_u32 s8, 2
    s_cbranch_scc0 L_B_ex2
    buffer_load_dwordx4 v144, s[48:51], s100 offen lds
L_B_ex2:
    s_add_u32 s99, s99, 128
    s_add_u32 s100, s100, s101
    s_barrier
    s_sub_u32 s16, s15, 8
    s_lshl_b32 s16, s16, 3
    s_add_u32 s16, s16, s8
    s_mul_i32 s17, s16, 6
    v_add_u32 v20, s17, v1
    v_min_u32 v20, 1023, v20
    s_and_b32 s18, s9, 1
    s_lshl_b32 s18, s18, 10
    v_add_u32 v20, s18, v20
    v_mul_u32_u24 v20, 1152, v20
    s_lshl_b32 s17, s16, 2
    s_sub_u32 s17, s17, 6
    v_add_u32 v21, s17, v1
    v_max_i32 v21, 0, v21
    v_mul_u32_u24 v22, 5462, v21
    v_lshrrev_b32 v22, 16, v22
    v_min_u32 v22, 63, v22
    v_mad_i32_i24 v23, v22, -12, v21
    v_min_u32 v23, 11, v23
    v_mul_u32_u24 v24, 22, v23
    v_lshrrev_b32 v24, 6, v24
    v_mad_i32_i24 v25, v24, -3, v23
    s_lshr_b32 s18, s9, 1
    s_mul_i32 s18, s18, 288
    s_and_b32 s18, s18, 0xffffff80
    v_lshlrev_b32 v25, 7, v25
    v_add_u32 v25, s18, v25
    v_cmp_eq_u32 vcc, 3, v24
    v_mul_u32_u24 v26, 1152, v24
    v_mul_u32_u24 v27, 3456, v22
    v_add_u32 v26, v26, v27
    v_mul_u32_u24 v27, 1152, v22
    v_cndmask_b32 v26, v26, v27, vcc
    v_add_u32 v26, v26, v25
    v_mov_b32 v27, 221184
    v_mov_b32 v28, 73728
    v_cndmask_b32 v202, v27, v28, vcc
    v_mov_b32 v27, s52
    v_mov_b32 v28, s42
    v_cndmask_b32 v200, v27, v28, vcc
    v_mov_b32 v27, s53
    v_mov_b32 v28, s43
    v_cndmask_b32 v201, v27, v28, vcc
    v_cmp_gt_u32 vcc, 6, v1
    v_mov_b32 v27, s40
    v_mov_b32 v28, s41
    v_mov_b32 v29, 128
    v_cndmask_b32 v200, v200, v27, vcc
    v_cndmask_b32 v201, v201, v28, vcc
    v_cndmask_b32 v202, v202, v29, vcc
    v_cndmask_b32 v26, v26, v20, vcc
    v_mul_u32_u24 v27, 3, v202
    v_add_u32 v26, v26, v27
    v_add_co_u32 v200, vcc, v200, v26
    v_mov_b32 v27, 0
    s_nop 0
    v_addc_co_u32 v201, vcc, v201, v27, vcc
    s_add_u32 m0, s96, 69632
    s_nop 0
    buffer_load_dwordx4 v134, s[44:47], s99 offen lds
    s_add_u32 m0, s96, 70656
    s_nop 0
    buffer_load_dwordx4 v135, s[44:47], s99 offen lds
    s_add_u32 m0, s97, 86016
    s_nop 0
    buffer_load_dwordx4 v136, s[48:51], s100 offen lds
    s_add_u32 m0, s97, 87040
    s_nop 0
    buffer_load_dwordx4 v143, s[48:51], s100 offen lds
    s_add_u32 m0, s98, 102400
    s_cmp_lt_u32 s8, 2
    s_cbranch_scc0 L_B_ex3
    buffer_load_dwordx4 v144, s[48:51], s100 offen lds
L_B_ex3:
    s_add_u32 s99, s99, 128
    s_add_u32 s100, s100, s101
    s_mov_b32 exec_lo, 0x3ff
    s_mov_b32 exec_hi, 0
    global_load_dword v203, v[200:201], off
    s_mov_b64 exec, -1
    v_add_co_u32 v200, vcc, v200, v202
    v_mov_b32 v204, 0
    s_nop 0
    v_addc_co_u32 v201, vcc, v201, v204, vcc
    s_mov_b32 exec_lo, 0x3ff
    s_mov_b32 exec_hi, 0
    global_load_dword v203, v[200:201], off
    s_mov_b64 exec, -1
    v_add_co_u32 v200, vcc, v200, v202
    v_mov_b32 v204, 0
    s_nop 0
    v_addc_co_u32 v201, vcc, v201, v204, vcc
    s_mov_b32 exec_lo, 0x3ff
    s_mov_b32 exec_hi, 0
    global_load_dword v203, v[200:201], off
    s_mov_b64 exec, -1
    v_add_co_u32 v200, vcc, v200, v202
    v_mov_b32 v204, 0
    s_nop 0
    v_addc_co_u32 v201, vcc, v201, v204, vcc
    s_mov_b32 exec_lo, 0x3ff
    s_mov_b32 exec_hi, 0
    global_load_dword v203, v[200:201], off
    s_mov_b64 exec, -1
    v_add_co_u32 v200, vcc, v200, v202
    v_mov_b32 v204, 0
    s_nop 0
    v_addc_co_u32 v201, vcc, v201, v204, vcc
    s_mov_b32 exec_lo, 0x3ff
    s_mov_b32 exec_hi, 0
    global_load_dword v203, v[200:201], off
    s_mov_b64 exec, -1
    v_add_co_u32 v200, vcc, v200, v202
    v_mov_b32 v204, 0
    s_nop 0
    v_addc_co_u32 v201, vcc, v201, v204, vcc
    s_mov_b32 exec_lo, 0x3ff
    s_mov_b32 exec_hi, 0
    global_load_dword v203, v[200:201], off
    s_mov_b64 exec, -1
    v_add_co_u32 v200, vcc, v200, v202
    v_mov_b32 v204, 0
    s_nop 0
    v_addc_co_u32 v201, vcc, v201, v204, vcc
    s_mul_i32 s16, s9, 24
    s_add_u32 s16, s16, s15
    s_sub_u32 s16, s16, 8
    s_cmp_lt_u32 s16, 144
    s_cselect_b32 s60, 1, 0
    s_cbranch_scc0 L_WF_pre_end
    s_cmp_ge_u32 s16, 72
    s_cselect_b32 s17, s54, s22
    s_cselect_b32 s18, s55, s23
    s_cselect_b32 s19, 72, 0
    s_cselect_b32 s20, 36, 0
    s_mov_b32 s24, s17
    s_and_b32 s25, s18, 0xffff
    s_mov_b32 s26, 663552
    s_mov_b32 s27, 0x20000
    s_sub_u32 s16, s16, s19
    s_mul_i32 s17, s16, 3641
    s_lshr_b32 s17, s17, 16
    s_mul_i32 s18, s17, 18
    s_sub_u32 s21, s16, s18
    s_mul_i32 s18, s17, 9
    s_add_u32 s18, s18, s20
    s_add_u32 s18, s18, s8
    s_mul_i32 s18, s18, 18
    s_add_u32 s18, s18, s21
    s_lshl_b32 s18, s18, 10
    s_add_u32 s18, s18, 0x740000
    s_add_u32 s22, s4, s18
    s_addc_u32 s23, s5, 0
    s_mul_i32 s20, s17, 288
    s_cmp_ge_u32 s21, 16
    s_cselect_b64 s[74:75], -1, 0
    s_lshl_b32 s19, s21, 2
    s_lshl_b32 s16, s8, 6
    v_add_u32 v20, s16, v1
    s_lshl_b32 s16, s8, 10
    s_add_u32 s16, s16, 139264
    v_mul_u32_u24 v21, 3641, v20
    v_lshrrev_b32 v21, 16, v21
    v_mad_i32_i24 v22, v21, -16, v20
    v_mad_i32_i24 v22, v21, -2, v22
    v_bfe_u32 v23, v21, 2, 2
    v_add_u32 v23, s19, v23
    v_lshrrev_b32 v24, 4, v21
    v_and_b32 v25, 3, v21
    v_lshrrev_b32 v26, 1, v23
    v_mul_u32_u24 v26, 18, v26
    v_and_b32 v27, 1, v23
    v_lshl_add_u32 v26, v27, 2, v26
    v_add_u32 v26, v26, v25
    v_lshl_add_u32 v26, v24, 3, v26
    v_lshl_add_u32 v24, v24, 2, v25
    v_subrev_u32 v23, 64, v23
    v_mul_u32_u24 v23, 72, v23
    v_lshrrev_b32 v27, 1, v24
    v_mul_u32_u24 v27, 18, v27
    v_add_u32 v23, v23, v27
    v_and_b32 v24, 1, v24
    v_add_u32 v23, v23, v24
    v_add_u32 v23, 16, v23
    v_cndmask_b32 v26, v26, v23, s[74:75]
    v_mul_u32_u24 v26, 1152, v26
    v_lshl_add_u32 v26, v22, 4, v26
    s_mov_b32 m0, s16
    s_nop 0
    buffer_load_dwordx4 v26, s[24:27], s20 offen lds
    s_cmp_lg_u32 s8, 0
    s_cbranch_scc1 L_WF_pre_end
    v_add_u32 v20, 512, v1
    s_mov_b32 s16, 147456
    v_mul_u32_u24 v21, 3641, v20
    v_lshrrev_b32 v21, 16, v21
    v_mad_i32_i24 v22, v21, -16, v20
    v_mad_i32_i24 v22, v21, -2, v22
    v_bfe_u32 v23, v21, 2, 2
    v_add_u32 v23, s19, v23
    v_lshrrev_b32 v24, 4, v21
    v_and_b32 v25, 3, v21
    v_lshrrev_b32 v26, 1, v23
    v_mul_u32_u24 v26, 18, v26
    v_and_b32 v27, 1, v23
    v_lshl_add_u32 v26, v27, 2, v26
    v_add_u32 v26, v26, v25
    v_lshl_add_u32 v26, v24, 3, v26
    v_lshl_add_u32 v24, v24, 2, v25
    v_subrev_u32 v23, 64, v23
    v_mul_u32_u24 v23, 72, v23
    v_lshrrev_b32 v27, 1, v24
    v_mul_u32_u24 v27, 18, v27
    v_add_u32 v23, v23, v27
    v_and_b32 v24, 1, v24
    v_add_u32 v23, v23, v24
    v_add_u32 v23, 16, v23
    v_cndmask_b32 v26, v26, v23, s[74:75]
    v_mul_u32_u24 v26, 1152, v26
    v_lshl_add_u32 v26, v22, 4, v26
    s_mov_b32 m0, s16
    s_nop 0
    buffer_load_dwordx4 v26, s[24:27], s20 offen lds
L_WF_pre_end:
    s_cmp_eq_u32 s71, 3
    s_cbranch_scc1 L_f2_aq
    s_cmp_eq_u32 s13, 0
    s_cbranch_scc0 L_B_kv1
    s_waitcnt vmcnt(14)
    s_barrier
    v_add_u32 v140, 0, v137
    v_add_u32 v141, 0, v138
    v_add_u32 v142, 0, v139
    ds_read_b128 v[36:39], v140 offset:0
    ds_read_b128 v[40:43], v140 offset:2048
    ds_read_b64_tr_b16 v[52:53], v142 offset:0
    ds_read_b64_tr_b16 v[54:55], v142 offset:4608
    ds_read_b64_tr_b16 v[56:57], v142 offset:32
    ds_read_b64_tr_b16 v[58:59], v142 offset:4640
    ds_read_b64_tr_b16 v[60:61], v142 offset:160
    ds_read_b64_tr_b16 v[62:63], v142 offset:4768
    ds_read_b64_tr_b16 v[64:65], v142 offset:192
    ds_read_b64_tr_b16 v[66:67], v142 offset:4800
    ds_read_b64_tr_b16 v[68:69], v142 offset:224
    ds_read_b64_tr_b16 v[70:71], v142 offset:4832
    s_waitcnt lgkmcnt(0)
    v_mfma_f32_16x16x32_bf16 v[92:95], v[36:39], v[52:55], 0
    ds_read_b128 v[44:47], v141 offset:0
    ds_read_b128 v[48:51], v141 offset:2048
    ds_read_b64_tr_b16 v[72:73], v142 offset:9216
    v_mfma_f32_16x16x32_bf16 v[112:115], v[40:43], v[52:55], 0
    ds_read_b64_tr_b16 v[74:75], v142 offset:13824
    ds_read_b64_tr_b16 v[76:77], v142 offset:9248
    ds_read_b64_tr_b16 v[78:79], v142 offset:13856
    v_mfma_f32_16x16x32_bf16 v[96:99], v[36:39], v[56:59], 0
    ds_read_b64_tr_b16 v[80:81], v142 offset:9376
    ds_read_b64_tr_b16 v[82:83], v142 offset:13984
    ds_read_b64_tr_b16 v[84:85], v142 offset:9408
    s_add_u32 m0, s96, 104448
    v_mfma_f32_16x16x32_bf16 v[116:119], v[40:43], v[56:59], 0
    ds_read_b64_tr_b16 v[86:87], v142 offset:14016
    ds_read_b64_tr_b16 v[88:89], v142 offset:9440
    ds_read_b64_tr_b16 v[90:91], v142 offset:14048
    buffer_load_dwordx4 v134, s[44:47], s99 offen lds
    v_mfma_f32_16x16x32_bf16 v[100:103], v[36:39], v[60:63], 0
    s_add_u32 m0, s96, 105472
    v_mfma_f32_16x16x32_bf16 v[120:123], v[40:43], v[60:63], 0
    buffer_load_dwordx4 v135, s[44:47], s99 offen lds
    v_mfma_f32_16x16x32_bf16 v[104:107], v[36:39], v[64:67], 0
    s_add_u32 m0, s97, 120832
    v_mfma_f32_16x16x32_bf16 v[124:127], v[40:43], v[64:67], 0
    buffer_load_dwordx4 v136, s[48:51], s100 offen lds
    v_mfma_f32_16x16x32_bf16 v[108:111], v[36:39], v[68:71], 0
    s_add_u32 m0, s97, 121856
    v_mfma_f32_16x16x32_bf16 v[128:131], v[40:43], v[68:71], 0
    buffer_load_dwordx4 v143, s[48:51], s100 offen lds
    s_add_u32 m0, s98, 137216
    s_cmp_lt_u32 s8, 2
    s_cbranch_scc0 L_B_ex4
    buffer_load_dwordx4 v144, s[48:51], s100 offen lds
L_B_ex4:
    s_add_u32 s99, s99, 128
    s_add_u32 s100, s100, s101
    s_waitcnt vmcnt(14)
    s_waitcnt lgkmcnt(0)
    s_barrier
    v_add_u32 v140, 34816, v137
    v_add_u32 v141, 34816, v138
    v_add_u32 v142, 34816, v139
    v_mfma_f32_16x16x32_bf16 v[92:95], v[44:47], v[72:75], v[92:95]
    ds_read_b128 v[36:39], v140 offset:0
    ds_read_b128 v[40:43], v140 offset:2048
    ds_read_b64_tr_b16 v[52:53], v142 offset:0
    v_mfma_f32_16x16x32_bf16 v[112:115], v[48:51], v[72:75], v[112:115]
    ds_read_b64_tr_b16 v[54:55], v142 offset:4608
    ds_read_b64_tr_b16 v[56:57], v142 offset:32
    ds_read_b64_tr_b16 v[58:59], v142 offset:4640
    v_mfma_f32_16x16x32_bf16 v[96:99], v[44:47], v[76:79], v[96:99]
    ds_read_b64_tr_b16 v[60:61], v142 offset:160
    ds_read_b64_tr_b16 v[62:63], v142 offset:4768
    ds_read_b64_tr_b16 v[64:65], v142 offset:192
    s_add_u32 m0, s96, 0
    v_mfma_f32_16x16x32_bf16 v[116:119], v[48:51], v[76:79], v[116:119]
    ds_read_b64_tr_b16 v[66:67], v142 offset:4800
    ds_read_b64_tr_b16 v[68:69], v142 offset:224
    ds_read_b64_tr_b16 v[70:71], v142 offset:4832
    buffer_load_dwordx4 v134, s[44:47], s99 offen lds
    v_mfma_f32_16x16x32_bf16 v[100:103], v[44:47], v[80:83], v[100:103]
    s_add_u32 m0, s96, 1024
    v_mfma_f32_16x16x32_bf16 v[120:123], v[48:51], v[80:83], v[120:123]
    buffer_load_dwordx4 v135, s[44:47], s99 offen lds
    v_mfma_f32_16x16x32_bf16 v[104:107], v[44:47], v[84:87], v[104:107]
    s_add_u32 m0, s97, 16384
    v_mfma_f32_16x16x32_bf16 v[124:127], v[48:51], v[84:87], v[124:127]
    buffer_load_dwordx4 v136, s[48:51], s100 offen lds
    v_mfma_f32_16x16x32_bf16 v[108:111], v[44:47], v[88:91], v[108:111]
    v_mfma_f32_16x16x32_bf16 v[128:131], v[48:51], v[88:91], v[128:131]
    s_waitcnt lgkmcnt(0)
    v_mfma_f32_16x16x32_bf16 v[92:95], v[36:39], v[52:55], v[92:95]
    ds_read_b128 v[44:47], v141 offset:0
    ds_read_b128 v[48:51], v141 offset:2048
    ds_read_b64_tr_b16 v[72:73], v142 offset:9216
    v_mfma_f32_16x16x32_bf16 v[112:115], v[40:43], v[52:55], v[112:115]
    ds_read_b64_tr_b16 v[74:75], v142 offset:13824
    ds_read_b64_tr_b16 v[76:77], v142 offset:9248
    ds_read_b64_tr_b16 v[78:79], v142 offset:13856
    v_mfma_f32_16x16x32_bf16 v[96:99], v[36:39], v[56:59], v[96:99]
    ds_read_b64_tr_b16 v[80:81], v142 offset:9376
    ds_read_b64_tr_b16 v[82:83], v142 offset:13984
    ds_read_b64_tr_b16 v[84:85], v142 offset:9408
    s_add_u32 m0, s97, 17408
    v_mfma_f32_16x16x32_bf16 v[116:119], v[40:43], v[56:59], v[116:119]
    ds_read_b64_tr_b16 v[86:87], v142 offset:14016
    ds_read_b64_tr_b16 v[88:89], v142 offset:9440
    ds_read_b64_tr_b16 v[90:91], v142 offset:14048
    buffer_load_dwordx4 v143, s[48:51], s100 offen lds
    v_mfma_f32_16x16x32_bf16 v[100:103], v[36:39], v[60:63], v[100:103]
    s_add_u32 m0, s98, 32768
    s_cmp_lt_u32 s8, 2
    s_cbranch_scc0 L_B_ex5
    buffer_load_dwordx4 v144, s[48:51], s100 offen lds
L_B_ex5:
    s_add_u32 s99, s99, 128
    s_add_u32 s100, s100, s101
    v_mfma_f32_16x16x32_bf16 v[120:123], v[40:43], v[60:63], v[120:123]
    v_mfma_f32_16x16x32_bf16 v[104:107], v[36:39], v[64:67], v[104:107]
    v_mfma_f32_16x16x32_bf16 v[124:127], v[40:43], v[64:67], v[124:127]
    v_mfma_f32_16x16x32_bf16 v[108:111], v[36:39], v[68:71], v[108:111]
    v_mfma_f32_16x16x32_bf16 v[128:131], v[40:43], v[68:71], v[128:131]
    s_waitcnt vmcnt(14)
    s_waitcnt lgkmcnt(0)
    s_barrier
    v_mov_b32 v210, 0
    global_load_dword v211, v210, s[6:7] sc1
    v_add_u32 v140, 69632, v137
    v_add_u32 v141, 69632, v138
    v_add_u32 v142, 69632, v139
    v_mfma_f32_16x16x32_bf16 v[92:95], v[44:47], v[72:75], v[92:95]
    ds_read_b128 v[36:39], v140 offset:0
    ds_read_b128 v[40:43], v140 offset:2048
    ds_read_b64_tr_b16 v[52:53], v142 offset:0
    v_mfma_f32_16x16x32_bf16 v[112:115], v[48:51], v[72:75], v[112:115]
    ds_read_b64_tr_b16 v[54:55], v142 offset:4608
    ds_read_b64_tr_b16 v[56:57], v142 offset:32
    ds_read_b64_tr_b16 v[58:59], v142 offset:4640
    v_mfma_f32_16x16x32_bf16 v[96:99], v[44:47], v[76:79], v[96:99]
    ds_read_b64_tr_b16 v[60:61], v142 offset:160
    ds_read_b64_tr_b16 v[62:63], v142 offset:4768
    ds_read_b64_tr_b16 v[64:65], v142 offset:192
    s_add_u32 m0, s96, 34816
    v_mfma_f32_16x16x32_bf16 v[116:119], v[48:51], v[76:79], v[116:119]
    ds_read_b64_tr_b16 v[66:67], v142 offset:4800
    ds_read_b64_tr_b16 v[68:69], v142 offset:224
    ds_read_b64_tr_b16 v[70:71], v142 offset:4832
    buffer_load_dwordx4 v134, s[44:47], s99 offen lds
    v_mfma_f32_16x16x32_bf16 v[100:103], v[44:47], v[80:83], v[100:103]
    s_add_u32 m0, s96, 35840
    v_mfma_f32_16x16x32_bf16 v[120:123], v[48:51], v[80:83], v[120:123]
    buffer_load_dwordx4 v135, s[44:47], s99 offen lds
    v_mfma_f32_16x16x32_bf16 v[104:107], v[44:47], v[84:87], v[104:107]
    s_add_u32 m0, s97, 51200
    v_mfma_f32_16x16x32_bf16 v[124:127], v[48:51], v[84:87], v[124:127]
    buffer_load_dwordx4 v136, s[48:51], s100 offen lds
    v_mfma_f32_16x16x32_bf16 v[108:111], v[44:47], v[88:91], v[108:111]
    v_mfma_f32_16x16x32_bf16 v[128:131], v[48:51], v[88:91], v[128:131]
    s_waitcnt lgkmcnt(0)
    v_mfma_f32_16x16x32_bf16 v[92:95], v[36:39], v[52:55], v[92:95]
    ds_read_b128 v[44:47], v141 offset:0
    ds_read_b128 v[48:51], v141 offset:2048
    ds_read_b64_tr_b16 v[72:73], v142 offset:9216
    v_mfma_f32_16x16x32_bf16 v[112:115], v[40:43], v[52:55], v[112:115]
    ds_read_b64_tr_b16 v[74:75], v142 offset:13824
    ds_read_b64_tr_b16 v[76:77], v142 offset:9248
    ds_read_b64_tr_b16 v[78:79], v142 offset:13856
    v_mfma_f32_16x16x32_bf16 v[96:99], v[36:39], v[56:59], v[96:99]
    ds_read_b64_tr_b16 v[80:81], v142 offset:9376
    ds_read_b64_tr_b16 v[82:83], v142 offset:13984
    ds_read_b64_tr_b16 v[84:85], v142 offset:9408
    s_add_u32 m0, s97, 52224
    v_mfma_f32_16x16x32_bf16 v[116:119], v[40:43], v[56:59], v[116:119]
    ds_read_b64_tr_b16 v[86:87], v142 offset:14016
    ds_read_b64_tr_b16 v[88:89], v142 offset:9440
    ds_read_b64_tr_b16 v[90:91], v142 offset:14048
    buffer_load_dwordx4 v143, s[48:51], s100 offen lds
    v_mfma_f32_16x16x32_bf16 v[100:103], v[36:39], v[60:63], v[100:103]
    s_add_u32 m0, s98, 67584
    s_cmp_lt_u32 s8, 2
    s_cbranch_scc0 L_B_ex6
    buffer_load_dwordx4 v144, s[48:51], s100 offen lds
L_B_ex6:
    s_add_u32 s99, s99, 128
    s_add_u32 s100, s100, s101
    v_mfma_f32_16x16x32_bf16 v[120:123], v[40:43], v[60:63], v[120:123]
    v_mfma_f32_16x16x32_bf16 v[104:107], v[36:39], v[64:67], v[104:107]
    v_mfma_f32_16x16x32_bf16 v[124:127], v[40:43], v[64:67], v[124:127]
    v_mfma_f32_16x16x32_bf16 v[108:111], v[36:39], v[68:71], v[108:111]
    v_mfma_f32_16x16x32_bf16 v[128:131], v[40:43], v[68:71], v[128:131]
    s_waitcnt vmcnt(9)
    s_waitcnt lgkmcnt(0)
    s_barrier
    s_cmp_eq_u32 s60, 0
    s_cbranch_scc1 L_WF_post_end1
    v_lshrrev_b32 v20, 2, v2
    v_lshl_add_u32 v20, v3, 2, v20
    v_and_b32 v21, 3, v2
    v_lshlrev_b32 v21, 3, v21
    v_mul_u32_u24 v20, 288, v20
    v_add_u32 v20, v20, v21
    s_lshl_b32 s16, s8, 5
    s_add_u32 s16, s16, 139264
    v_add_u32 v20, s16, v20
    v_lshlrev_b32 v21, 4, v1
    ds_read_b64_tr_b16 v[28:29], v20
    ds_read_b64_tr_b16 v[30:31], v20 offset:4608
    ds_read_b64_tr_b16 v[32:33], v20 offset:256
    ds_read_b64_tr_b16 v[34:35], v20 offset:4864
    s_waitcnt lgkmcnt(0)
    global_store_dwordx4 v21, v[28:31], s[22:23] sc1
    s_cmp_lg_u32 s8, 0
    s_cbranch_scc1 L_WF_post_end1
    s_add_u32 s22, s22, 147456
    s_addc_u32 s23, s23, 0
    global_store_dwordx4 v21, v[32:35], s[22:23] sc1
L_WF_post_end1:
    v_and_b32 v4, 31, v1
    v_lshrrev_b32 v5, 5, v1
    v_lshlrev_b32 v6, 4, v1
    s_lshl_b32 s16, s14, 1
    s_lshl_b32 s54, s12, 3
    s_add_u32 s54, s54, s16
    s_add_u32 s55, s54, s13
    s_mov_b32 s64, -1
    s_mov_b32 s65, 0
    s_mov_b32 s66, 0x7ffff
    s_mov_b32 s67, 0x7ffff
    v_mov_b32 v242, -1
    v_mov_b32 v243, 0
    s_add_u32 s62, s4, 0x4b0000
    s_addc_u32 s63, s5, 0
    s_add_u32 s16, s8, 0
    s_lshl_b32 s24, s16, 10
    s_mov_b32 s29, s24
    s_cmp_ge_u32 s16, 20
    s_cselect_b32 s17, 59392, 0
    s_add_u32 s24, s24, s17
    s_cmp_ge_u32 s16, 20
    s_cselect_b32 s17, 4294966784, 0
    s_add_u32 s29, s29, s17
    s_add_u32 s16, s8, 8
    s_lshl_b32 s25, s16, 10
    s_mov_b32 s30, s25
    s_cmp_ge_u32 s16, 20
    s_cselect_b32 s17, 59392, 0
    s_add_u32 s25, s25, s17
    s_cmp_ge_u32 s16, 20
    s_cselect_b32 s17, 4294966784, 0
    s_add_u32 s30, s30, s17
    s_add_u32 s16, s8, 16
    s_lshl_b32 s26, s16, 10
    s_mov_b32 s31, s26
    s_cmp_ge_u32 s16, 20
    s_cselect_b32 s17, 59392, 0
    s_add_u32 s26, s26, s17
    s_cmp_ge_u32 s16, 20
    s_cselect_b32 s17, 4294966784, 0
    s_add_u32 s31, s31, s17
    s_add_u32 s16, s8, 24
    s_lshl_b32 s27, s16, 10
    s_mov_b32 s36, s27
    s_cmp_ge_u32 s16, 20
    s_cselect_b32 s17, 59392, 0
    s_add_u32 s27, s27, s17
    s_cmp_ge_u32 s16, 20
    s_cselect_b32 s17, 4294966784, 0
    s_add_u32 s36, s36, s17
    s_add_u32 s16, s8, 32
    s_lshl_b32 s28, s16, 10
    s_mov_b32 s37, s28
    s_cmp_ge_u32 s16, 20
    s_cselect_b32 s17, 59392, 0
    s_add_u32 s28, s28, s17
    s_cmp_ge_u32 s16, 20
    s_cselect_b32 s17, 4294966784, 0
    s_add_u32 s37, s37, s17
    s_add_u32 s16, s4, 0x480000
    s_addc_u32 s17, s5, 0
    s_mov_b32 s32, s16
    s_and_b32 s33, s17, 0xffff
    s_mov_b32 s34, 163840
    s_mov_b32 s35, 0x20000
    s_mul_i32 s16, s11, 73728
    s_add_u32 s16, s16, 0x890000
    s_lshr_b32 s17, s55, 1
    s_lshl_b32 s17, s17, 10
    s_and_b32 s18, s55, 1
    s_lshl_b32 s18, s18, 9
    s_add_u32 s17, s17, s18
    s_add_u32 s17, s17, s16
    s_add_u32 s56, s4, s17
    s_addc_u32 s57, s5, 0
    s_lshr_b32 s17, s55, 4
    s_add_u32 s17, s17, 16
    s_lshl_b32 s17, s17, 10
    s_lshr_b32 s18, s55, 2
    s_and_b32 s18, s18, 3
    s_lshl_b32 s18, s18, 8
    s_add_u32 s17, s17, s18
    s_and_b32 s18, s55, 3
    s_lshl_b32 s18, s18, 2
    s_add_u32 s17, s17, s18
    s_add_u32 s17, s17, s16
    s_add_u32 s58, s4, s17
    s_addc_u32 s59, s5, 0
    v_lshrrev_b32 v16, 4, v4
    v_mul_u32_u24 v16, 36864, v16
    v_and_b32 v7, 15, v4
    v_lshl_add_u32 v7, v7, 4, v16
    v_add_u32 v140, 104448, v137
    v_add_u32 v141, 104448, v138
    v_add_u32 v142, 104448, v139
    v_mfma_f32_16x16x32_bf16 v[92:95], v[44:47], v[72:75], v[92:95]
    ds_read_b128 v[36:39], v140 offset:0
    ds_read_b128 v[40:43], v140 offset:2048
    ds_read_b64_tr_b16 v[52:53], v142 offset:0
    v_mfma_f32_16x16x32_bf16 v[112:115], v[48:51], v[72:75], v[112:115]
    ds_read_b64_tr_b16 v[54:55], v142 offset:4608
    ds_read_b64_tr_b16 v[56:57], v142 offset:32
    ds_read_b64_tr_b16 v[58:59], v142 offset:4640
    v_mfma_f32_16x16x32_bf16 v[96:99], v[44:47], v[76:79], v[96:99]
    ds_read_b64_tr_b16 v[60:61], v142 offset:160
    ds_read_b64_tr_b16 v[62:63], v142 offset:4768
    ds_read_b64_tr_b16 v[64:65], v142 offset:192
    s_add_u32 m0, s96, 69632
    v_mfma_f32_16x16x32_bf16 v[116:119], v[48:51], v[76:79], v[116:119]
    ds_read_b64_tr_b16 v[66:67], v142 offset:4800
    ds_read_b64_tr_b16 v[68:69], v142 offset:224
    ds_read_b64_tr_b16 v[70:71], v142 offset:4832
    buffer_load_dwordx4 v134, s[44:47], s99 offen lds
    v_mfma_f32_16x16x32_bf16 v[100:103], v[44:47], v[80:83], v[100:103]
    s_add_u32 m0, s96, 70656
    v_mfma_f32_16x16x32_bf16 v[120:123], v[48:51], v[80:83], v[120:123]
    buffer_load_dwordx4 v135, s[44:47], s99 offen lds
    v_mfma_f32_16x16x32_bf16 v[104:107], v[44:47], v[84:87], v[104:107]
    s_add_u32 m0, s97, 86016
    v_mfma_f32_16x16x32_bf16 v[124:127], v[48:51], v[84:87], v[124:127]
    buffer_load_dwordx4 v136, s[48:51], s100 offen lds
    v_mfma_f32_16x16x32_bf16 v[108:111], v[44:47], v[88:91], v[108:111]
    v_mfma_f32_16x16x32_bf16 v[128:131], v[48:51], v[88:91], v[128:131]
    s_waitcnt lgkmcnt(0)
    v_mfma_f32_16x16x32_bf16 v[92:95], v[36:39], v[52:55], v[92:95]
    ds_read_b128 v[44:47], v141 offset:0
    ds_read_b128 v[48:51], v141 offset:2048
    ds_read_b64_tr_b16 v[72:73], v142 offset:9216
    v_mfma_f32_16x16x32_bf16 v[112:115], v[40:43], v[52:55], v[112:115]
    ds_read_b64_tr_b16 v[74:75], v142 offset:13824
    ds_read_b64_tr_b16 v[76:77], v142 offset:9248
    ds_read_b64_tr_b16 v[78:79], v142 offset:13856
    v_mfma_f32_16x16x32_bf16 v[96:99], v[36:39], v[56:59], v[96:99]
    ds_read_b64_tr_b16 v[80:81], v142 offset:9376
    ds_read_b64_tr_b16 v[82:83], v142 offset:13984
    ds_read_b64_tr_b16 v[84:85], v142 offset:9408
    s_add_u32 m0, s97, 87040
    v_mfma_f32_16x16x32_bf16 v[116:119], v[40:43], v[56:59], v[116:119]
    ds_read_b64_tr_b16 v[86:87], v142 offset:14016
    ds_read_b64_tr_b16 v[88:89], v142 offset:9440
    ds_read_b64_tr_b16 v[90:91], v142 offset:14048
    buffer_load_dwordx4 v143, s[48:51], s100 offen lds
    v_mfma_f32_16x16x32_bf16 v[100:103], v[36:39], v[60:63], v[100:103]
    s_add_u32 m0, s98, 102400
    s_cmp_lt_u32 s8, 2
    s_cbranch_scc0 L_B_ex7
    buffer_load_dwordx4 v144, s[48:51], s100 offen lds
L_B_ex7:
    s_add_u32 s99, s99, 128
    s_add_u32 s100, s100, s101
    v_mfma_f32_16x16x32_bf16 v[120:123], v[40:43], v[60:63], v[120:123]
    v_mfma_f32_16x16x32_bf16 v[104:107], v[36:39], v[64:67], v[104:107]
    v_mfma_f32_16x16x32_bf16 v[124:127], v[40:43], v[64:67], v[124:127]
    v_mfma_f32_16x16x32_bf16 v[108:111], v[36:39], v[68:71], v[108:111]
    v_mfma_f32_16x16x32_bf16 v[128:131], v[40:43], v[68:71], v[128:131]
    s_waitcnt vmcnt(9)
    s_waitcnt lgkmcnt(0)
    s_barrier
    v_add_u32 v140, 0, v137
    v_add_u32 v141, 0, v138
    v_add_u32 v142, 0, v139
    v_mfma_f32_16x16x32_bf16 v[92:95], v[44:47], v[72:75], v[92:95]
    ds_read_b128 v[36:39], v140 offset:0
    ds_read_b128 v[40:43], v140 offset:2048
    ds_read_b64_tr_b16 v[52:53], v142 offset:0
    v_mfma_f32_16x16x32_bf16 v[112:115], v[48:51], v[72:75], v[112:115]
    ds_read_b64_tr_b16 v[54:55], v142 offset:4608
    ds_read_b64_tr_b16 v[56:57], v142 offset:32
    ds_read_b64_tr_b16 v[58:59], v142 offset:4640
    v_mfma_f32_16x16x32_bf16 v[96:99], v[44:47], v[76:79], v[96:99]
    ds_read_b64_tr_b16 v[60:61], v142 offset:160
    ds_read_b64_tr_b16 v[62:63], v142 offset:4768
    ds_read_b64_tr_b16 v[64:65], v142 offset:192
    s_add_u32 m0, s96, 104448
    v_mfma_f32_16x16x32_bf16 v[116:119], v[48:51], v[76:79], v[116:119]
    ds_read_b64_tr_b16 v[66:67], v142 offset:4800
    ds_read_b64_tr_b16 v[68:69], v142 offset:224
    ds_read_b64_tr_b16 v[70:71], v142 offset:4832
    buffer_load_dwordx4 v134, s[44:47], s99 offen lds
    v_mfma_f32_16x16x32_bf16 v[100:103], v[44:47], v[80:83], v[100:103]
    s_add_u32 m0, s96, 105472
    v_mfma_f32_16x16x32_bf16 v[120:123], v[48:51], v[80:83], v[120:123]
    buffer_load_dwordx4 v135, s[44:47], s99 offen lds
    v_mfma_f32_16x16x32_bf16 v[104:107], v[44:47], v[84:87], v[104:107]
    s_add_u32 m0, s97, 120832
    v_mfma_f32_16x16x32_bf16 v[124:127], v[48:51], v[84:87], v[124:127]
    buffer_load_dwordx4 v136, s[48:51], s100 offen lds
    v_mfma_f32_16x16x32_bf16 v[108:111], v[44:47], v[88:91], v[108:111]
    v_mfma_f32_16x16x32_bf16 v[128:131], v[48:51], v[88:91], v[128:131]
    s_waitcnt lgkmcnt(0)
    v_mfma_f32_16x16x32_bf16 v[92:95], v[36:39], v[52:55], v[92:95]
    ds_read_b128 v[44:47], v141 offset:0
    ds_read_b128 v[48:51], v141 offset:2048
    ds_read_b64_tr_b16 v[72:73], v142 offset:9216
    v_mfma_f32_16x16x32_bf16 v[112:115], v[40:43], v[52:55], v[112:115]
    ds_read_b64_tr_b16 v[74:75], v142 offset:13824
    ds_read_b64_tr_b16 v[76:77], v142 offset:9248
    ds_read_b64_tr_b16 v[78:79], v142 offset:13856
    v_mfma_f32_16x16x32_bf16 v[96:99], v[36:39], v[56:59], v[96:99]
    ds_read_b64_tr_b16 v[80:81], v142 offset:9376
    ds_read_b64_tr_b16 v[82:83], v142 offset:13984
    ds_read_b64_tr_b16 v[84:85], v142 offset:9408
    s_add_u32 m0, s97, 121856
    v_mfma_f32_16x16x32_bf16 v[116:119], v[40:43], v[56:59], v[116:119]
    ds_read_b64_tr_b16 v[86:87], v142 offset:14016
    ds_read_b64_tr_b16 v[88:89], v142 offset:9440
    ds_read_b64_tr_b16 v[90:91], v142 offset:14048
    buffer_load_dwordx4 v143, s[48:51], s100 offen lds
    v_mfma_f32_16x16x32_bf16 v[100:103], v[36:39], v[60:63], v[100:103]
    s_add_u32 m0, s98, 137216
    s_cmp_lt_u32 s8, 2
    s_cbranch_scc0 L_B_ex8
    buffer_load_dwordx4 v144, s[48:51], s100 offen lds
L_B_ex8:
    s_add_u32 s99, s99, 128
    s_add_u32 s100, s100, s101
    v_mfma_f32_16x16x32_bf16 v[120:123], v[40:43], v[60:63], v[120:123]
    v_mfma_f32_16x16x32_bf16 v[104:107], v[36:39], v[64:67], v[104:107]
    v_mfma_f32_16x16x32_bf16 v[124:127], v[40:43], v[64:67], v[124:127]
    v_mfma_f32_16x16x32_bf16 v[108:111], v[36:39], v[68:71], v[108:111]
    v_mfma_f32_16x16x32_bf16 v[128:131], v[40:43], v[68:71], v[128:131]
    s_waitcnt vmcnt(8)
    s_waitcnt lgkmcnt(0)
    s_barrier
    v_lshlrev_b32 v236, 7, v1
    v_add_u32 v236, 0xf10000, v236
    s_cmp_lg_u32 s8, 0
    s_cbranch_scc1 L_pa_iBkv0
    global_load_dword v232, v236, s[4:5] sc1
L_pa_iBkv0:
    v_add_u32 v140, 34816, v137
    v_add_u32 v141, 34816, v138
    v_add_u32 v142, 34816, v139
    v_mfma_f32_16x16x32_bf16 v[92:95], v[44:47], v[72:75], v[92:95]
    ds_read_b128 v[36:39], v140 offset:0
    ds_read_b128 v[40:43], v140 offset:2048
    ds_read_b64_tr_b16 v[52:53], v142 offset:0
    v_mfma_f32_16x16x32_bf16 v[112:115], v[48:51], v[72:75], v[112:115]
    ds_read_b64_tr_b16 v[54:55], v142 offset:4608
    ds_read_b64_tr_b16 v[56:57], v142 offset:32
    ds_read_b64_tr_b16 v[58:59], v142 offset:4640
    v_mfma_f32_16x16x32_bf16 v[96:99], v[44:47], v[76:79], v[96:99]
    ds_read_b64_tr_b16 v[60:61], v142 offset:160
    ds_read_b64_tr_b16 v[62:63], v142 offset:4768
    ds_read_b64_tr_b16 v[64:65], v142 offset:192
    s_add_u32 m0, s96, 0
    v_mfma_f32_16x16x32_bf16 v[116:119], v[48:51], v[76:79], v[116:119]
    ds_read_b64_tr_b16 v[66:67], v142 offset:4800
    ds_read_b64_tr_b16 v[68:69], v142 offset:224
    ds_read_b64_tr_b16 v[70:71], v142 offset:4832
    buffer_load_dwordx4 v134, s[44:47], s99 offen lds
    v_mfma_f32_16x16x32_bf16 v[100:103], v[44:47], v[80:83], v[100:103]
    s_add_u32 m0, s96, 1024
    v_mfma_f32_16x16x32_bf16 v[120:123], v[48:51], v[80:83], v[120:123]
    buffer_load_dwordx4 v135, s[44:47], s99 offen lds
    v_mfma_f32_16x16x32_bf16 v[104:107], v[44:47], v[84:87], v[104:107]
    s_add_u32 m0, s97, 16384
    v_mfma_f32_16x16x32_bf16 v[124:127], v[48:51], v[84:87], v[124:127]
    buffer_load_dwordx4 v136, s[48:51], s100 offen lds
    v_mfma_f32_16x16x32_bf16 v[108:111], v[44:47], v[88:91], v[108:111]
    v_mfma_f32_16x16x32_bf16 v[128:131], v[48:51], v[88:91], v[128:131]
    s_waitcnt lgkmcnt(0)
    v_mfma_f32_16x16x32_bf16 v[92:95], v[36:39], v[52:55], v[92:95]
    ds_read_b128 v[44:47], v141 offset:0
    ds_read_b128 v[48:51], v141 offset:2048
    ds_read_b64_tr_b16 v[72:73], v142 offset:9216
    v_mfma_f32_16x16x32_bf16 v[112:115], v[40:43], v[52:55], v[112:115]
    ds_read_b64_tr_b16 v[74:75], v142 offset:13824
    ds_read_b64_tr_b16 v[76:77], v142 offset:9248
    ds_read_b64_tr_b16 v[78:79], v142 offset:13856
    v_mfma_f32_16x16x32_bf16 v[96:99], v[36:39], v[56:59], v[96:99]
    ds_read_b64_tr_b16 v[80:81], v142 offset:9376
    ds_read_b64_tr_b16 v[82:83], v142 offset:13984
    ds_read_b64_tr_b16 v[84:85], v142 offset:9408
    s_add_u32 m0, s97, 17408
    v_mfma_f32_16x16x32_bf16 v[116:119], v[40:43], v[56:59], v[116:119]
    ds_read_b64_tr_b16 v[86:87], v142 offset:14016
    ds_read_b64_tr_b16 v[88:89], v142 offset:9440
    ds_read_b64_tr_b16 v[90:91], v142 offset:14048
    buffer_load_dwordx4 v143, s[48:51], s100 offen lds
    v_mfma_f32_16x16x32_bf16 v[100:103], v[36:39], v[60:63], v[100:103]
    s_add_u32 m0, s98, 32768
    s_cmp_lt_u32 s8, 2
    s_cbranch_scc0 L_B_ex9
    buffer_load_dwordx4 v144, s[48:51], s100 offen lds
L_B_ex9:
    s_add_u32 s99, s99, 128
    s_add_u32 s100, s100, s101
    v_mfma_f32_16x16x32_bf16 v[120:123], v[40:43], v[60:63], v[120:123]
    v_mfma_f32_16x16x32_bf16 v[104:107], v[36:39], v[64:67], v[104:107]
    v_mfma_f32_16x16x32_bf16 v[124:127], v[40:43], v[64:67], v[124:127]
    v_mfma_f32_16x16x32_bf16 v[108:111], v[36:39], v[68:71], v[108:111]
    v_mfma_f32_16x16x32_bf16 v[128:131], v[40:43], v[68:71], v[128:131]
    s_waitcnt vmcnt(8)
    s_waitcnt lgkmcnt(0)
    s_barrier
    s_mov_b32 s21, 0
L_non0:
    v_readfirstlane_b32 s3, v211
    s_add_u32 s21, s21, 1
    s_cmp_lg_u32 s3, 0
    s_cbranch_scc1 L_non0_ok
    s_sleep 8
    global_load_dword v211, v210, s[6:7] sc1
    s_waitcnt vmcnt(0)
    s_cmp_lt_u32 s21, 0x40000
    s_cbranch_scc1 L_non0
L_non0_ok:
    v_add_u32 v140, 69632, v137
    v_add_u32 v141, 69632, v138
    v_add_u32 v142, 69632, v139
    v_mfma_f32_16x16x32_bf16 v[92:95], v[44:47], v[72:75], v[92:95]
    ds_read_b128 v[36:39], v140 offset:0
    ds_read_b128 v[40:43], v140 offset:2048
    ds_read_b64_tr_b16 v[52:53], v142 offset:0
    v_mfma_f32_16x16x32_bf16 v[112:115], v[48:51], v[72:75], v[112:115]
    ds_read_b64_tr_b16 v[54:55], v142 offset:4608
    ds_read_b64_tr_b16 v[56:57], v142 offset:32
    ds_read_b64_tr_b16 v[58:59], v142 offset:4640
    v_mfma_f32_16x16x32_bf16 v[96:99], v[44:47], v[76:79], v[96:99]
    ds_read_b64_tr_b16 v[60:61], v142 offset:160
    ds_read_b64_tr_b16 v[62:63], v142 offset:4768
    ds_read_b64_tr_b16 v[64:65], v142 offset:192
    v_mfma_f32_16x16x32_bf16 v[116:119], v[48:51], v[76:79], v[116:119]
    ds_read_b64_tr_b16 v[66:67], v142 offset:4800
    ds_read_b64_tr_b16 v[68:69], v142 offset:224
    ds_read_b64_tr_b16 v[70:71], v142 offset:4832
    v_mfma_f32_16x16x32_bf16 v[100:103], v[44:47], v[80:83], v[100:103]
    v_mfma_f32_16x16x32_bf16 v[120:123], v[48:51], v[80:83], v[120:123]
    v_mfma_f32_16x16x32_bf16 v[104:107], v[44:47], v[84:87], v[104:107]
    v_mfma_f32_16x16x32_bf16 v[124:127], v[48:51], v[84:87], v[124:127]
    v_mfma_f32_16x16x32_bf16 v[108:111], v[44:47], v[88:91], v[108:111]
    v_mfma_f32_16x16x32_bf16 v[128:131], v[48:51], v[88:91], v[128:131]
    s_waitcnt lgkmcnt(0)
    v_mfma_f32_16x16x32_bf16 v[92:95], v[36:39], v[52:55], v[92:95]
    ds_read_b128 v[44:47], v141 offset:0
    ds_read_b128 v[48:51], v141 offset:2048
    ds_read_b64_tr_b16 v[72:73], v142 offset:9216
    v_mfma_f32_16x16x32_bf16 v[112:115], v[40:43], v[52:55], v[112:115]
    ds_read_b64_tr_b16 v[74:75], v142 offset:13824
    ds_read_b64_tr_b16 v[76:77], v142 offset:9248
    ds_read_b64_tr_b16 v[78:79], v142 offset:13856
    v_mfma_f32_16x16x32_bf16 v[96:99], v[36:39], v[56:59], v[96:99]
    ds_read_b64_tr_b16 v[80:81], v142 offset:9376
    ds_read_b64_tr_b16 v[82:83], v142 offset:13984
    ds_read_b64_tr_b16 v[84:85], v142 offset:9408
    v_mfma_f32_16x16x32_bf16 v[116:119], v[40:43], v[56:59], v[116:119]
    ds_read_b64_tr_b16 v[86:87], v142 offset:14016
    ds_read_b64_tr_b16 v[88:89], v142 offset:9440
    ds_read_b64_tr_b16 v[90:91], v142 offset:14048
    v_mfma_f32_16x16x32_bf16 v[100:103], v[36:39], v[60:63], v[100:103]
    v_mfma_f32_16x16x32_bf16 v[120:123], v[40:43], v[60:63], v[120:123]
    v_mfma_f32_16x16x32_bf16 v[104:107], v[36:39], v[64:67], v[104:107]
    v_mfma_f32_16x16x32_bf16 v[124:127], v[40:43], v[64:67], v[124:127]
    v_mfma_f32_16x16x32_bf16 v[108:111], v[36:39], v[68:71], v[108:111]
    v_mfma_f32_16x16x32_bf16 v[128:131], v[40:43], v[68:71], v[128:131]
    s_waitcnt vmcnt(4)
    s_waitcnt lgkmcnt(0)
    s_barrier
    v_add_u32 v140, 104448, v137
    v_add_u32 v141, 104448, v138
    v_add_u32 v142, 104448, v139
    v_mfma_f32_16x16x32_bf16 v[92:95], v[44:47], v[72:75], v[92:95]
    ds_read_b128 v[36:39], v140 offset:0
    ds_read_b128 v[40:43], v140 offset:2048
    ds_read_b64_tr_b16 v[52:53], v142 offset:0
    v_mfma_f32_16x16x32_bf16 v[112:115], v[48:51], v[72:75], v[112:115]
    ds_read_b64_tr_b16 v[54:55], v142 offset:4608
    ds_read_b64_tr_b16 v[56:57], v142 offset:32
    ds_read_b64_tr_b16 v[58:59], v142 offset:4640
    v_mfma_f32_16x16x32_bf16 v[96:99], v[44:47], v[76:79], v[96:99]
    ds_read_b64_tr_b16 v[60:61], v142 offset:160
    ds_read_b64_tr_b16 v[62:63], v142 offset:4768
    ds_read_b64_tr_b16 v[64:65], v142 offset:192
    v_mfma_f32_16x16x32_bf16 v[116:119], v[48:51], v[76:79], v[116:119]
    ds_read_b64_tr_b16 v[66:67], v142 offset:4800
    ds_read_b64_tr_b16 v[68:69], v142 offset:224
    ds_read_b64_tr_b16 v[70:71], v142 offset:4832
    v_mfma_f32_16x16x32_bf16 v[100:103], v[44:47], v[80:83], v[100:103]
    v_mfma_f32_16x16x32_bf16 v[120:123], v[48:51], v[80:83], v[120:123]
    v_mfma_f32_16x16x32_bf16 v[104:107], v[44:47], v[84:87], v[104:107]
    v_mfma_f32_16x16x32_bf16 v[124:127], v[48:51], v[84:87], v[124:127]
    v_mfma_f32_16x16x32_bf16 v[108:111], v[44:47], v[88:91], v[108:111]
    v_mfma_f32_16x16x32_bf16 v[128:131], v[48:51], v[88:91], v[128:131]
    s_waitcnt lgkmcnt(0)
    v_mfma_f32_16x16x32_bf16 v[92:95], v[36:39], v[52:55], v[92:95]
    ds_read_b128 v[44:47], v141 offset:0
    ds_read_b128 v[48:51], v141 offset:2048
    ds_read_b64_tr_b16 v[72:73], v142 offset:9216
    v_mfma_f32_16x16x32_bf16 v[112:115], v[40:43], v[52:55], v[112:115]
    ds_read_b64_tr_b16 v[74:75], v142 offset:13824
    ds_read_b64_tr_b16 v[76:77], v142 offset:9248
    ds_read_b64_tr_b16 v[78:79], v142 offset:13856
    v_mfma_f32_16x16x32_bf16 v[96:99], v[36:39], v[56:59], v[96:99]
    ds_read_b64_tr_b16 v[80:81], v142 offset:9376
    ds_read_b64_tr_b16 v[82:83], v142 offset:13984
    ds_read_b64_tr_b16 v[84:85], v142 offset:9408
    v_mfma_f32_16x16x32_bf16 v[116:119], v[40:43], v[56:59], v[116:119]
    ds_read_b64_tr_b16 v[86:87], v142 offset:14016
    ds_read_b64_tr_b16 v[88:89], v142 offset:9440
    ds_read_b64_tr_b16 v[90:91], v142 offset:14048
    v_mfma_f32_16x16x32_bf16 v[100:103], v[36:39], v[60:63], v[100:103]
    v_mfma_f32_16x16x32_bf16 v[120:123], v[40:43], v[60:63], v[120:123]
    v_mfma_f32_16x16x32_bf16 v[104:107], v[36:39], v[64:67], v[104:107]
    v_mfma_f32_16x16x32_bf16 v[124:127], v[40:43], v[64:67], v[124:127]
    v_mfma_f32_16x16x32_bf16 v[108:111], v[36:39], v[68:71], v[108:111]
    v_mfma_f32_16x16x32_bf16 v[128:131], v[40:43], v[68:71], v[128:131]
    s_waitcnt vmcnt(0)
    s_cmp_lg_u32 s8, 0
    s_cbranch_scc1 L_pa_cBkv0
    s_mov_b32 s21, 0
L_pa_wBkv0_spin:
    s_waitcnt vmcnt(0)
    v_cmp_eq_u32 vcc, s3, v232
    s_add_u32 s21, s21, 1
    s_cmp_eq_u64 vcc, -1
    s_cbranch_scc1 L_pa_wBkv0_ok
    s_sleep 2
    global_load_dword v232, v236, s[4:5] sc1
    s_cmp_lt_u32 s21, 0x40000
    s_cbranch_scc1 L_pa_wBkv0_spin
L_pa_wBkv0_ok:
L_pa_cBkv0:
    s_waitcnt lgkmcnt(0)
    s_barrier
    v_add_u32 v140, 0, v137
    v_add_u32 v141, 0, v138
    v_add_u32 v142, 0, v139
    v_mfma_f32_16x16x32_bf16 v[92:95], v[44:47], v[72:75], v[92:95]
    ds_read_b128 v[36:39], v140 offset:0
    ds_read_b128 v[40:43], v140 offset:2048
    ds_read_b64_tr_b16 v[52:53], v142 offset:0
    v_mfma_f32_16x16x32_bf16 v[112:115], v[48:51], v[72:75], v[112:115]
    ds_read_b64_tr_b16 v[54:55], v142 offset:4608
    ds_read_b64_tr_b16 v[56:57], v142 offset:32
    ds_read_b64_tr_b16 v[58:59], v142 offset:4640
    v_mfma_f32_16x16x32_bf16 v[96:99], v[44:47], v[76:79], v[96:99]
    ds_read_b64_tr_b16 v[60:61], v142 offset:160
    ds_read_b64_tr_b16 v[62:63], v142 offset:4768
    ds_read_b64_tr_b16 v[64:65], v142 offset:192
    s_mov_b32 s96, -1
    s_mov_b32 s98, -1
    s_cmp_eq_u32 s8, 3
    s_cselect_b32 s97, 0, -1
    s_cmp_eq_u32 s8, 7
    s_cselect_b32 s99, 0, -1
    v_lshlrev_b32 v237, 4, v1
    s_add_u32 m0, s29, 119808
    s_mov_b32 s52, s24
    buffer_load_dwordx4 v237, s[32:35], s52 offen sc1 lds
    v_mfma_f32_16x16x32_bf16 v[116:119], v[48:51], v[76:79], v[116:119]
    ds_read_b64_tr_b16 v[66:67], v142 offset:4800
    ds_read_b64_tr_b16 v[68:69], v142 offset:224
    ds_read_b64_tr_b16 v[70:71], v142 offset:4832
    s_add_u32 m0, s30, 119808
    s_mov_b32 s52, s25
    v_mfma_f32_16x16x32_bf16 v[100:103], v[44:47], v[80:83], v[100:103]
    buffer_load_dwordx4 v237, s[32:35], s52 offen sc1 lds
    v_mfma_f32_16x16x32_bf16 v[120:123], v[48:51], v[80:83], v[120:123]
    s_add_u32 m0, s31, 119808
    s_mov_b32 s52, s26
    s_mov_b64 exec, s[96:97]
    buffer_load_dwordx4 v237, s[32:35], s52 offen sc1 lds
    s_mov_b64 exec, -1
    v_mfma_f32_16x16x32_bf16 v[104:107], v[44:47], v[84:87], v[104:107]
    v_mfma_f32_16x16x32_bf16 v[124:127], v[48:51], v[84:87], v[124:127]
    v_mfma_f32_16x16x32_bf16 v[108:111], v[44:47], v[88:91], v[108:111]
    v_mfma_f32_16x16x32_bf16 v[128:131], v[48:51], v[88:91], v[128:131]
    s_waitcnt lgkmcnt(0)
    v_mfma_f32_16x16x32_bf16 v[92:95], v[36:39], v[52:55], v[92:95]
    ds_read_b128 v[44:47], v141 offset:0
    ds_read_b128 v[48:51], v141 offset:2048
    ds_read_b64_tr_b16 v[72:73], v142 offset:9216
    v_mfma_f32_16x16x32_bf16 v[112:115], v[40:43], v[52:55], v[112:115]
    ds_read_b64_tr_b16 v[74:75], v142 offset:13824
    ds_read_b64_tr_b16 v[76:77], v142 offset:9248
    ds_read_b64_tr_b16 v[78:79], v142 offset:13856
    v_mfma_f32_16x16x32_bf16 v[96:99], v[36:39], v[56:59], v[96:99]
    ds_read_b64_tr_b16 v[80:81], v142 offset:9376
    ds_read_b64_tr_b16 v[82:83], v142 offset:13984
    ds_read_b64_tr_b16 v[84:85], v142 offset:9408
    s_add_u32 m0, s36, 119808
    s_mov_b32 s52, s27
    v_mfma_f32_16x16x32_bf16 v[116:119], v[40:43], v[56:59], v[116:119]
    ds_read_b64_tr_b16 v[86:87], v142 offset:14016
    ds_read_b64_tr_b16 v[88:89], v142 offset:9440
    ds_read_b64_tr_b16 v[90:91], v142 offset:14048
    buffer_load_dwordx4 v237, s[32:35], s52 offen sc1 lds
    v_mfma_f32_16x16x32_bf16 v[100:103], v[36:39], v[60:63], v[100:103]
    s_add_u32 m0, s37, 119808
    s_mov_b32 s52, s28
    s_mov_b64 exec, s[98:99]
    buffer_load_dwordx4 v237, s[32:35], s52 offen sc1 lds
    s_mov_b64 exec, -1
    v_mfma_f32_16x16x32_bf16 v[120:123], v[40:43], v[60:63], v[120:123]
    v_and_b32 v236, 31, v1
    s_lshl_b32 s16, s8, 5
    v_add_u32 v236, s16, v236
    v_lshlrev_b32 v236, 7, v236
    v_add_u32 v236, 0xd10000, v236
    s_mov_b32 exec_hi, 0
    global_load_dword v224, v236, s[4:5] sc1
    s_mov_b64 exec, -1
    v_mfma_f32_16x16x32_bf16 v[104:107], v[36:39], v[64:67], v[104:107]
    s_lshl_b32 s16, s11, 7
    s_add_u32 s16, s16, 0x4a9000
    v_and_b32 v236, 31, v1
    v_lshlrev_b32 v236, 2, v236
    v_add_u32 v236, s16, v236
    global_load_dword v228, v236, s[4:5] sc1
    v_mfma_f32_16x16x32_bf16 v[124:127], v[40:43], v[64:67], v[124:127]
    v_mfma_f32_16x16x32_bf16 v[108:111], v[36:39], v[68:71], v[108:111]
    v_mfma_f32_16x16x32_bf16 v[128:131], v[40:43], v[68:71], v[128:131]
    s_waitcnt lgkmcnt(0)
    v_mfma_f32_16x16x32_bf16 v[92:95], v[44:47], v[72:75], v[92:95]
    v_mfma_f32_16x16x32_bf16 v[112:115], v[48:51], v[72:75], v[112:115]
    v_mfma_f32_16x16x32_bf16 v[96:99], v[44:47], v[76:79], v[96:99]
    v_mfma_f32_16x16x32_bf16 v[116:119], v[48:51], v[76:79], v[116:119]
    v_mfma_f32_16x16x32_bf16 v[100:103], v[44:47], v[80:83], v[100:103]
    v_mfma_f32_16x16x32_bf16 v[120:123], v[48:51], v[80:83], v[120:123]
    v_mfma_f32_16x16x32_bf16 v[104:107], v[44:47], v[84:87], v[104:107]
    v_mfma_f32_16x16x32_bf16 v[124:127], v[48:51], v[84:87], v[124:127]
    v_mfma_f32_16x16x32_bf16 v[108:111], v[44:47], v[88:91], v[108:111]
    v_mfma_f32_16x16x32_bf16 v[128:131], v[48:51], v[88:91], v[128:131]
    s_mov_b32 s16, 0x3fb8aa3b
    s_mov_b32 s17, 0x358637bd
    v_cmp_gt_u32 s[74:75], 8, v2
    s_nop 4
    v_mul_f32 v20, s16, v92
    v_exp_f32_e64 v20, v20 clamp
    v_max_f32 v21, 0, v92
    v_add_f32 v21, s17, v21
    v_add_f32 v92, v21, v20
    v_mul_f32 v20, s16, v93
    v_exp_f32_e64 v20, v20 clamp
    v_max_f32 v21, 0, v93
    v_add_f32 v21, s17, v21
    v_add_f32 v93, v21, v20
    v_mul_f32 v20, s16, v94
    v_exp_f32_e64 v20, v20 clamp
    v_max_f32 v21, 0, v94
    v_add_f32 v21, s17, v21
    v_add_f32 v94, v21, v20
    v_mul_f32 v20, s16, v95
    v_exp_f32_e64 v20, v20 clamp
    v_max_f32 v21, 0, v95
    v_add_f32 v21, s17, v21
    v_add_f32 v95, v21, v20
    v_mul_f32 v20, s16, v112
    v_exp_f32_e64 v20, v20 clamp
    v_max_f32 v21, 0, v112
    v_add_f32 v21, s17, v21
    v_add_f32 v112, v21, v20
    v_mul_f32 v20, s16, v113
    v_exp_f32_e64 v20, v20 clamp
    v_max_f32 v21, 0, v113
    v_add_f32 v21, s17, v21
    v_add_f32 v113, v21, v20
    v_mul_f32 v20, s16, v114
    v_exp_f32_e64 v20, v20 clamp
    v_max_f32 v21, 0, v114
    v_add_f32 v21, s17, v21
    v_add_f32 v114, v21, v20
    v_mul_f32 v20, s16, v115
    v_exp_f32_e64 v20, v20 clamp
    v_max_f32 v21, 0, v115
    v_add_f32 v21, s17, v21
    v_add_f32 v115, v21, v20
    v_mul_f32 v20, s16, v96
    v_exp_f32_e64 v20, v20 clamp
    v_max_f32 v21, 0, v96
    v_add_f32 v21, s17, v21
    v_add_f32 v96, v21, v20
    v_mul_f32 v20, s16, v97
    v_exp_f32_e64 v20, v20 clamp
    v_max_f32 v21, 0, v97
    v_add_f32 v21, s17, v21
    v_add_f32 v97, v21, v20
    v_mul_f32 v20, s16, v98
    v_exp_f32_e64 v20, v20 clamp
    v_max_f32 v21, 0, v98
    v_add_f32 v21, s17, v21
    v_add_f32 v98, v21, v20
    v_mul_f32 v20, s16, v99
    v_exp_f32_e64 v20, v20 clamp
    v_max_f32 v21, 0, v99
    v_add_f32 v21, s17, v21
    v_add_f32 v99, v21, v20
    v_mul_f32 v20, s16, v116
    v_exp_f32_e64 v20, v20 clamp
    v_max_f32 v21, 0, v116
    v_add_f32 v21, s17, v21
    v_add_f32 v116, v21, v20
    v_mul_f32 v20, s16, v117
    v_exp_f32_e64 v20, v20 clamp
    v_max_f32 v21, 0, v117
    v_add_f32 v21, s17, v21
    v_add_f32 v117, v21, v20
    v_mul_f32 v20, s16, v118
    v_exp_f32_e64 v20, v20 clamp
    v_max_f32 v21, 0, v118
    v_add_f32 v21, s17, v21
    v_add_f32 v118, v21, v20
    v_mul_f32 v20, s16, v119
    v_exp_f32_e64 v20, v20 clamp
    v_max_f32 v21, 0, v119
    v_add_f32 v21, s17, v21
    v_add_f32 v119, v21, v20
    s_lshl_b32 s18, s14, 6
    s_add_u32 s18, s18, 73728
    v_mul_u32_u24 v20, 272, v2
    v_lshl_add_u32 v20, v3, 3, v20
    v_add_u32 v20, s18, v20
    s_barrier
    v_cvt_pk_bf16_f32 v92, v92, v93
    v_cvt_pk_bf16_f32 v93, v94, v95
    ds_write_b64 v20, v[92:93] offset:0
    v_cvt_pk_bf16_f32 v112, v112, v113
    v_cvt_pk_bf16_f32 v113, v114, v115
    ds_write_b64 v20, v[112:113] offset:32
    v_cvt_pk_bf16_f32 v96, v96, v97
    v_cvt_pk_bf16_f32 v97, v98, v99
    ds_write_b64 v20, v[96:97] offset:4352
    v_cvt_pk_bf16_f32 v116, v116, v117
    v_cvt_pk_bf16_f32 v117, v118, v119
    ds_write_b64 v20, v[116:117] offset:4384
    v_cvt_pk_bf16_f32 v100, v100, v101
    v_cvt_pk_bf16_f32 v101, v102, v103
    ds_write_b64 v20, v[100:101] offset:21760
    v_cvt_pk_bf16_f32 v120, v120, v121
    v_cvt_pk_bf16_f32 v121, v122, v123
    ds_write_b64 v20, v[120:121] offset:21792
    v_cvt_pk_bf16_f32 v104, v104, v105
    v_cvt_pk_bf16_f32 v105, v106, v107
    ds_write_b64 v20, v[104:105] offset:26112
    v_cvt_pk_bf16_f32 v124, v124, v125
    v_cvt_pk_bf16_f32 v125, v126, v127
    ds_write_b64 v20, v[124:125] offset:26144
    v_cvt_pk_bf16_f32 v108, v108, v109
    v_cvt_pk_bf16_f32 v109, v110, v111
    ds_write_b64 v20, v[108:109] offset:30464
    v_cvt_pk_bf16_f32 v128, v128, v129
    v_cvt_pk_bf16_f32 v129, v130, v131
    ds_write_b64 v20, v[128:129] offset:30496
    s_waitcnt lgkmcnt(0)
    s_barrier
    s_branch L_B_kvblk
L_B_kv1:
    s_waitcnt vmcnt(14)
    s_barrier
    v_add_u32 v140, 0, v137
    v_add_u32 v141, 0, v138
    v_add_u32 v142, 0, v139
    ds_read_b128 v[36:39], v140 offset:0
    ds_read_b128 v[40:43], v140 offset:2048
    ds_read_b64_tr_b16 v[52:53], v142 offset:64
    ds_read_b64_tr_b16 v[54:55], v142 offset:4672
    ds_read_b64_tr_b16 v[56:57], v142 offset:96
    ds_read_b64_tr_b16 v[58:59], v142 offset:4704
    ds_read_b64_tr_b16 v[60:61], v142 offset:128
    ds_read_b64_tr_b16 v[62:63], v142 offset:4736
    ds_read_b64_tr_b16 v[64:65], v142 offset:256
    ds_read_b64_tr_b16 v[66:67], v142 offset:4864
    s_waitcnt lgkmcnt(0)
    v_mfma_f32_16x16x32_bf16 v[92:95], v[36:39], v[52:55], 0
    ds_read_b128 v[44:47], v141 offset:0
    ds_read_b128 v[48:51], v141 offset:2048
    ds_read_b64_tr_b16 v[72:73], v142 offset:9280
    v_mfma_f32_16x16x32_bf16 v[112:115], v[40:43], v[52:55], 0
    ds_read_b64_tr_b16 v[74:75], v142 offset:13888
    ds_read_b64_tr_b16 v[76:77], v142 offset:9312
    ds_read_b64_tr_b16 v[78:79], v142 offset:13920
    v_mfma_f32_16x16x32_bf16 v[96:99], v[36:39], v[56:59], 0
    ds_read_b64_tr_b16 v[80:81], v142 offset:9344
    ds_read_b64_tr_b16 v[82:83], v142 offset:13952
    ds_read_b64_tr_b16 v[84:85], v142 offset:9472
    s_add_u32 m0, s96, 104448
    v_mfma_f32_16x16x32_bf16 v[116:119], v[40:43], v[56:59], 0
    ds_read_b64_tr_b16 v[86:87], v142 offset:14080
    buffer_load_dwordx4 v134, s[44:47], s99 offen lds
    v_mfma_f32_16x16x32_bf16 v[100:103], v[36:39], v[60:63], 0
    s_add_u32 m0, s96, 105472
    v_mfma_f32_16x16x32_bf16 v[120:123], v[40:43], v[60:63], 0
    buffer_load_dwordx4 v135, s[44:47], s99 offen lds
    v_mfma_f32_16x16x32_bf16 v[104:107], v[36:39], v[64:67], 0
    s_add_u32 m0, s97, 120832
    v_mfma_f32_16x16x32_bf16 v[124:127], v[40:43], v[64:67], 0
    buffer_load_dwordx4 v136, s[48:51], s100 offen lds
    s_add_u32 m0, s97, 121856
    s_nop 0
    buffer_load_dwordx4 v143, s[48:51], s100 offen lds
    s_add_u32 m0, s98, 137216
    s_cmp_lt_u32 s8, 2
    s_cbranch_scc0 L_B_ex10
    buffer_load_dwordx4 v144, s[48:51], s100 offen lds
L_B_ex10:
    s_add_u32 s99, s99, 128
    s_add_u32 s100, s100, s101
    s_waitcnt vmcnt(14)
    s_waitcnt lgkmcnt(0)
    s_barrier
    v_add_u32 v140, 34816, v137
    v_add_u32 v141, 34816, v138
    v_add_u32 v142, 34816, v139
    v_mfma_f32_16x16x32_bf16 v[92:95], v[44:47], v[72:75], v[92:95]
    ds_read_b128 v[36:39], v140 offset:0
    ds_read_b128 v[40:43], v140 offset:2048
    ds_read_b64_tr_b16 v[52:53], v142 offset:64
    v_mfma_f32_16x16x32_bf16 v[112:115], v[48:51], v[72:75], v[112:115]
    ds_read_b64_tr_b16 v[54:55], v142 offset:4672
    ds_read_b64_tr_b16 v[56:57], v142 offset:96
    ds_read_b64_tr_b16 v[58:59], v142 offset:4704
    v_mfma_f32_16x16x32_bf16 v[96:99], v[44:47], v[76:79], v[96:99]
    ds_read_b64_tr_b16 v[60:61], v142 offset:128
    ds_read_b64_tr_b16 v[62:63], v142 offset:4736
    ds_read_b64_tr_b16 v[64:65], v142 offset:256
    s_add_u32 m0, s96, 0
    v_mfma_f32_16x16x32_bf16 v[116:119], v[48:51], v[76:79], v[116:119]
    ds_read_b64_tr_b16 v[66:67], v142 offset:4864
    buffer_load_dwordx4 v134, s[44:47], s99 offen lds
    v_mfma_f32_16x16x32_bf16 v[100:103], v[44:47], v[80:83], v[100:103]
    s_add_u32 m0, s96, 1024
    v_mfma_f32_16x16x32_bf16 v[120:123], v[48:51], v[80:83], v[120:123]
    buffer_load_dwordx4 v135, s[44:47], s99 offen lds
    v_mfma_f32_16x16x32_bf16 v[104:107], v[44:47], v[84:87], v[104:107]
    s_add_u32 m0, s97, 16384
    v_mfma_f32_16x16x32_bf16 v[124:127], v[48:51], v[84:87], v[124:127]
    buffer_load_dwordx4 v136, s[48:51], s100 offen lds
    s_waitcnt lgkmcnt(0)
    v_mfma_f32_16x16x32_bf16 v[92:95], v[36:39], v[52:55], v[92:95]
    ds_read_b128 v[44:47], v141 offset:0
    ds_read_b128 v[48:51], v141 offset:2048
    ds_read_b64_tr_b16 v[72:73], v142 offset:9280
    v_mfma_f32_16x16x32_bf16 v[112:115], v[40:43], v[52:55], v[112:115]
    ds_read_b64_tr_b16 v[74:75], v142 offset:13888
    ds_read_b64_tr_b16 v[76:77], v142 offset:9312
    ds_read_b64_tr_b16 v[78:79], v142 offset:13920
    v_mfma_f32_16x16x32_bf16 v[96:99], v[36:39], v[56:59], v[96:99]
    ds_read_b64_tr_b16 v[80:81], v142 offset:9344
    ds_read_b64_tr_b16 v[82:83], v142 offset:13952
    ds_read_b64_tr_b16 v[84:85], v142 offset:9472
    s_add_u32 m0, s97, 17408
    v_mfma_f32_16x16x32_bf16 v[116:119], v[40:43], v[56:59], v[116:119]
    ds_read_b64_tr_b16 v[86:87], v142 offset:14080
    buffer_load_dwordx4 v143, s[48:51], s100 offen lds
    v_mfma_f32_16x16x32_bf16 v[100:103], v[36:39], v[60:63], v[100:103]
    s_add_u32 m0, s98, 32768
    s_cmp_lt_u32 s8, 2
    s_cbranch_scc0 L_B_ex11
    buffer_load_dwordx4 v144, s[48:51], s100 offen lds
L_B_ex11:
    s_add_u32 s99, s99, 128
    s_add_u32 s100, s100, s101
    v_mfma_f32_16x16x32_bf16 v[120:123], v[40:43], v[60:63], v[120:123]
    v_mfma_f32_16x16x32_bf16 v[104:107], v[36:39], v[64:67], v[104:107]
    v_mfma_f32_16x16x32_bf16 v[124:127], v[40:43], v[64:67], v[124:127]
    s_waitcnt vmcnt(14)
    s_waitcnt lgkmcnt(0)
    s_barrier
    v_mov_b32 v210, 0
    global_load_dword v211, v210, s[6:7] sc1
    v_add_u32 v140, 69632, v137
    v_add_u32 v141, 69632, v138
    v_add_u32 v142, 69632, v139
    v_mfma_f32_16x16x32_bf16 v[92:95], v[44:47], v[72:75], v[92:95]
    ds_read_b128 v[36:39], v140 offset:0
    ds_read_b128 v[40:43], v140 offset:2048
    ds_read_b64_tr_b16 v[52:53], v142 offset:64
    v_mfma_f32_16x16x32_bf16 v[112:115], v[48:51], v[72:75], v[112:115]
    ds_read_b64_tr_b16 v[54:55], v142 offset:4672
    ds_read_b64_tr_b16 v[56:57], v142 offset:96
    ds_read_b64_tr_b16 v[58:59], v142 offset:4704
    v_mfma_f32_16x16x32_bf16 v[96:99], v[44:47], v[76:79], v[96:99]
    ds_read_b64_tr_b16 v[60:61], v142 offset:128
    ds_read_b64_tr_b16 v[62:63], v142 offset:4736
    ds_read_b64_tr_b16 v[64:65], v142 offset:256
    s_add_u32 m0, s96, 34816
    v_mfma_f32_16x16x32_bf16 v[116:119], v[48:51], v[76:79], v[116:119]
    ds_read_b64_tr_b16 v[66:67], v142 offset:4864
    buffer_load_dwordx4 v134, s[44:47], s99 offen lds
    v_mfma_f32_16x16x32_bf16 v[100:103], v[44:47], v[80:83], v[100:103]
    s_add_u32 m0, s96, 35840
    v_mfma_f32_16x16x32_bf16 v[120:123], v[48:51], v[80:83], v[120:123]
    buffer_load_dwordx4 v135, s[44:47], s99 offen lds
    v_mfma_f32_16x16x32_bf16 v[104:107], v[44:47], v[84:87], v[104:107]
    s_add_u32 m0, s97, 51200
    v_mfma_f32_16x16x32_bf16 v[124:127], v[48:51], v[84:87], v[124:127]
    buffer_load_dwordx4 v136, s[48:51], s100 offen lds
    s_waitcnt lgkmcnt(0)
    v_mfma_f32_16x16x32_bf16 v[92:95], v[36:39], v[52:55], v[92:95]
    ds_read_b128 v[44:47], v141 offset:0
    ds_read_b128 v[48:51], v141 offset:2048
    ds_read_b64_tr_b16 v[72:73], v142 offset:9280
    v_mfma_f32_16x16x32_bf16 v[112:115], v[40:43], v[52:55], v[112:115]
    ds_read_b64_tr_b16 v[74:75], v142 offset:13888
    ds_read_b64_tr_b16 v[76:77], v142 offset:9312
    ds_read_b64_tr_b16 v[78:79], v142 offset:13920
    v_mfma_f32_16x16x32_bf16 v[96:99], v[36:39], v[56:59], v[96:99]
    ds_read_b64_tr_b16 v[80:81], v142 offset:9344
    ds_read_b64_tr_b16 v[82:83], v142 offset:13952
    ds_read_b64_tr_b16 v[84:85], v142 offset:9472
    s_add_u32 m0, s97, 52224
    v_mfma_f32_16x16x32_bf16 v[116:119], v[40:43], v[56:59], v[116:119]
    ds_read_b64_tr_b16 v[86:87], v142 offset:14080
    buffer_load_dwordx4 v143, s[48:51], s100 offen lds
    v_mfma_f32_16x16x32_bf16 v[100:103], v[36:39], v[60:63], v[100:103]
    s_add_u32 m0, s98, 67584
    s_cmp_lt_u32 s8, 2
    s_cbranch_scc0 L_B_ex12
    buffer_load_dwordx4 v144, s[48:51], s100 offen lds
L_B_ex12:
    s_add_u32 s99, s99, 128
    s_add_u32 s100, s100, s101
    v_mfma_f32_16x16x32_bf16 v[120:123], v[40:43], v[60:63], v[120:123]
    v_mfma_f32_16x16x32_bf16 v[104:107], v[36:39], v[64:67], v[104:107]
    v_mfma_f32_16x16x32_bf16 v[124:127], v[40:43], v[64:67], v[124:127]
    s_waitcnt vmcnt(9)
    s_waitcnt lgkmcnt(0)
    s_barrier
    s_cmp_eq_u32 s60, 0
    s_cbranch_scc1 L_WF_post_end2
    v_lshrrev_b32 v20, 2, v2
    v_lshl_add_u32 v20, v3, 2, v20
    v_and_b32 v21, 3, v2
    v_lshlrev_b32 v21, 3, v21
    v_mul_u32_u24 v20, 288, v20
    v_add_u32 v20, v20, v21
    s_lshl_b32 s16, s8, 5
    s_add_u32 s16, s16, 139264
    v_add_u32 v20, s16, v20
    v_lshlrev_b32 v21, 4, v1
    ds_read_b64_tr_b16 v[28:29], v20
    ds_read_b64_tr_b16 v[30:31], v20 offset:4608
    ds_read_b64_tr_b16 v[32:33], v20 offset:256
    ds_read_b64_tr_b16 v[34:35], v20 offset:4864
    s_waitcnt lgkmcnt(0)
    global_store_dwordx4 v21, v[28:31], s[22:23] sc1
    s_cmp_lg_u32 s8, 0
    s_cbranch_scc1 L_WF_post_end2
    s_add_u32 s22, s22, 147456
    s_addc_u32 s23, s23, 0
    global_store_dwordx4 v21, v[32:35], s[22:23] sc1
L_WF_post_end2:
    v_and_b32 v4, 31, v1
    v_lshrrev_b32 v5, 5, v1
    v_lshlrev_b32 v6, 4, v1
    s_lshl_b32 s16, s14, 1
    s_lshl_b32 s54, s12, 3
    s_add_u32 s54, s54, s16
    s_add_u32 s55, s54, s13
    s_mov_b32 s64, -1
    s_mov_b32 s65, 0
    s_mov_b32 s66, 0x7ffff
    s_mov_b32 s67, 0x7ffff
    v_mov_b32 v242, -1
    v_mov_b32 v243, 0
    s_add_u32 s62, s4, 0x4b0000
    s_addc_u32 s63, s5, 0
    s_add_u32 s16, s8, 0
    s_lshl_b32 s24, s16, 10
    s_mov_b32 s29, s24
    s_cmp_ge_u32 s16, 20
    s_cselect_b32 s17, 59392, 0
    s_add_u32 s24, s24, s17
    s_cmp_ge_u32 s16, 20
    s_cselect_b32 s17, 4294966784, 0
    s_add_u32 s29, s29, s17
    s_add_u32 s16, s8, 8
    s_lshl_b32 s25, s16, 10
    s_mov_b32 s30, s25
    s_cmp_ge_u32 s16, 20
    s_cselect_b32 s17, 59392, 0
    s_add_u32 s25, s25, s17
    s_cmp_ge_u32 s16, 20
    s_cselect_b32 s17, 4294966784, 0
    s_add_u32 s30, s30, s17
    s_add_u32 s16, s8, 16
    s_lshl_b32 s26, s16, 10
    s_mov_b32 s31, s26
    s_cmp_ge_u32 s16, 20
    s_cselect_b32 s17, 59392, 0
    s_add_u32 s26, s26, s17
    s_cmp_ge_u32 s16, 20
    s_cselect_b32 s17, 4294966784, 0
    s_add_u32 s31, s31, s17
    s_add_u32 s16, s8, 24
    s_lshl_b32 s27, s16, 10
    s_mov_b32 s36, s27
    s_cmp_ge_u32 s16, 20
    s_cselect_b32 s17, 59392, 0
    s_add_u32 s27, s27, s17
    s_cmp_ge_u32 s16, 20
    s_cselect_b32 s17, 4294966784, 0
    s_add_u32 s36, s36, s17
    s_add_u32 s16, s8, 32
    s_lshl_b32 s28, s16, 10
    s_mov_b32 s37, s28
    s_cmp_ge_u32 s16, 20
    s_cselect_b32 s17, 59392, 0
    s_add_u32 s28, s28, s17
    s_cmp_ge_u32 s16, 20
    s_cselect_b32 s17, 4294966784, 0
    s_add_u32 s37, s37, s17
    s_add_u32 s16, s4, 0x480000
    s_addc_u32 s17, s5, 0
    s_mov_b32 s32, s16
    s_and_b32 s33, s17, 0xffff
    s_mov_b32 s34, 163840
    s_mov_b32 s35, 0x20000
    s_mul_i32 s16, s11, 73728
    s_add_u32 s16, s16, 0x890000
    s_lshr_b32 s17, s55, 1
    s_lshl_b32 s17, s17, 10
    s_and_b32 s18, s55, 1
    s_lshl_b32 s18, s18, 9
    s_add_u32 s17, s17, s18
    s_add_u32 s17, s17, s16
    s_add_u32 s56, s4, s17
    s_addc_u32 s57, s5, 0
    s_lshr_b32 s17, s55, 4
    s_add_u32 s17, s17, 16
    s_lshl_b32 s17, s17, 10
    s_lshr_b32 s18, s55, 2
    s_and_b32 s18, s18, 3
    s_lshl_b32 s18, s18, 8
    s_add_u32 s17, s17, s18
    s_and_b32 s18, s55, 3
    s_lshl_b32 s18, s18, 2
    s_add_u32 s17, s17, s18
    s_add_u32 s17, s17, s16
    s_add_u32 s58, s4, s17
    s_addc_u32 s59, s5, 0
    v_lshrrev_b32 v16, 4, v4
    v_mul_u32_u24 v16, 36864, v16
    v_and_b32 v7, 15, v4
    v_lshl_add_u32 v7, v7, 4, v16
    v_add_u32 v140, 104448, v137
    v_add_u32 v141, 104448, v138
    v_add_u32 v142, 104448, v139
    v_mfma_f32_16x16x32_bf16 v[92:95], v[44:47], v[72:75], v[92:95]
    ds_read_b128 v[36:39], v140 offset:0
    ds_read_b128 v[40:43], v140 offset:2048
    ds_read_b64_tr_b16 v[52:53], v142 offset:64
    v_mfma_f32_16x16x32_bf16 v[112:115], v[48:51], v[72:75], v[112:115]
    ds_read_b64_tr_b16 v[54:55], v142 offset:4672
    ds_read_b64_tr_b16 v[56:57], v142 offset:96
    ds_read_b64_tr_b16 v[58:59], v142 offset:4704
    v_mfma_f32_16x16x32_bf16 v[96:99], v[44:47], v[76:79], v[96:99]
    ds_read_b64_tr_b16 v[60:61], v142 offset:128
    ds_read_b64_tr_b16 v[62:63], v142 offset:4736
    ds_read_b64_tr_b16 v[64:65], v142 offset:256
    s_add_u32 m0, s96, 69632
    v_mfma_f32_16x16x32_bf16 v[116:119], v[48:51], v[76:79], v[116:119]
    ds_read_b64_tr_b16 v[66:67], v142 offset:4864
    buffer_load_dwordx4 v134, s[44:47], s99 offen lds
    v_mfma_f32_16x16x32_bf16 v[100:103], v[44:47], v[80:83], v[100:103]
    s_add_u32 m0, s96, 70656
    v_mfma_f32_16x16x32_bf16 v[120:123], v[48:51], v[80:83], v[120:123]
    buffer_load_dwordx4 v135, s[44:47], s99 offen lds
    v_mfma_f32_16x16x32_bf16 v[104:107], v[44:47], v[84:87], v[104:107]
    s_add_u32 m0, s97, 86016
    v_mfma_f32_16x16x32_bf16 v[124:127], v[48:51], v[84:87], v[124:127]
    buffer_load_dwordx4 v136, s[48:51], s100 offen lds
    s_waitcnt lgkmcnt(0)
    v_mfma_f32_16x16x32_bf16 v[92:95], v[36:39], v[52:55], v[92:95]
    ds_read_b128 v[44:47], v141 offset:0
    ds_read_b128 v[48:51], v141 offset:2048
    ds_read_b64_tr_b16 v[72:73], v142 offset:9280
    v_mfma_f32_16x16x32_bf16 v[112:115], v[40:43], v[52:55], v[112:115]
    ds_read_b64_tr_b16 v[74:75], v142 offset:13888
    ds_read_b64_tr_b16 v[76:77], v142 offset:9312
    ds_read_b64_tr_b16 v[78:79], v142 offset:13920
    v_mfma_f32_16x16x32_bf16 v[96:99], v[36:39], v[56:59], v[96:99]
    ds_read_b64_tr_b16 v[80:81], v142 offset:9344
    ds_read_b64_tr_b16 v[82:83], v142 offset:13952
    ds_read_b64_tr_b16 v[84:85], v142 offset:9472
    s_add_u32 m0, s97, 87040
    v_mfma_f32_16x16x32_bf16 v[116:119], v[40:43], v[56:59], v[116:119]
    ds_read_b64_tr_b16 v[86:87], v142 offset:14080
    buffer_load_dwordx4 v143, s[48:51], s100 offen lds
    v_mfma_f32_16x16x32_bf16 v[100:103], v[36:39], v[60:63], v[100:103]
    s_add_u32 m0, s98, 102400
    s_cmp_lt_u32 s8, 2
    s_cbranch_scc0 L_B_ex13
    buffer_load_dwordx4 v144, s[48:51], s100 offen lds
L_B_ex13:
    s_add_u32 s99, s99, 128
    s_add_u32 s100, s100, s101
    v_mfma_f32_16x16x32_bf16 v[120:123], v[40:43], v[60:63], v[120:123]
    v_mfma_f32_16x16x32_bf16 v[104:107], v[36:39], v[64:67], v[104:107]
    v_mfma_f32_16x16x32_bf16 v[124:127], v[40:43], v[64:67], v[124:127]
    s_waitcnt vmcnt(9)
    s_waitcnt lgkmcnt(0)
    s_barrier
    v_add_u32 v140, 0, v137
    v_add_u32 v141, 0, v138
    v_add_u32 v142, 0, v139
    v_mfma_f32_16x16x32_bf16 v[92:95], v[44:47], v[72:75], v[92:95]
    ds_read_b128 v[36:39], v140 offset:0
    ds_read_b128 v[40:43], v140 offset:2048
    ds_read_b64_tr_b16 v[52:53], v142 offset:64
    v_mfma_f32_16x16x32_bf16 v[112:115], v[48:51], v[72:75], v[112:115]
    ds_read_b64_tr_b16 v[54:55], v142 offset:4672
    ds_read_b64_tr_b16 v[56:57], v142 offset:96
    ds_read_b64_tr_b16 v[58:59], v142 offset:4704
    v_mfma_f32_16x16x32_bf16 v[96:99], v[44:47], v[76:79], v[96:99]
    ds_read_b64_tr_b16 v[60:61], v142 offset:128
    ds_read_b64_tr_b16 v[62:63], v142 offset:4736
    ds_read_b64_tr_b16 v[64:65], v142 offset:256
    s_add_u32 m0, s96, 104448
    v_mfma_f32_16x16x32_bf16 v[116:119], v[48:51], v[76:79], v[116:119]
    ds_read_b64_tr_b16 v[66:67], v142 offset:4864
    buffer_load_dwordx4 v134, s[44:47], s99 offen lds
    v_mfma_f32_16x16x32_bf16 v[100:103], v[44:47], v[80:83], v[100:103]
    s_add_u32 m0, s96, 105472
    v_mfma_f32_16x16x32_bf16 v[120:123], v[48:51], v[80:83], v[120:123]
    buffer_load_dwordx4 v135, s[44:47], s99 offen lds
    v_mfma_f32_16x16x32_bf16 v[104:107], v[44:47], v[84:87], v[104:107]
    s_add_u32 m0, s97, 120832
    v_mfma_f32_16x16x32_bf16 v[124:127], v[48:51], v[84:87], v[124:127]
    buffer_load_dwordx4 v136, s[48:51], s100 offen lds
    s_waitcnt lgkmcnt(0)
    v_mfma_f32_16x16x32_bf16 v[92:95], v[36:39], v[52:55], v[92:95]
    ds_read_b128 v[44:47], v141 offset:0
    ds_read_b128 v[48:51], v141 offset:2048
    ds_read_b64_tr_b16 v[72:73], v142 offset:9280
    v_mfma_f32_16x16x32_bf16 v[112:115], v[40:43], v[52:55], v[112:115]
    ds_read_b64_tr_b16 v[74:75], v142 offset:13888
    ds_read_b64_tr_b16 v[76:77], v142 offset:9312
    ds_read_b64_tr_b16 v[78:79], v142 offset:13920
    v_mfma_f32_16x16x32_bf16 v[96:99], v[36:39], v[56:59], v[96:99]
    ds_read_b64_tr_b16 v[80:81], v142 offset:9344
    ds_read_b64_tr_b16 v[82:83], v142 offset:13952
    ds_read_b64_tr_b16 v[84:85], v142 offset:9472
    s_add_u32 m0, s97, 121856
    v_mfma_f32_16x16x32_bf16 v[116:119], v[40:43], v[56:59], v[116:119]
    ds_read_b64_tr_b16 v[86:87], v142 offset:14080
    buffer_load_dwordx4 v143, s[48:51], s100 offen lds
    v_mfma_f32_16x16x32_bf16 v[100:103], v[36:39], v[60:63], v[100:103]
    s_add_u32 m0, s98, 137216
    s_cmp_lt_u32 s8, 2
    s_cbranch_scc0 L_B_ex14
    buffer_load_dwordx4 v144, s[48:51], s100 offen lds
L_B_ex14:
    s_add_u32 s99, s99, 128
    s_add_u32 s100, s100, s101
    v_mfma_f32_16x16x32_bf16 v[120:123], v[40:43], v[60:63], v[120:123]
    v_mfma_f32_16x16x32_bf16 v[104:107], v[36:39], v[64:67], v[104:107]
    v_mfma_f32_16x16x32_bf16 v[124:127], v[40:43], v[64:67], v[124:127]
    s_waitcnt vmcnt(8)
    s_waitcnt lgkmcnt(0)
    s_barrier
    v_lshlrev_b32 v236, 7, v1
    v_add_u32 v236, 0xf10000, v236
    s_cmp_lg_u32 s8, 0
    s_cbranch_scc1 L_pa_iBkv1
    global_load_dword v232, v236, s[4:5] sc1
L_pa_iBkv1:
    v_add_u32 v140, 34816, v137
    v_add_u32 v141, 34816, v138
    v_add_u32 v142, 34816, v139
    v_mfma_f32_16x16x32_bf16 v[92:95], v[44:47], v[72:75], v[92:95]
    ds_read_b128 v[36:39], v140 offset:0
    ds_read_b128 v[40:43], v140 offset:2048
    ds_read_b64_tr_b16 v[52:53], v142 offset:64
    v_mfma_f32_16x16x32_bf16 v[112:115], v[48:51], v[72:75], v[112:115]
    ds_read_b64_tr_b16 v[54:55], v142 offset:4672
    ds_read_b64_tr_b16 v[56:57], v142 offset:96
    ds_read_b64_tr_b16 v[58:59], v142 offset:4704
    v_mfma_f32_16x16x32_bf16 v[96:99], v[44:47], v[76:79], v[96:99]
    ds_read_b64_tr_b16 v[60:61], v142 offset:128
    ds_read_b64_tr_b16 v[62:63], v142 offset:4736
    ds_read_b64_tr_b16 v[64:65], v142 offset:256
    s_add_u32 m0, s96, 0
    v_mfma_f32_16x16x32_bf16 v[116:119], v[48:51], v[76:79], v[116:119]
    ds_read_b64_tr_b16 v[66:67], v142 offset:4864
    buffer_load_dwordx4 v134, s[44:47], s99 offen lds
    v_mfma_f32_16x16x32_bf16 v[100:103], v[44:47], v[80:83], v[100:103]
    s_add_u32 m0, s96, 1024
    v_mfma_f32_16x16x32_bf16 v[120:123], v[48:51], v[80:83], v[120:123]
    buffer_load_dwordx4 v135, s[44:47], s99 offen lds
    v_mfma_f32_16x16x32_bf16 v[104:107], v[44:47], v[84:87], v[104:107]
    s_add_u32 m0, s97, 16384
    v_mfma_f32_16x16x32_bf16 v[124:127], v[48:51], v[84:87], v[124:127]
    buffer_load_dwordx4 v136, s[48:51], s100 offen lds
    s_waitcnt lgkmcnt(0)
    v_mfma_f32_16x16x32_bf16 v[92:95], v[36:39], v[52:55], v[92:95]
    ds_read_b128 v[44:47], v141 offset:0
    ds_read_b128 v[48:51], v141 offset:2048
    ds_read_b64_tr_b16 v[72:73], v142 offset:9280
    v_mfma_f32_16x16x32_bf16 v[112:115], v[40:43], v[52:55], v[112:115]
    ds_read_b64_tr_b16 v[74:75], v142 offset:13888
    ds_read_b64_tr_b16 v[76:77], v142 offset:9312
    ds_read_b64_tr_b16 v[78:79], v142 offset:13920
    v_mfma_f32_16x16x32_bf16 v[96:99], v[36:39], v[56:59], v[96:99]
    ds_read_b64_tr_b16 v[80:81], v142 offset:9344
    ds_read_b64_tr_b16 v[82:83], v142 offset:13952
    ds_read_b64_tr_b16 v[84:85], v142 offset:9472
    s_add_u32 m0, s97, 17408
    v_mfma_f32_16x16x32_bf16 v[116:119], v[40:43], v[56:59], v[116:119]
    ds_read_b64_tr_b16 v[86:87], v142 offset:14080
    buffer_load_dwordx4 v143, s[48:51], s100 offen lds
    v_mfma_f32_16x16x32_bf16 v[100:103], v[36:39], v[60:63], v[100:103]
    s_add_u32 m0, s98, 32768
    s_cmp_lt_u32 s8, 2
    s_cbranch_scc0 L_B_ex15
    buffer_load_dwordx4 v144, s[48:51], s100 offen lds
L_B_ex15:
    s_add_u32 s99, s99, 128
    s_add_u32 s100, s100, s101
    v_mfma_f32_16x16x32_bf16 v[120:123], v[40:43], v[60:63], v[120:123]
    v_mfma_f32_16x16x32_bf16 v[104:107], v[36:39], v[64:67], v[104:107]
    v_mfma_f32_16x16x32_bf16 v[124:127], v[40:43], v[64:67], v[124:127]
    s_waitcnt vmcnt(8)
    s_waitcnt lgkmcnt(0)
    s_barrier
    s_mov_b32 s21, 0
L_non1:
    v_readfirstlane_b32 s3, v211
    s_add_u32 s21, s21, 1
    s_cmp_lg_u32 s3, 0
    s_cbranch_scc1 L_non1_ok
    s_sleep 8
    global_load_dword v211, v210, s[6:7] sc1
    s_waitcnt vmcnt(0)
    s_cmp_lt_u32 s21, 0x40000
    s_cbranch_scc1 L_non1
L_non1_ok:
    v_add_u32 v140, 69632, v137
    v_add_u32 v141, 69632, v138
    v_add_u32 v142, 69632, v139
    v_mfma_f32_16x16x32_bf16 v[92:95], v[44:47], v[72:75], v[92:95]
    ds_read_b128 v[36:39], v140 offset:0
    ds_read_b128 v[40:43], v140 offset:2048
    ds_read_b64_tr_b16 v[52:53], v142 offset:64
    v_mfma_f32_16x16x32_bf16 v[112:115], v[48:51], v[72:75], v[112:115]
    ds_read_b64_tr_b16 v[54:55], v142 offset:4672
    ds_read_b64_tr_b16 v[56:57], v142 offset:96
    ds_read_b64_tr_b16 v[58:59], v142 offset:4704
    v_mfma_f32_16x16x32_bf16 v[96:99], v[44:47], v[76:79], v[96:99]
    ds_read_b64_tr_b16 v[60:61], v142 offset:128
    ds_read_b64_tr_b16 v[62:63], v142 offset:4736
    ds_read_b64_tr_b16 v[64:65], v142 offset:256
    v_mfma_f32_16x16x32_bf16 v[116:119], v[48:51], v[76:79], v[116:119]
    ds_read_b64_tr_b16 v[66:67], v142 offset:4864
    v_mfma_f32_16x16x32_bf16 v[100:103], v[44:47], v[80:83], v[100:103]
    v_mfma_f32_16x16x32_bf16 v[120:123], v[48:51], v[80:83], v[120:123]
    v_mfma_f32_16x16x32_bf16 v[104:107], v[44:47], v[84:87], v[104:107]
    v_mfma_f32_16x16x32_bf16 v[124:127], v[48:51], v[84:87], v[124:127]
    s_waitcnt lgkmcnt(0)
    v_mfma_f32_16x16x32_bf16 v[92:95], v[36:39], v[52:55], v[92:95]
    ds_read_b128 v[44:47], v141 offset:0
    ds_read_b128 v[48:51], v141 offset:2048
    ds_read_b64_tr_b16 v[72:73], v142 offset:9280
    v_mfma_f32_16x16x32_bf16 v[112:115], v[40:43], v[52:55], v[112:115]
    ds_read_b64_tr_b16 v[74:75], v142 offset:13888
    ds_read_b64_tr_b16 v[76:77], v142 offset:9312
    ds_read_b64_tr_b16 v[78:79], v142 offset:13920
    v_mfma_f32_16x16x32_bf16 v[96:99], v[36:39], v[56:59], v[96:99]
    ds_read_b64_tr_b16 v[80:81], v142 offset:9344
    ds_read_b64_tr_b16 v[82:83], v142 offset:13952
    ds_read_b64_tr_b16 v[84:85], v142 offset:9472
    v_mfma_f32_16x16x32_bf16 v[116:119], v[40:43], v[56:59], v[116:119]
    ds_read_b64_tr_b16 v[86:87], v142 offset:14080
    v_mfma_f32_16x16x32_bf16 v[100:103], v[36:39], v[60:63], v[100:103]
    v_mfma_f32_16x16x32_bf16 v[120:123], v[40:43], v[60:63], v[120:123]
    v_mfma_f32_16x16x32_bf16 v[104:107], v[36:39], v[64:67], v[104:107]
    v_mfma_f32_16x16x32_bf16 v[124:127], v[40:43], v[64:67], v[124:127]
    s_waitcnt vmcnt(4)
    s_waitcnt lgkmcnt(0)
    s_barrier
    v_add_u32 v140, 104448, v137
    v_add_u32 v141, 104448, v138
    v_add_u32 v142, 104448, v139
    v_mfma_f32_16x16x32_bf16 v[92:95], v[44:47], v[72:75], v[92:95]
    ds_read_b128 v[36:39], v140 offset:0
    ds_read_b128 v[40:43], v140 offset:2048
    ds_read_b64_tr_b16 v[52:53], v142 offset:64
    v_mfma_f32_16x16x32_bf16 v[112:115], v[48:51], v[72:75], v[112:115]
    ds_read_b64_tr_b16 v[54:55], v142 offset:4672
    ds_read_b64_tr_b16 v[56:57], v142 offset:96
    ds_read_b64_tr_b16 v[58:59], v142 offset:4704
    v_mfma_f32_16x16x32_bf16 v[96:99], v[44:47], v[76:79], v[96:99]
    ds_read_b64_tr_b16 v[60:61], v142 offset:128
    ds_read_b64_tr_b16 v[62:63], v142 offset:4736
    ds_read_b64_tr_b16 v[64:65], v142 offset:256
    v_mfma_f32_16x16x32_bf16 v[116:119], v[48:51], v[76:79], v[116:119]
    ds_read_b64_tr_b16 v[66:67], v142 offset:4864
    v_mfma_f32_16x16x32_bf16 v[100:103], v[44:47], v[80:83], v[100:103]
    v_mfma_f32_16x16x32_bf16 v[120:123], v[48:51], v[80:83], v[120:123]
    v_mfma_f32_16x16x32_bf16 v[104:107], v[44:47], v[84:87], v[104:107]
    v_mfma_f32_16x16x32_bf16 v[124:127], v[48:51], v[84:87], v[124:127]
    s_waitcnt lgkmcnt(0)
    v_mfma_f32_16x16x32_bf16 v[92:95], v[36:39], v[52:55], v[92:95]
    ds_read_b128 v[44:47], v141 offset:0
    ds_read_b128 v[48:51], v141 offset:2048
    ds_read_b64_tr_b16 v[72:73], v142 offset:9280
    v_mfma_f32_16x16x32_bf16 v[112:115], v[40:43], v[52:55], v[112:115]
    ds_read_b64_tr_b16 v[74:75], v142 offset:13888
    ds_read_b64_tr_b16 v[76:77], v142 offset:9312
    ds_read_b64_tr_b16 v[78:79], v142 offset:13920
    v_mfma_f32_16x16x32_bf16 v[96:99], v[36:39], v[56:59], v[96:99]
    ds_read_b64_tr_b16 v[80:81], v142 offset:9344
    ds_read_b64_tr_b16 v[82:83], v142 offset:13952
    ds_read_b64_tr_b16 v[84:85], v142 offset:9472
    v_mfma_f32_16x16x32_bf16 v[116:119], v[40:43], v[56:59], v[116:119]
    ds_read_b64_tr_b16 v[86:87], v142 offset:14080
    v_mfma_f32_16x16x32_bf16 v[100:103], v[36:39], v[60:63], v[100:103]
    v_mfma_f32_16x16x32_bf16 v[120:123], v[40:43], v[60:63], v[120:123]
    v_mfma_f32_16x16x32_bf16 v[104:107], v[36:39], v[64:67], v[104:107]
    v_mfma_f32_16x16x32_bf16 v[124:127], v[40:43], v[64:67], v[124:127]
    s_waitcnt vmcnt(0)
    s_cmp_lg_u32 s8, 0
    s_cbranch_scc1 L_pa_cBkv1
    s_mov_b32 s21, 0
L_pa_wBkv1_spin:
    s_waitcnt vmcnt(0)
    v_cmp_eq_u32 vcc, s3, v232
    s_add_u32 s21, s21, 1
    s_cmp_eq_u64 vcc, -1
    s_cbranch_scc1 L_pa_wBkv1_ok
    s_sleep 2
    global_load_dword v232, v236, s[4:5] sc1
    s_cmp_lt_u32 s21, 0x40000
    s_cbranch_scc1 L_pa_wBkv1_spin
L_pa_wBkv1_ok:
L_pa_cBkv1:
    s_waitcnt lgkmcnt(0)
    s_barrier
    v_add_u32 v140, 0, v137
    v_add_u32 v141, 0, v138
    v_add_u32 v142, 0, v139
    v_mfma_f32_16x16x32_bf16 v[92:95], v[44:47], v[72:75], v[92:95]
    ds_read_b128 v[36:39], v140 offset:0
    ds_read_b128 v[40:43], v140 offset:2048
    ds_read_b64_tr_b16 v[52:53], v142 offset:64
    v_mfma_f32_16x16x32_bf16 v[112:115], v[48:51], v[72:75], v[112:115]
    ds_read_b64_tr_b16 v[54:55], v142 offset:4672
    ds_read_b64_tr_b16 v[56:57], v142 offset:96
    ds_read_b64_tr_b16 v[58:59], v142 offset:4704
    v_mfma_f32_16x16x32_bf16 v[96:99], v[44:47], v[76:79], v[96:99]
    ds_read_b64_tr_b16 v[60:61], v142 offset:128
    ds_read_b64_tr_b16 v[62:63], v142 offset:4736
    ds_read_b64_tr_b16 v[64:65], v142 offset:256
    s_mov_b32 s96, -1
    s_mov_b32 s98, -1
    s_cmp_eq_u32 s8, 3
    s_cselect_b32 s97, 0, -1
    s_cmp_eq_u32 s8, 7
    s_cselect_b32 s99, 0, -1
    v_lshlrev_b32 v237, 4, v1
    s_add_u32 m0, s29, 119808
    s_mov_b32 s52, s24
    buffer_load_dwordx4 v237, s[32:35], s52 offen sc1 lds
    v_mfma_f32_16x16x32_bf16 v[116:119], v[48:51], v[76:79], v[116:119]
    ds_read_b64_tr_b16 v[66:67], v142 offset:4864
    s_add_u32 m0, s30, 119808
    s_mov_b32 s52, s25
    v_mfma_f32_16x16x32_bf16 v[100:103], v[44:47], v[80:83], v[100:103]
    buffer_load_dwordx4 v237, s[32:35], s52 offen sc1 lds
    v_mfma_f32_16x16x32_bf16 v[120:123], v[48:51], v[80:83], v[120:123]
    s_add_u32 m0, s31, 119808
    s_mov_b32 s52, s26
    s_mov_b64 exec, s[96:97]
    buffer_load_dwordx4 v237, s[32:35], s52 offen sc1 lds
    s_mov_b64 exec, -1
    v_mfma_f32_16x16x32_bf16 v[104:107], v[44:47], v[84:87], v[104:107]
    v_mfma_f32_16x16x32_bf16 v[124:127], v[48:51], v[84:87], v[124:127]
    s_waitcnt lgkmcnt(0)
    v_mfma_f32_16x16x32_bf16 v[92:95], v[36:39], v[52:55], v[92:95]
    ds_read_b128 v[44:47], v141 offset:0
    ds_read_b128 v[48:51], v141 offset:2048
    ds_read_b64_tr_b16 v[72:73], v142 offset:9280
    v_mfma_f32_16x16x32_bf16 v[112:115], v[40:43], v[52:55], v[112:115]
    ds_read_b64_tr_b16 v[74:75], v142 offset:13888
    ds_read_b64_tr_b16 v[76:77], v142 offset:9312
    ds_read_b64_tr_b16 v[78:79], v142 offset:13920
    v_mfma_f32_16x16x32_bf16 v[96:99], v[36:39], v[56:59], v[96:99]
    ds_read_b64_tr_b16 v[80:81], v142 offset:9344
    ds_read_b64_tr_b16 v[82:83], v142 offset:13952
    ds_read_b64_tr_b16 v[84:85], v142 offset:9472
    s_add_u32 m0, s36, 119808
    s_mov_b32 s52, s27
    v_mfma_f32_16x16x32_bf16 v[116:119], v[40:43], v[56:59], v[116:119]
    ds_read_b64_tr_b16 v[86:87], v142 offset:14080
    buffer_load_dwordx4 v237, s[32:35], s52 offen sc1 lds
    v_mfma_f32_16x16x32_bf16 v[100:103], v[36:39], v[60:63], v[100:103]
    s_add_u32 m0, s37, 119808
    s_mov_b32 s52, s28
    s_mov_b64 exec, s[98:99]
    buffer_load_dwordx4 v237, s[32:35], s52 offen sc1 lds
    s_mov_b64 exec, -1
    v_mfma_f32_16x16x32_bf16 v[120:123], v[40:43], v[60:63], v[120:123]
    v_and_b32 v236, 31, v1
    s_lshl_b32 s16, s8, 5
    v_add_u32 v236, s16, v236
    v_lshlrev_b32 v236, 7, v236
    v_add_u32 v236, 0xd10000, v236
    s_mov_b32 exec_hi, 0
    global_load_dword v224, v236, s[4:5] sc1
    s_mov_b64 exec, -1
    v_mfma_f32_16x16x32_bf16 v[104:107], v[36:39], v[64:67], v[104:107]
    s_lshl_b32 s16, s11, 7
    s_add_u32 s16, s16, 0x4a9000
    v_and_b32 v236, 31, v1
    v_lshlrev_b32 v236, 2, v236
    v_add_u32 v236, s16, v236
    global_load_dword v228, v236, s[4:5] sc1
    v_mfma_f32_16x16x32_bf16 v[124:127], v[40:43], v[64:67], v[124:127]
    s_waitcnt lgkmcnt(0)
    v_mfma_f32_16x16x32_bf16 v[92:95], v[44:47], v[72:75], v[92:95]
    v_mfma_f32_16x16x32_bf16 v[112:115], v[48:51], v[72:75], v[112:115]
    v_mfma_f32_16x16x32_bf16 v[96:99], v[44:47], v[76:79], v[96:99]
    v_mfma_f32_16x16x32_bf16 v[116:119], v[48:51], v[76:79], v[116:119]
    v_mfma_f32_16x16x32_bf16 v[100:103], v[44:47], v[80:83], v[100:103]
    v_mfma_f32_16x16x32_bf16 v[120:123], v[48:51], v[80:83], v[120:123]
    v_mfma_f32_16x16x32_bf16 v[104:107], v[44:47], v[84:87], v[104:107]
    v_mfma_f32_16x16x32_bf16 v[124:127], v[48:51], v[84:87], v[124:127]
    s_mov_b32 s16, 0x3fb8aa3b
    s_mov_b32 s17, 0x358637bd
    v_cmp_gt_u32 s[74:75], 8, v2
    s_nop 4
    v_mul_f32 v20, s16, v92
    v_exp_f32_e64 v20, v20 clamp
    v_max_f32 v21, 0, v92
    v_add_f32 v21, s17, v21
    v_add_f32 v92, v21, v20
    v_mul_f32 v20, s16, v93
    v_exp_f32_e64 v20, v20 clamp
    v_max_f32 v21, 0, v93
    v_add_f32 v21, s17, v21
    v_add_f32 v93, v21, v20
    v_mul_f32 v20, s16, v94
    v_exp_f32_e64 v20, v20 clamp
    v_max_f32 v21, 0, v94
    v_add_f32 v21, s17, v21
    v_add_f32 v94, v21, v20
    v_mul_f32 v20, s16, v95
    v_exp_f32_e64 v20, v20 clamp
    v_max_f32 v21, 0, v95
    v_add_f32 v21, s17, v21
    v_add_f32 v95, v21, v20
    v_mul_f32 v20, s16, v112
    v_exp_f32_e64 v20, v20 clamp
    v_max_f32 v21, 0, v112
    v_add_f32 v21, s17, v21
    v_add_f32 v112, v21, v20
    v_mul_f32 v20, s16, v113
    v_exp_f32_e64 v20, v20 clamp
    v_max_f32 v21, 0, v113
    v_add_f32 v21, s17, v21
    v_add_f32 v113, v21, v20
    v_mul_f32 v20, s16, v114
    v_exp_f32_e64 v20, v20 clamp
    v_max_f32 v21, 0, v114
    v_add_f32 v21, s17, v21
    v_add_f32 v114, v21, v20
    v_mul_f32 v20, s16, v115
    v_exp_f32_e64 v20, v20 clamp
    v_max_f32 v21, 0, v115
    v_add_f32 v21, s17, v21
    v_add_f32 v115, v21, v20
    v_mul_f32 v20, s16, v96
    v_exp_f32_e64 v20, v20 clamp
    v_max_f32 v21, 0, v96
    v_add_f32 v21, s17, v21
    v_add_f32 v96, v21, v20
    v_mul_f32 v20, s16, v97
    v_exp_f32_e64 v20, v20 clamp
    v_max_f32 v21, 0, v97
    v_add_f32 v21, s17, v21
    v_add_f32 v97, v21, v20
    v_mul_f32 v20, s16, v98
    v_exp_f32_e64 v20, v20 clamp
    v_max_f32 v21, 0, v98
    v_add_f32 v21, s17, v21
    v_add_f32 v98, v21, v20
    v_mul_f32 v20, s16, v99
    v_exp_f32_e64 v20, v20 clamp
    v_max_f32 v21, 0, v99
    v_add_f32 v21, s17, v21
    v_add_f32 v99, v21, v20
    v_mul_f32 v20, s16, v116
    v_exp_f32_e64 v20, v20 clamp
    v_max_f32 v21, 0, v116
    v_add_f32 v21, s17, v21
    v_add_f32 v116, v21, v20
    v_mul_f32 v20, s16, v117
    v_exp_f32_e64 v20, v20 clamp
    v_max_f32 v21, 0, v117
    v_add_f32 v21, s17, v21
    v_add_f32 v117, v21, v20
    v_mul_f32 v20, s16, v118
    v_exp_f32_e64 v20, v20 clamp
    v_max_f32 v21, 0, v118
    v_add_f32 v21, s17, v21
    v_add_f32 v118, v21, v20
    v_mul_f32 v20, s16, v119
    v_exp_f32_e64 v20, v20 clamp
    v_max_f32 v21, 0, v119
    v_add_f32 v21, s17, v21
    v_add_f32 v119, v21, v20
    v_mul_f32 v20, s16, v100
    v_exp_f32_e64 v20, v20 clamp
    v_max_f32 v21, 0, v100
    v_add_f32 v21, s17, v21
    v_add_f32 v21, v21, v20
    v_cndmask_b32 v100, v100, v21, s[74:75]
    v_mul_f32 v20, s16, v101
    v_exp_f32_e64 v20, v20 clamp
    v_max_f32 v21, 0, v101
    v_add_f32 v21, s17, v21
    v_add_f32 v21, v21, v20
    v_cndmask_b32 v101, v101, v21, s[74:75]
    v_mul_f32 v20, s16, v102
    v_exp_f32_e64 v20, v20 clamp
    v_max_f32 v21, 0, v102
    v_add_f32 v21, s17, v21
    v_add_f32 v21, v21, v20
    v_cndmask_b32 v102, v102, v21, s[74:75]
    v_mul_f32 v20, s16, v103
    v_exp_f32_e64 v20, v20 clamp
    v_max_f32 v21, 0, v103
    v_add_f32 v21, s17, v21
    v_add_f32 v21, v21, v20
    v_cndmask_b32 v103, v103, v21, s[74:75]
    v_mul_f32 v20, s16, v120
    v_exp_f32_e64 v20, v20 clamp
    v_max_f32 v21, 0, v120
    v_add_f32 v21, s17, v21
    v_add_f32 v21, v21, v20
    v_cndmask_b32 v120, v120, v21, s[74:75]
    v_mul_f32 v20, s16, v121
    v_exp_f32_e64 v20, v20 clamp
    v_max_f32 v21, 0, v121
    v_add_f32 v21, s17, v21
    v_add_f32 v21, v21, v20
    v_cndmask_b32 v121, v121, v21, s[74:75]
    v_mul_f32 v20, s16, v122
    v_exp_f32_e64 v20, v20 clamp
    v_max_f32 v21, 0, v122
    v_add_f32 v21, s17, v21
    v_add_f32 v21, v21, v20
    v_cndmask_b32 v122, v122, v21, s[74:75]
    v_mul_f32 v20, s16, v123
    v_exp_f32_e64 v20, v20 clamp
    v_max_f32 v21, 0, v123
    v_add_f32 v21, s17, v21
    v_add_f32 v21, v21, v20
    v_cndmask_b32 v123, v123, v21, s[74:75]
    s_lshl_b32 s18, s14, 6
    s_add_u32 s18, s18, 73728
    v_mul_u32_u24 v20, 272, v2
    v_lshl_add_u32 v20, v3, 3, v20
    v_add_u32 v20, s18, v20
    s_barrier
    v_cvt_pk_bf16_f32 v92, v92, v93
    v_cvt_pk_bf16_f32 v93, v94, v95
    ds_write_b64 v20, v[92:93] offset:8704
    v_cvt_pk_bf16_f32 v112, v112, v113
    v_cvt_pk_bf16_f32 v113, v114, v115
    ds_write_b64 v20, v[112:113] offset:8736
    v_cvt_pk_bf16_f32 v96, v96, v97
    v_cvt_pk_bf16_f32 v97, v98, v99
    ds_write_b64 v20, v[96:97] offset:13056
    v_cvt_pk_bf16_f32 v116, v116, v117
    v_cvt_pk_bf16_f32 v117, v118, v119
    ds_write_b64 v20, v[116:117] offset:13088
    v_cvt_pk_bf16_f32 v100, v100, v101
    v_cvt_pk_bf16_f32 v101, v102, v103
    ds_write_b64 v20, v[100:101] offset:17408
    v_cvt_pk_bf16_f32 v120, v120, v121
    v_cvt_pk_bf16_f32 v121, v122, v123
    ds_write_b64 v20, v[120:121] offset:17440
    v_cvt_pk_bf16_f32 v104, v104, v105
    v_cvt_pk_bf16_f32 v105, v106, v107
    ds_write_b64 v20, v[104:105] offset:34816
    v_cvt_pk_bf16_f32 v124, v124, v125
    v_cvt_pk_bf16_f32 v125, v126, v127
    ds_write_b64 v20, v[124:125] offset:34848
    s_waitcnt lgkmcnt(0)
    s_barrier
L_B_kvblk:
    v_mul_u32_u24 v20, 272, v2
    v_lshl_add_u32 v20, v3, 4, v20
    v_add_u32 v20, 73728, v20
    v_mov_b32 v32, 0x3f803f80
    v_mov_b32 v33, 0x3f803f80
    v_mov_b32 v34, 0x3f803f80
    v_mov_b32 v35, 0x3f803f80
    s_mul_i32 s20, s69, 8
    s_add_u32 s20, s20, s70
    s_mul_i32 s20, s20, 20480
    s_add_u32 s20, s20, 0x4b0000
    v_lshlrev_b32 v23, 4, v1
    s_add_u32 s16, s8, 0
    s_mul_i32 s17, s16, 43
    s_lshr_b32 s17, s17, 7
    s_mul_i32 s18, s17, 3
    s_sub_u32 s18, s16, s18
    s_add_u32 s18, s18, s17
    s_add_u32 s18, s18, 3
    s_min_u32 s18, s18, 8
    s_sub_u32 s19, s16, 15
    s_cmp_ge_u32 s16, 15
    s_cselect_b32 s17, s19, s17
    s_mul_i32 s17, s17, 4352
    s_mul_i32 s18, s18, 4352
    v_add_u32 v21, s17, v20
    v_add_u32 v22, s18, v20
    ds_read_b128 v[36:39], v21 offset:0
    ds_read_b128 v[40:43], v21 offset:64
    ds_read_b128 v[44:47], v21 offset:128
    ds_read_b128 v[48:51], v21 offset:192
    s_cbranch_scc1 L_B_blk0_z
    ds_read_b128 v[52:55], v22 offset:0
    ds_read_b128 v[56:59], v22 offset:64
    ds_read_b128 v[60:63], v22 offset:128
    ds_read_b128 v[64:67], v22 offset:192
    s_waitcnt lgkmcnt(0)
    v_mfma_f32_16x16x32_bf16 v[68:71], v[36:39], v[52:55], 0
    v_mfma_f32_16x16x32_bf16 v[68:71], v[40:43], v[56:59], v[68:71]
    v_mfma_f32_16x16x32_bf16 v[68:71], v[44:47], v[60:63], v[68:71]
    v_mfma_f32_16x16x32_bf16 v[68:71], v[48:51], v[64:67], v[68:71]
    s_branch L_B_blk0_st
L_B_blk0_z:
    s_waitcnt lgkmcnt(0)
    v_mfma_f32_16x16x32_bf16 v[68:71], v[36:39], v[32:35], 0
    v_mfma_f32_16x16x32_bf16 v[68:71], v[40:43], v[32:35], v[68:71]
    v_mfma_f32_16x16x32_bf16 v[68:71], v[44:47], v[32:35], v[68:71]
    v_mfma_f32_16x16x32_bf16 v[68:71], v[48:51], v[32:35], v[68:71]
L_B_blk0_st:
    s_lshl_b32 s16, s16, 10
    s_add_u32 s16, s16, s20
    s_add_u32 s76, s4, s16
    s_addc_u32 s77, s5, 0
    s_nop 7
    global_store_dwordx4 v23, v[68:71], s[76:77] sc1
L_B_blk0_done:
    s_add_u32 s16, s8, 8
    s_mul_i32 s17, s16, 43
    s_lshr_b32 s17, s17, 7
    s_mul_i32 s18, s17, 3
    s_sub_u32 s18, s16, s18
    s_add_u32 s18, s18, s17
    s_add_u32 s18, s18, 3
    s_min_u32 s18, s18, 8
    s_sub_u32 s19, s16, 15
    s_cmp_ge_u32 s16, 15
    s_cselect_b32 s17, s19, s17
    s_mul_i32 s17, s17, 4352
    s_mul_i32 s18, s18, 4352
    v_add_u32 v21, s17, v20
    v_add_u32 v22, s18, v20
    ds_read_b128 v[36:39], v21 offset:0
    ds_read_b128 v[40:43], v21 offset:64
    ds_read_b128 v[44:47], v21 offset:128
    ds_read_b128 v[48:51], v21 offset:192
    s_cbranch_scc1 L_B_blk1_z
    ds_read_b128 v[52:55], v22 offset:0
    ds_read_b128 v[56:59], v22 offset:64
    ds_read_b128 v[60:63], v22 offset:128
    ds_read_b128 v[64:67], v22 offset:192
    s_waitcnt lgkmcnt(0)
    v_mfma_f32_16x16x32_bf16 v[72:75], v[36:39], v[52:55], 0
    v_mfma_f32_16x16x32_bf16 v[72:75], v[40:43], v[56:59], v[72:75]
    v_mfma_f32_16x16x32_bf16 v[72:75], v[44:47], v[60:63], v[72:75]
    v_mfma_f32_16x16x32_bf16 v[72:75], v[48:51], v[64:67], v[72:75]
    s_branch L_B_blk1_st
L_B_blk1_z:
    s_waitcnt lgkmcnt(0)
    v_mfma_f32_16x16x32_bf16 v[72:75], v[36:39], v[32:35], 0
    v_mfma_f32_16x16x32_bf16 v[72:75], v[40:43], v[32:35], v[72:75]
    v_mfma_f32_16x16x32_bf16 v[72:75], v[44:47], v[32:35], v[72:75]
    v_mfma_f32_16x16x32_bf16 v[72:75], v[48:51], v[32:35], v[72:75]
L_B_blk1_st:
    s_lshl_b32 s16, s16, 10
    s_add_u32 s16, s16, s20
    s_add_u32 s76, s4, s16
    s_addc_u32 s77, s5, 0
    s_nop 7
    global_store_dwordx4 v23, v[72:75], s[76:77] sc1
L_B_blk1_done:
    s_add_u32 s16, s8, 16
    s_cmp_ge_u32 s16, 20
    s_cbranch_scc1 L_B_blk2_done
    s_mul_i32 s17, s16, 43
    s_lshr_b32 s17, s17, 7
    s_mul_i32 s18, s17, 3
    s_sub_u32 s18, s16, s18
    s_add_u32 s18, s18, s17
    s_add_u32 s18, s18, 3
    s_min_u32 s18, s18, 8
    s_sub_u32 s19, s16, 15
    s_cmp_ge_u32 s16, 15
    s_cselect_b32 s17, s19, s17
    s_mul_i32 s17, s17, 4352
    s_mul_i32 s18, s18, 4352
    v_add_u32 v21, s17, v20
    v_add_u32 v22, s18, v20
    ds_read_b128 v[36:39], v21 offset:0
    ds_read_b128 v[40:43], v21 offset:64
    ds_read_b128 v[44:47], v21 offset:128
    ds_read_b128 v[48:51], v21 offset:192
    s_cbranch_scc1 L_B_blk2_z
    ds_read_b128 v[52:55], v22 offset:0
    ds_read_b128 v[56:59], v22 offset:64
    ds_read_b128 v[60:63], v22 offset:128
    ds_read_b128 v[64:67], v22 offset:192
    s_waitcnt lgkmcnt(0)
    v_mfma_f32_16x16x32_bf16 v[76:79], v[36:39], v[52:55], 0
    v_mfma_f32_16x16x32_bf16 v[76:79], v[40:43], v[56:59], v[76:79]
    v_mfma_f32_16x16x32_bf16 v[76:79], v[44:47], v[60:63], v[76:79]
    v_mfma_f32_16x16x32_bf16 v[76:79], v[48:51], v[64:67], v[76:79]
    s_branch L_B_blk2_st
L_B_blk2_z:
    s_waitcnt lgkmcnt(0)
    v_mfma_f32_16x16x32_bf16 v[76:79], v[36:39], v[32:35], 0
    v_mfma_f32_16x16x32_bf16 v[76:79], v[40:43], v[32:35], v[76:79]
    v_mfma_f32_16x16x32_bf16 v[76:79], v[44:47], v[32:35], v[76:79]
    v_mfma_f32_16x16x32_bf16 v[76:79], v[48:51], v[32:35], v[76:79]
L_B_blk2_st:
    s_lshl_b32 s16, s16, 10
    s_add_u32 s16, s16, s20
    s_add_u32 s76, s4, s16
    s_addc_u32 s77, s5, 0
    s_nop 7
    global_store_dwordx4 v23, v[76:79], s[76:77] sc1
L_B_blk2_done:
    s_and_b32 s16, s11, 0xfc
    s_add_u32 s16, s16, s12
    s_lshl_b32 s16, s16, 3
    s_lshl_b32 s17, s14, 1
    s_add_u32 s16, s16, s17
    v_and_b32 v238, 1, v1
    v_add_u32 v238, s16, v238
    v_lshlrev_b32 v238, 7, v238
    v_add_u32 v238, 0xf40000, v238
    global_load_dword v239, v238, s[4:5] sc1
    s_waitcnt vmcnt(3)
    s_branch L_B_done
L_f2_aq:
    s_cmp_eq_u32 s13, 0
    s_cbranch_scc0 L_A_q1
    s_waitcnt vmcnt(14)
    s_barrier
    v_add_u32 v140, 0, v137
    v_add_u32 v141, 0, v138
    v_add_u32 v142, 0, v139
    ds_read_b128 v[36:39], v140 offset:0
    ds_read_b128 v[40:43], v140 offset:2048
    ds_read_b64_tr_b16 v[52:53], v142 offset:0
    ds_read_b64_tr_b16 v[54:55], v142 offset:4608
    ds_read_b64_tr_b16 v[56:57], v142 offset:32
    ds_read_b64_tr_b16 v[58:59], v142 offset:4640
    ds_read_b64_tr_b16 v[60:61], v142 offset:160
    ds_read_b64_tr_b16 v[62:63], v142 offset:4768
    ds_read_b64_tr_b16 v[64:65], v142 offset:192
    ds_read_b64_tr_b16 v[66:67], v142 offset:4800
    ds_read_b64_tr_b16 v[68:69], v142 offset:224
    ds_read_b64_tr_b16 v[70:71], v142 offset:4832
    s_waitcnt lgkmcnt(0)
    v_mfma_f32_16x16x32_bf16 v[92:95], v[52:55], v[36:39], 0
    ds_read_b128 v[44:47], v141 offset:0
    ds_read_b128 v[48:51], v141 offset:2048
    ds_read_b64_tr_b16 v[72:73], v142 offset:9216
    v_mfma_f32_16x16x32_bf16 v[112:115], v[52:55], v[40:43], 0
    ds_read_b64_tr_b16 v[74:75], v142 offset:13824
    ds_read_b64_tr_b16 v[76:77], v142 offset:9248
    ds_read_b64_tr_b16 v[78:79], v142 offset:13856
    v_mfma_f32_16x16x32_bf16 v[96:99], v[56:59], v[36:39], 0
    ds_read_b64_tr_b16 v[80:81], v142 offset:9376
    ds_read_b64_tr_b16 v[82:83], v142 offset:13984
    ds_read_b64_tr_b16 v[84:85], v142 offset:9408
    s_add_u32 m0, s96, 104448
    v_mfma_f32_16x16x32_bf16 v[116:119], v[56:59], v[40:43], 0
    ds_read_b64_tr_b16 v[86:87], v142 offset:14016
    ds_read_b64_tr_b16 v[88:89], v142 offset:9440
    ds_read_b64_tr_b16 v[90:91], v142 offset:14048
    buffer_load_dwordx4 v134, s[44:47], s99 offen lds
    v_mfma_f32_16x16x32_bf16 v[100:103], v[60:63], v[36:39], 0
    s_add_u32 m0, s96, 105472
    v_mfma_f32_16x16x32_bf16 v[120:123], v[60:63], v[40:43], 0
    buffer_load_dwordx4 v135, s[44:47], s99 offen lds
    v_mfma_f32_16x16x32_bf16 v[104:107], v[64:67], v[36:39], 0
    s_add_u32 m0, s97, 120832
    v_mfma_f32_16x16x32_bf16 v[124:127], v[64:67], v[40:43], 0
    buffer_load_dwordx4 v136, s[48:51], s100 offen lds
    v_mfma_f32_16x16x32_bf16 v[108:111], v[68:71], v[36:39], 0
    s_add_u32 m0, s97, 121856
    v_mfma_f32_16x16x32_bf16 v[128:131], v[68:71], v[40:43], 0
    buffer_load_dwordx4 v143, s[48:51], s100 offen lds
    s_add_u32 m0, s98, 137216
    s_cmp_lt_u32 s8, 2
    s_cbranch_scc0 L_B_ex16
    buffer_load_dwordx4 v144, s[48:51], s100 offen lds
L_B_ex16:
    s_add_u32 s99, s99, 128
    s_add_u32 s100, s100, s101
    s_waitcnt vmcnt(14)
    s_waitcnt lgkmcnt(0)
    s_barrier
    v_add_u32 v140, 34816, v137
    v_add_u32 v141, 34816, v138
    v_add_u32 v142, 34816, v139
    v_mfma_f32_16x16x32_bf16 v[92:95], v[72:75], v[44:47], v[92:95]
    ds_read_b128 v[36:39], v140 offset:0
    ds_read_b128 v[40:43], v140 offset:2048
    ds_read_b64_tr_b16 v[52:53], v142 offset:0
    v_mfma_f32_16x16x32_bf16 v[112:115], v[72:75], v[48:51], v[112:115]
    ds_read_b64_tr_b16 v[54:55], v142 offset:4608
    ds_read_b64_tr_b16 v[56:57], v142 offset:32
    ds_read_b64_tr_b16 v[58:59], v142 offset:4640
    v_mfma_f32_16x16x32_bf16 v[96:99], v[76:79], v[44:47], v[96:99]
    ds_read_b64_tr_b16 v[60:61], v142 offset:160
    ds_read_b64_tr_b16 v[62:63], v142 offset:4768
    ds_read_b64_tr_b16 v[64:65], v142 offset:192
    s_add_u32 m0, s96, 0
    v_mfma_f32_16x16x32_bf16 v[116:119], v[76:79], v[48:51], v[116:119]
    ds_read_b64_tr_b16 v[66:67], v142 offset:4800
    ds_read_b64_tr_b16 v[68:69], v142 offset:224
    ds_read_b64_tr_b16 v[70:71], v142 offset:4832
    buffer_load_dwordx4 v134, s[44:47], s99 offen lds
    v_mfma_f32_16x16x32_bf16 v[100:103], v[80:83], v[44:47], v[100:103]
    s_add_u32 m0, s96, 1024
    v_mfma_f32_16x16x32_bf16 v[120:123], v[80:83], v[48:51], v[120:123]
    buffer_load_dwordx4 v135, s[44:47], s99 offen lds
    v_mfma_f32_16x16x32_bf16 v[104:107], v[84:87], v[44:47], v[104:107]
    s_add_u32 m0, s97, 16384
    v_mfma_f32_16x16x32_bf16 v[124:127], v[84:87], v[48:51], v[124:127]
    buffer_load_dwordx4 v136, s[48:51], s100 offen lds
    v_mfma_f32_16x16x32_bf16 v[108:111], v[88:91], v[44:47], v[108:111]
    v_mfma_f32_16x16x32_bf16 v[128:131], v[88:91], v[48:51], v[128:131]
    s_waitcnt lgkmcnt(0)
    v_mfma_f32_16x16x32_bf16 v[92:95], v[52:55], v[36:39], v[92:95]
    ds_read_b128 v[44:47], v141 offset:0
    ds_read_b128 v[48:51], v141 offset:2048
    ds_read_b64_tr_b16 v[72:73], v142 offset:9216
    v_mfma_f32_16x16x32_bf16 v[112:115], v[52:55], v[40:43], v[112:115]
    ds_read_b64_tr_b16 v[74:75], v142 offset:13824
    ds_read_b64_tr_b16 v[76:77], v142 offset:9248
    ds_read_b64_tr_b16 v[78:79], v142 offset:13856
    v_mfma_f32_16x16x32_bf16 v[96:99], v[56:59], v[36:39], v[96:99]
    ds_read_b64_tr_b16 v[80:81], v142 offset:9376
    ds_read_b64_tr_b16 v[82:83], v142 offset:13984
    ds_read_b64_tr_b16 v[84:85], v142 offset:9408
    s_add_u32 m0, s97, 17408
    v_mfma_f32_16x16x32_bf16 v[116:119], v[56:59], v[40:43], v[116:119]
    ds_read_b64_tr_b16 v[86:87], v142 offset:14016
    ds_read_b64_tr_b16 v[88:89], v142 offset:9440
    ds_read_b64_tr_b16 v[90:91], v142 offset:14048
    buffer_load_dwordx4 v143, s[48:51], s100 offen lds
    v_mfma_f32_16x16x32_bf16 v[100:103], v[60:63], v[36:39], v[100:103]
    s_add_u32 m0, s98, 32768
    s_cmp_lt_u32 s8, 2
    s_cbranch_scc0 L_B_ex17
    buffer_load_dwordx4 v144, s[48:51], s100 offen lds
L_B_ex17:
    s_add_u32 s99, s99, 128
    s_add_u32 s100, s100, s101
    v_mfma_f32_16x16x32_bf16 v[120:123], v[60:63], v[40:43], v[120:123]
    v_mfma_f32_16x16x32_bf16 v[104:107], v[64:67], v[36:39], v[104:107]
    v_mfma_f32_16x16x32_bf16 v[124:127], v[64:67], v[40:43], v[124:127]
    v_mfma_f32_16x16x32_bf16 v[108:111], v[68:71], v[36:39], v[108:111]
    v_mfma_f32_16x16x32_bf16 v[128:131], v[68:71], v[40:43], v[128:131]
    s_waitcnt vmcnt(14)
    s_waitcnt lgkmcnt(0)
    s_barrier
    v_mov_b32 v210, 0
    global_load_dword v211, v210, s[6:7] sc1
    v_add_u32 v140, 69632, v137
    v_add_u32 v141, 69632, v138
    v_add_u32 v142, 69632, v139
    v_mfma_f32_16x16x32_bf16 v[92:95], v[72:75], v[44:47], v[92:95]
    ds_read_b128 v[36:39], v140 offset:0
    ds_read_b128 v[40:43], v140 offset:2048
    ds_read_b64_tr_b16 v[52:53], v142 offset:0
    v_mfma_f32_16x16x32_bf16 v[112:115], v[72:75], v[48:51], v[112:115]
    ds_read_b64_tr_b16 v[54:55], v142 offset:4608
    ds_read_b64_tr_b16 v[56:57], v142 offset:32
    ds_read_b64_tr_b16 v[58:59], v142 offset:4640
    v_mfma_f32_16x16x32_bf16 v[96:99], v[76:79], v[44:47], v[96:99]
    ds_read_b64_tr_b16 v[60:61], v142 offset:160
    ds_read_b64_tr_b16 v[62:63], v142 offset:4768
    ds_read_b64_tr_b16 v[64:65], v142 offset:192
    s_add_u32 m0, s96, 34816
    v_mfma_f32_16x16x32_bf16 v[116:119], v[76:79], v[48:51], v[116:119]
    ds_read_b64_tr_b16 v[66:67], v142 offset:4800
    ds_read_b64_tr_b16 v[68:69], v142 offset:224
    ds_read_b64_tr_b16 v[70:71], v142 offset:4832
    buffer_load_dwordx4 v134, s[44:47], s99 offen lds
    v_mfma_f32_16x16x32_bf16 v[100:103], v[80:83], v[44:47], v[100:103]
    s_add_u32 m0, s96, 35840
    v_mfma_f32_16x16x32_bf16 v[120:123], v[80:83], v[48:51], v[120:123]
    buffer_load_dwordx4 v135, s[44:47], s99 offen lds
    v_mfma_f32_16x16x32_bf16 v[104:107], v[84:87], v[44:47], v[104:107]
    s_add_u32 m0, s97, 51200
    v_mfma_f32_16x16x32_bf16 v[124:127], v[84:87], v[48:51], v[124:127]
    buffer_load_dwordx4 v136, s[48:51], s100 offen lds
    v_mfma_f32_16x16x32_bf16 v[108:111], v[88:91], v[44:47], v[108:111]
    v_mfma_f32_16x16x32_bf16 v[128:131], v[88:91], v[48:51], v[128:131]
    s_waitcnt lgkmcnt(0)
    v_mfma_f32_16x16x32_bf16 v[92:95], v[52:55], v[36:39], v[92:95]
    ds_read_b128 v[44:47], v141 offset:0
    ds_read_b128 v[48:51], v141 offset:2048
    ds_read_b64_tr_b16 v[72:73], v142 offset:9216
    v_mfma_f32_16x16x32_bf16 v[112:115], v[52:55], v[40:43], v[112:115]
    ds_read_b64_tr_b16 v[74:75], v142 offset:13824
    ds_read_b64_tr_b16 v[76:77], v142 offset:9248
    ds_read_b64_tr_b16 v[78:79], v142 offset:13856
    v_mfma_f32_16x16x32_bf16 v[96:99], v[56:59], v[36:39], v[96:99]
    ds_read_b64_tr_b16 v[80:81], v142 offset:9376
    ds_read_b64_tr_b16 v[82:83], v142 offset:13984
    ds_read_b64_tr_b16 v[84:85], v142 offset:9408
    s_add_u32 m0, s97, 52224
    v_mfma_f32_16x16x32_bf16 v[116:119], v[56:59], v[40:43], v[116:119]
    ds_read_b64_tr_b16 v[86:87], v142 offset:14016
    ds_read_b64_tr_b16 v[88:89], v142 offset:9440
    ds_read_b64_tr_b16 v[90:91], v142 offset:14048
    buffer_load_dwordx4 v143, s[48:51], s100 offen lds
    v_mfma_f32_16x16x32_bf16 v[100:103], v[60:63], v[36:39], v[100:103]
    s_add_u32 m0, s98, 67584
    s_cmp_lt_u32 s8, 2
    s_cbranch_scc0 L_B_ex18
    buffer_load_dwordx4 v144, s[48:51], s100 offen lds
L_B_ex18:
    s_add_u32 s99, s99, 128
    s_add_u32 s100, s100, s101
    v_mfma_f32_16x16x32_bf16 v[120:123], v[60:63], v[40:43], v[120:123]
    v_mfma_f32_16x16x32_bf16 v[104:107], v[64:67], v[36:39], v[104:107]
    v_mfma_f32_16x16x32_bf16 v[124:127], v[64:67], v[40:43], v[124:127]
    v_mfma_f32_16x16x32_bf16 v[108:111], v[68:71], v[36:39], v[108:111]
    v_mfma_f32_16x16x32_bf16 v[128:131], v[68:71], v[40:43], v[128:131]
    s_waitcnt vmcnt(9)
    s_waitcnt lgkmcnt(0)
    s_barrier
    s_cmp_eq_u32 s60, 0
    s_cbranch_scc1 L_WF_post_end3
    v_lshrrev_b32 v20, 2, v2
    v_lshl_add_u32 v20, v3, 2, v20
    v_and_b32 v21, 3, v2
    v_lshlrev_b32 v21, 3, v21
    v_mul_u32_u24 v20, 288, v20
    v_add_u32 v20, v20, v21
    s_lshl_b32 s16, s8, 5
    s_add_u32 s16, s16, 139264
    v_add_u32 v20, s16, v20
    v_lshlrev_b32 v21, 4, v1
    ds_read_b64_tr_b16 v[28:29], v20
    ds_read_b64_tr_b16 v[30:31], v20 offset:4608
    ds_read_b64_tr_b16 v[32:33], v20 offset:256
    ds_read_b64_tr_b16 v[34:35], v20 offset:4864
    s_waitcnt lgkmcnt(0)
    global_store_dwordx4 v21, v[28:31], s[22:23] sc1
    s_cmp_lg_u32 s8, 0
    s_cbranch_scc1 L_WF_post_end3
    s_add_u32 s22, s22, 147456
    s_addc_u32 s23, s23, 0
    global_store_dwordx4 v21, v[32:35], s[22:23] sc1
L_WF_post_end3:
    v_and_b32 v4, 31, v1
    v_lshrrev_b32 v5, 5, v1
    v_lshlrev_b32 v6, 4, v1
    s_lshl_b32 s16, s14, 1
    s_lshl_b32 s54, s12, 3
    s_add_u32 s54, s54, s16
    s_add_u32 s55, s54, s13
    s_mov_b32 s64, -1
    s_mov_b32 s65, 0
    s_mov_b32 s66, 0x7ffff
    s_mov_b32 s67, 0x7ffff
    v_mov_b32 v242, -1
    v_mov_b32 v243, 0
    s_add_u32 s62, s4, 0x4b0000
    s_addc_u32 s63, s5, 0
    s_add_u32 s16, s8, 0
    s_lshl_b32 s24, s16, 10
    s_mov_b32 s29, s24
    s_cmp_ge_u32 s16, 20
    s_cselect_b32 s17, 59392, 0
    s_add_u32 s24, s24, s17
    s_cmp_ge_u32 s16, 20
    s_cselect_b32 s17, 4294966784, 0
    s_add_u32 s29, s29, s17
    s_add_u32 s16, s8, 8
    s_lshl_b32 s25, s16, 10
    s_mov_b32 s30, s25
    s_cmp_ge_u32 s16, 20
    s_cselect_b32 s17, 59392, 0
    s_add_u32 s25, s25, s17
    s_cmp_ge_u32 s16, 20
    s_cselect_b32 s17, 4294966784, 0
    s_add_u32 s30, s30, s17
    s_add_u32 s16, s8, 16
    s_lshl_b32 s26, s16, 10
    s_mov_b32 s31, s26
    s_cmp_ge_u32 s16, 20
    s_cselect_b32 s17, 59392, 0
    s_add_u32 s26, s26, s17
    s_cmp_ge_u32 s16, 20
    s_cselect_b32 s17, 4294966784, 0
    s_add_u32 s31, s31, s17
    s_add_u32 s16, s8, 24
    s_lshl_b32 s27, s16, 10
    s_mov_b32 s36, s27
    s_cmp_ge_u32 s16, 20
    s_cselect_b32 s17, 59392, 0
    s_add_u32 s27, s27, s17
    s_cmp_ge_u32 s16, 20
    s_cselect_b32 s17, 4294966784, 0
    s_add_u32 s36, s36, s17
    s_add_u32 s16, s8, 32
    s_lshl_b32 s28, s16, 10
    s_mov_b32 s37, s28
    s_cmp_ge_u32 s16, 20
    s_cselect_b32 s17, 59392, 0
    s_add_u32 s28, s28, s17
    s_cmp_ge_u32 s16, 20
    s_cselect_b32 s17, 4294966784, 0
    s_add_u32 s37, s37, s17
    s_add_u32 s16, s4, 0x480000
    s_addc_u32 s17, s5, 0
    s_mov_b32 s32, s16
    s_and_b32 s33, s17, 0xffff
    s_mov_b32 s34, 163840
    s_mov_b32 s35, 0x20000
    s_mul_i32 s16, s11, 73728
    s_add_u32 s16, s16, 0x890000
    s_lshr_b32 s17, s55, 1
    s_lshl_b32 s17, s17, 10
    s_and_b32 s18, s55, 1
    s_lshl_b32 s18, s18, 9
    s_add_u32 s17, s17, s18
    s_add_u32 s17, s17, s16
    s_add_u32 s56, s4, s17
    s_addc_u32 s57, s5, 0
    s_lshr_b32 s17, s55, 4
    s_add_u32 s17, s17, 16
    s_lshl_b32 s17, s17, 10
    s_lshr_b32 s18, s55, 2
    s_and_b32 s18, s18, 3
    s_lshl_b32 s18, s18, 8
    s_add_u32 s17, s17, s18
    s_and_b32 s18, s55, 3
    s_lshl_b32 s18, s18, 2
    s_add_u32 s17, s17, s18
    s_add_u32 s17, s17, s16
    s_add_u32 s58, s4, s17
    s_addc_u32 s59, s5, 0
    v_lshrrev_b32 v16, 4, v4
    v_mul_u32_u24 v16, 36864, v16
    v_and_b32 v7, 15, v4
    v_lshl_add_u32 v7, v7, 4, v16
    v_add_u32 v140, 104448, v137
    v_add_u32 v141, 104448, v138
    v_add_u32 v142, 104448, v139
    v_mfma_f32_16x16x32_bf16 v[92:95], v[72:75], v[44:47], v[92:95]
    ds_read_b128 v[36:39], v140 offset:0
    ds_read_b128 v[40:43], v140 offset:2048
    ds_read_b64_tr_b16 v[52:53], v142 offset:0
    v_mfma_f32_16x16x32_bf16 v[112:115], v[72:75], v[48:51], v[112:115]
    ds_read_b64_tr_b16 v[54:55], v142 offset:4608
    ds_read_b64_tr_b16 v[56:57], v142 offset:32
    ds_read_b64_tr_b16 v[58:59], v142 offset:4640
    v_mfma_f32_16x16x32_bf16 v[96:99], v[76:79], v[44:47], v[96:99]
    ds_read_b64_tr_b16 v[60:61], v142 offset:160
    ds_read_b64_tr_b16 v[62:63], v142 offset:4768
    ds_read_b64_tr_b16 v[64:65], v142 offset:192
    s_add_u32 m0, s96, 69632
    v_mfma_f32_16x16x32_bf16 v[116:119], v[76:79], v[48:51], v[116:119]
    ds_read_b64_tr_b16 v[66:67], v142 offset:4800
    ds_read_b64_tr_b16 v[68:69], v142 offset:224
    ds_read_b64_tr_b16 v[70:71], v142 offset:4832
    buffer_load_dwordx4 v134, s[44:47], s99 offen lds
    v_mfma_f32_16x16x32_bf16 v[100:103], v[80:83], v[44:47], v[100:103]
    s_add_u32 m0, s96, 70656
    v_mfma_f32_16x16x32_bf16 v[120:123], v[80:83], v[48:51], v[120:123]
    buffer_load_dwordx4 v135, s[44:47], s99 offen lds
    v_mfma_f32_16x16x32_bf16 v[104:107], v[84:87], v[44:47], v[104:107]
    s_add_u32 m0, s97, 86016
    v_mfma_f32_16x16x32_bf16 v[124:127], v[84:87], v[48:51], v[124:127]
    buffer_load_dwordx4 v136, s[48:51], s100 offen lds
    v_mfma_f32_16x16x32_bf16 v[108:111], v[88:91], v[44:47], v[108:111]
    v_mfma_f32_16x16x32_bf16 v[128:131], v[88:91], v[48:51], v[128:131]
    s_waitcnt lgkmcnt(0)
    v_mfma_f32_16x16x32_bf16 v[92:95], v[52:55], v[36:39], v[92:95]
    ds_read_b128 v[44:47], v141 offset:0
    ds_read_b128 v[48:51], v141 offset:2048
    ds_read_b64_tr_b16 v[72:73], v142 offset:9216
    v_mfma_f32_16x16x32_bf16 v[112:115], v[52:55], v[40:43], v[112:115]
    ds_read_b64_tr_b16 v[74:75], v142 offset:13824
    ds_read_b64_tr_b16 v[76:77], v142 offset:9248
    ds_read_b64_tr_b16 v[78:79], v142 offset:13856
    v_mfma_f32_16x16x32_bf16 v[96:99], v[56:59], v[36:39], v[96:99]
    ds_read_b64_tr_b16 v[80:81], v142 offset:9376
    ds_read_b64_tr_b16 v[82:83], v142 offset:13984
    ds_read_b64_tr_b16 v[84:85], v142 offset:9408
    s_add_u32 m0, s97, 87040
    v_mfma_f32_16x16x32_bf16 v[116:119], v[56:59], v[40:43], v[116:119]
    ds_read_b64_tr_b16 v[86:87], v142 offset:14016
    ds_read_b64_tr_b16 v[88:89], v142 offset:9440
    ds_read_b64_tr_b16 v[90:91], v142 offset:14048
    buffer_load_dwordx4 v143, s[48:51], s100 offen lds
    v_mfma_f32_16x16x32_bf16 v[100:103], v[60:63], v[36:39], v[100:103]
    s_add_u32 m0, s98, 102400
    s_cmp_lt_u32 s8, 2
    s_cbranch_scc0 L_B_ex19
    buffer_load_dwordx4 v144, s[48:51], s100 offen lds
L_B_ex19:
    s_add_u32 s99, s99, 128
    s_add_u32 s100, s100, s101
    v_mfma_f32_16x16x32_bf16 v[120:123], v[60:63], v[40:43], v[120:123]
    v_mfma_f32_16x16x32_bf16 v[104:107], v[64:67], v[36:39], v[104:107]
    v_mfma_f32_16x16x32_bf16 v[124:127], v[64:67], v[40:43], v[124:127]
    v_mfma_f32_16x16x32_bf16 v[108:111], v[68:71], v[36:39], v[108:111]
    v_mfma_f32_16x16x32_bf16 v[128:131], v[68:71], v[40:43], v[128:131]
    s_waitcnt vmcnt(9)
    s_waitcnt lgkmcnt(0)
    s_barrier
    v_add_u32 v140, 0, v137
    v_add_u32 v141, 0, v138
    v_add_u32 v142, 0, v139
    v_mfma_f32_16x16x32_bf16 v[92:95], v[72:75], v[44:47], v[92:95]
    ds_read_b128 v[36:39], v140 offset:0
    ds_read_b128 v[40:43], v140 offset:2048
    ds_read_b64_tr_b16 v[52:53], v142 offset:0
    v_mfma_f32_16x16x32_bf16 v[112:115], v[72:75], v[48:51], v[112:115]
    ds_read_b64_tr_b16 v[54:55], v142 offset:4608
    ds_read_b64_tr_b16 v[56:57], v142 offset:32
    ds_read_b64_tr_b16 v[58:59], v142 offset:4640
    v_mfma_f32_16x16x32_bf16 v[96:99], v[76:79], v[44:47], v[96:99]
    ds_read_b64_tr_b16 v[60:61], v142 offset:160
    ds_read_b64_tr_b16 v[62:63], v142 offset:4768
    ds_read_b64_tr_b16 v[64:65], v142 offset:192
    s_add_u32 m0, s96, 104448
    v_mfma_f32_16x16x32_bf16 v[116:119], v[76:79], v[48:51], v[116:119]
    ds_read_b64_tr_b16 v[66:67], v142 offset:4800
    ds_read_b64_tr_b16 v[68:69], v142 offset:224
    ds_read_b64_tr_b16 v[70:71], v142 offset:4832
    buffer_load_dwordx4 v134, s[44:47], s99 offen lds
    v_mfma_f32_16x16x32_bf16 v[100:103], v[80:83], v[44:47], v[100:103]
    s_add_u32 m0, s96, 105472
    v_mfma_f32_16x16x32_bf16 v[120:123], v[80:83], v[48:51], v[120:123]
    buffer_load_dwordx4 v135, s[44:47], s99 offen lds
    v_mfma_f32_16x16x32_bf16 v[104:107], v[84:87], v[44:47], v[104:107]
    s_add_u32 m0, s97, 120832
    v_mfma_f32_16x16x32_bf16 v[124:127], v[84:87], v[48:51], v[124:127]
    buffer_load_dwordx4 v136, s[48:51], s100 offen lds
    v_mfma_f32_16x16x32_bf16 v[108:111], v[88:91], v[44:47], v[108:111]
    v_mfma_f32_16x16x32_bf16 v[128:131], v[88:91], v[48:51], v[128:131]
    s_waitcnt lgkmcnt(0)
    v_mfma_f32_16x16x32_bf16 v[92:95], v[52:55], v[36:39], v[92:95]
    ds_read_b128 v[44:47], v141 offset:0
    ds_read_b128 v[48:51], v141 offset:2048
    ds_read_b64_tr_b16 v[72:73], v142 offset:9216
    v_mfma_f32_16x16x32_bf16 v[112:115], v[52:55], v[40:43], v[112:115]
    ds_read_b64_tr_b16 v[74:75], v142 offset:13824
    ds_read_b64_tr_b16 v[76:77], v142 offset:9248
    ds_read_b64_tr_b16 v[78:79], v142 offset:13856
    v_mfma_f32_16x16x32_bf16 v[96:99], v[56:59], v[36:39], v[96:99]
    ds_read_b64_tr_b16 v[80:81], v142 offset:9376
    ds_read_b64_tr_b16 v[82:83], v142 offset:13984
    ds_read_b64_tr_b16 v[84:85], v142 offset:9408
    s_add_u32 m0, s97, 121856
    v_mfma_f32_16x16x32_bf16 v[116:119], v[56:59], v[40:43], v[116:119]
    ds_read_b64_tr_b16 v[86:87], v142 offset:14016
    ds_read_b64_tr_b16 v[88:89], v142 offset:9440
    ds_read_b64_tr_b16 v[90:91], v142 offset:14048
    buffer_load_dwordx4 v143, s[48:51], s100 offen lds
    v_mfma_f32_16x16x32_bf16 v[100:103], v[60:63], v[36:39], v[100:103]
    s_add_u32 m0, s98, 137216
    s_cmp_lt_u32 s8, 2
    s_cbranch_scc0 L_B_ex20
    buffer_load_dwordx4 v144, s[48:51], s100 offen lds
L_B_ex20:
    s_add_u32 s99, s99, 128
    s_add_u32 s100, s100, s101
    v_mfma_f32_16x16x32_bf16 v[120:123], v[60:63], v[40:43], v[120:123]
    v_mfma_f32_16x16x32_bf16 v[104:107], v[64:67], v[36:39], v[104:107]
    v_mfma_f32_16x16x32_bf16 v[124:127], v[64:67], v[40:43], v[124:127]
    v_mfma_f32_16x16x32_bf16 v[108:111], v[68:71], v[36:39], v[108:111]
    v_mfma_f32_16x16x32_bf16 v[128:131], v[68:71], v[40:43], v[128:131]
    s_waitcnt vmcnt(8)
    s_waitcnt lgkmcnt(0)
    s_barrier
    v_add_u32 v140, 34816, v137
    v_add_u32 v141, 34816, v138
    v_add_u32 v142, 34816, v139
    v_mfma_f32_16x16x32_bf16 v[92:95], v[72:75], v[44:47], v[92:95]
    ds_read_b128 v[36:39], v140 offset:0
    ds_read_b128 v[40:43], v140 offset:2048
    ds_read_b64_tr_b16 v[52:53], v142 offset:0
    v_mfma_f32_16x16x32_bf16 v[112:115], v[72:75], v[48:51], v[112:115]
    ds_read_b64_tr_b16 v[54:55], v142 offset:4608
    ds_read_b64_tr_b16 v[56:57], v142 offset:32
    ds_read_b64_tr_b16 v[58:59], v142 offset:4640
    v_mfma_f32_16x16x32_bf16 v[96:99], v[76:79], v[44:47], v[96:99]
    ds_read_b64_tr_b16 v[60:61], v142 offset:160
    ds_read_b64_tr_b16 v[62:63], v142 offset:4768
    ds_read_b64_tr_b16 v[64:65], v142 offset:192
    s_add_u32 m0, s96, 0
    v_mfma_f32_16x16x32_bf16 v[116:119], v[76:79], v[48:51], v[116:119]
    ds_read_b64_tr_b16 v[66:67], v142 offset:4800
    ds_read_b64_tr_b16 v[68:69], v142 offset:224
    ds_read_b64_tr_b16 v[70:71], v142 offset:4832
    buffer_load_dwordx4 v134, s[44:47], s99 offen lds
    v_mfma_f32_16x16x32_bf16 v[100:103], v[80:83], v[44:47], v[100:103]
    s_add_u32 m0, s96, 1024
    v_mfma_f32_16x16x32_bf16 v[120:123], v[80:83], v[48:51], v[120:123]
    buffer_load_dwordx4 v135, s[44:47], s99 offen lds
    v_mfma_f32_16x16x32_bf16 v[104:107], v[84:87], v[44:47], v[104:107]
    s_add_u32 m0, s97, 16384
    v_mfma_f32_16x16x32_bf16 v[124:127], v[84:87], v[48:51], v[124:127]
    buffer_load_dwordx4 v136, s[48:51], s100 offen lds
    v_mfma_f32_16x16x32_bf16 v[108:111], v[88:91], v[44:47], v[108:111]
    v_mfma_f32_16x16x32_bf16 v[128:131], v[88:91], v[48:51], v[128:131]
    s_waitcnt lgkmcnt(0)
    v_mfma_f32_16x16x32_bf16 v[92:95], v[52:55], v[36:39], v[92:95]
    ds_read_b128 v[44:47], v141 offset:0
    ds_read_b128 v[48:51], v141 offset:2048
    ds_read_b64_tr_b16 v[72:73], v142 offset:9216
    v_mfma_f32_16x16x32_bf16 v[112:115], v[52:55], v[40:43], v[112:115]
    ds_read_b64_tr_b16 v[74:75], v142 offset:13824
    ds_read_b64_tr_b16 v[76:77], v142 offset:9248
    ds_read_b64_tr_b16 v[78:79], v142 offset:13856
    v_mfma_f32_16x16x32_bf16 v[96:99], v[56:59], v[36:39], v[96:99]
    ds_read_b64_tr_b16 v[80:81], v142 offset:9376
    ds_read_b64_tr_b16 v[82:83], v142 offset:13984
    ds_read_b64_tr_b16 v[84:85], v142 offset:9408
    s_add_u32 m0, s97, 17408
    v_mfma_f32_16x16x32_bf16 v[116:119], v[56:59], v[40:43], v[116:119]
    ds_read_b64_tr_b16 v[86:87], v142 offset:14016
    ds_read_b64_tr_b16 v[88:89], v142 offset:9440
    ds_read_b64_tr_b16 v[90:91], v142 offset:14048
    buffer_load_dwordx4 v143, s[48:51], s100 offen lds
    v_mfma_f32_16x16x32_bf16 v[100:103], v[60:63], v[36:39], v[100:103]
    s_add_u32 m0, s98, 32768
    s_cmp_lt_u32 s8, 2
    s_cbranch_scc0 L_B_ex21
    buffer_load_dwordx4 v144, s[48:51], s100 offen lds
L_B_ex21:
    s_add_u32 s99, s99, 128
    s_add_u32 s100, s100, s101
    v_mfma_f32_16x16x32_bf16 v[120:123], v[60:63], v[40:43], v[120:123]
    v_mfma_f32_16x16x32_bf16 v[104:107], v[64:67], v[36:39], v[104:107]
    v_mfma_f32_16x16x32_bf16 v[124:127], v[64:67], v[40:43], v[124:127]
    v_mfma_f32_16x16x32_bf16 v[108:111], v[68:71], v[36:39], v[108:111]
    v_mfma_f32_16x16x32_bf16 v[128:131], v[68:71], v[40:43], v[128:131]
    s_waitcnt vmcnt(8)
    s_waitcnt lgkmcnt(0)
    s_barrier
    s_mov_b32 s21, 0
L_non2:
    v_readfirstlane_b32 s3, v211
    s_add_u32 s21, s21, 1
    s_cmp_lg_u32 s3, 0
    s_cbranch_scc1 L_non2_ok
    s_sleep 8
    global_load_dword v211, v210, s[6:7] sc1
    s_waitcnt vmcnt(0)
    s_cmp_lt_u32 s21, 0x40000
    s_cbranch_scc1 L_non2
L_non2_ok:
    v_add_u32 v140, 69632, v137
    v_add_u32 v141, 69632, v138
    v_add_u32 v142, 69632, v139
    v_mfma_f32_16x16x32_bf16 v[92:95], v[72:75], v[44:47], v[92:95]
    ds_read_b128 v[36:39], v140 offset:0
    ds_read_b128 v[40:43], v140 offset:2048
    ds_read_b64_tr_b16 v[52:53], v142 offset:0
    v_mfma_f32_16x16x32_bf16 v[112:115], v[72:75], v[48:51], v[112:115]
    ds_read_b64_tr_b16 v[54:55], v142 offset:4608
    ds_read_b64_tr_b16 v[56:57], v142 offset:32
    ds_read_b64_tr_b16 v[58:59], v142 offset:4640
    v_mfma_f32_16x16x32_bf16 v[96:99], v[76:79], v[44:47], v[96:99]
    ds_read_b64_tr_b16 v[60:61], v142 offset:160
    ds_read_b64_tr_b16 v[62:63], v142 offset:4768
    ds_read_b64_tr_b16 v[64:65], v142 offset:192
    v_mfma_f32_16x16x32_bf16 v[116:119], v[76:79], v[48:51], v[116:119]
    ds_read_b64_tr_b16 v[66:67], v142 offset:4800
    ds_read_b64_tr_b16 v[68:69], v142 offset:224
    ds_read_b64_tr_b16 v[70:71], v142 offset:4832
    v_mfma_f32_16x16x32_bf16 v[100:103], v[80:83], v[44:47], v[100:103]
    v_mfma_f32_16x16x32_bf16 v[120:123], v[80:83], v[48:51], v[120:123]
    v_mfma_f32_16x16x32_bf16 v[104:107], v[84:87], v[44:47], v[104:107]
    v_mfma_f32_16x16x32_bf16 v[124:127], v[84:87], v[48:51], v[124:127]
    v_mfma_f32_16x16x32_bf16 v[108:111], v[88:91], v[44:47], v[108:111]
    v_mfma_f32_16x16x32_bf16 v[128:131], v[88:91], v[48:51], v[128:131]
    s_waitcnt lgkmcnt(0)
    v_mfma_f32_16x16x32_bf16 v[92:95], v[52:55], v[36:39], v[92:95]
    ds_read_b128 v[44:47], v141 offset:0
    ds_read_b128 v[48:51], v141 offset:2048
    ds_read_b64_tr_b16 v[72:73], v142 offset:9216
    v_mfma_f32_16x16x32_bf16 v[112:115], v[52:55], v[40:43], v[112:115]
    ds_read_b64_tr_b16 v[74:75], v142 offset:13824
    ds_read_b64_tr_b16 v[76:77], v142 offset:9248
    ds_read_b64_tr_b16 v[78:79], v142 offset:13856
    v_mfma_f32_16x16x32_bf16 v[96:99], v[56:59], v[36:39], v[96:99]
    ds_read_b64_tr_b16 v[80:81], v142 offset:9376
    ds_read_b64_tr_b16 v[82:83], v142 offset:13984
    ds_read_b64_tr_b16 v[84:85], v142 offset:9408
    v_mfma_f32_16x16x32_bf16 v[116:119], v[56:59], v[40:43], v[116:119]
    ds_read_b64_tr_b16 v[86:87], v142 offset:14016
    ds_read_b64_tr_b16 v[88:89], v142 offset:9440
    ds_read_b64_tr_b16 v[90:91], v142 offset:14048
    v_mfma_f32_16x16x32_bf16 v[100:103], v[60:63], v[36:39], v[100:103]
    v_mfma_f32_16x16x32_bf16 v[120:123], v[60:63], v[40:43], v[120:123]
    v_mfma_f32_16x16x32_bf16 v[104:107], v[64:67], v[36:39], v[104:107]
    v_mfma_f32_16x16x32_bf16 v[124:127], v[64:67], v[40:43], v[124:127]
    v_mfma_f32_16x16x32_bf16 v[108:111], v[68:71], v[36:39], v[108:111]
    v_mfma_f32_16x16x32_bf16 v[128:131], v[68:71], v[40:43], v[128:131]
    s_waitcnt vmcnt(4)
    s_waitcnt lgkmcnt(0)
    s_barrier
    v_add_u32 v140, 104448, v137
    v_add_u32 v141, 104448, v138
    v_add_u32 v142, 104448, v139
    v_mfma_f32_16x16x32_bf16 v[92:95], v[72:75], v[44:47], v[92:95]
    ds_read_b128 v[36:39], v140 offset:0
    ds_read_b128 v[40:43], v140 offset:2048
    ds_read_b64_tr_b16 v[52:53], v142 offset:0
    v_mfma_f32_16x16x32_bf16 v[112:115], v[72:75], v[48:51], v[112:115]
    ds_read_b64_tr_b16 v[54:55], v142 offset:4608
    ds_read_b64_tr_b16 v[56:57], v142 offset:32
    ds_read_b64_tr_b16 v[58:59], v142 offset:4640
    v_mfma_f32_16x16x32_bf16 v[96:99], v[76:79], v[44:47], v[96:99]
    ds_read_b64_tr_b16 v[60:61], v142 offset:160
    ds_read_b64_tr_b16 v[62:63], v142 offset:4768
    ds_read_b64_tr_b16 v[64:65], v142 offset:192
    v_mfma_f32_16x16x32_bf16 v[116:119], v[76:79], v[48:51], v[116:119]
    ds_read_b64_tr_b16 v[66:67], v142 offset:4800
    ds_read_b64_tr_b16 v[68:69], v142 offset:224
    ds_read_b64_tr_b16 v[70:71], v142 offset:4832
    v_mfma_f32_16x16x32_bf16 v[100:103], v[80:83], v[44:47], v[100:103]
    v_mfma_f32_16x16x32_bf16 v[120:123], v[80:83], v[48:51], v[120:123]
    v_mfma_f32_16x16x32_bf16 v[104:107], v[84:87], v[44:47], v[104:107]
    v_mfma_f32_16x16x32_bf16 v[124:127], v[84:87], v[48:51], v[124:127]
    v_mfma_f32_16x16x32_bf16 v[108:111], v[88:91], v[44:47], v[108:111]
    v_mfma_f32_16x16x32_bf16 v[128:131], v[88:91], v[48:51], v[128:131]
    s_waitcnt lgkmcnt(0)
    v_mfma_f32_16x16x32_bf16 v[92:95], v[52:55], v[36:39], v[92:95]
    ds_read_b128 v[44:47], v141 offset:0
    ds_read_b128 v[48:51], v141 offset:2048
    ds_read_b64_tr_b16 v[72:73], v142 offset:9216
    v_mfma_f32_16x16x32_bf16 v[112:115], v[52:55], v[40:43], v[112:115]
    ds_read_b64_tr_b16 v[74:75], v142 offset:13824
    ds_read_b64_tr_b16 v[76:77], v142 offset:9248
    ds_read_b64_tr_b16 v[78:79], v142 offset:13856
    v_mfma_f32_16x16x32_bf16 v[96:99], v[56:59], v[36:39], v[96:99]
    ds_read_b64_tr_b16 v[80:81], v142 offset:9376
    ds_read_b64_tr_b16 v[82:83], v142 offset:13984
    ds_read_b64_tr_b16 v[84:85], v142 offset:9408
    v_mfma_f32_16x16x32_bf16 v[116:119], v[56:59], v[40:43], v[116:119]
    ds_read_b64_tr_b16 v[86:87], v142 offset:14016
    ds_read_b64_tr_b16 v[88:89], v142 offset:9440
    ds_read_b64_tr_b16 v[90:91], v142 offset:14048
    v_mfma_f32_16x16x32_bf16 v[100:103], v[60:63], v[36:39], v[100:103]
    v_mfma_f32_16x16x32_bf16 v[120:123], v[60:63], v[40:43], v[120:123]
    v_mfma_f32_16x16x32_bf16 v[104:107], v[64:67], v[36:39], v[104:107]
    v_mfma_f32_16x16x32_bf16 v[124:127], v[64:67], v[40:43], v[124:127]
    v_mfma_f32_16x16x32_bf16 v[108:111], v[68:71], v[36:39], v[108:111]
    v_mfma_f32_16x16x32_bf16 v[128:131], v[68:71], v[40:43], v[128:131]
    s_waitcnt vmcnt(0)
    s_waitcnt lgkmcnt(0)
    s_barrier
    v_add_u32 v140, 0, v137
    v_add_u32 v141, 0, v138
    v_add_u32 v142, 0, v139
    v_mfma_f32_16x16x32_bf16 v[92:95], v[72:75], v[44:47], v[92:95]
    ds_read_b128 v[36:39], v140 offset:0
    ds_read_b128 v[40:43], v140 offset:2048
    ds_read_b64_tr_b16 v[52:53], v142 offset:0
    v_mfma_f32_16x16x32_bf16 v[112:115], v[72:75], v[48:51], v[112:115]
    ds_read_b64_tr_b16 v[54:55], v142 offset:4608
    ds_read_b64_tr_b16 v[56:57], v142 offset:32
    ds_read_b64_tr_b16 v[58:59], v142 offset:4640
    v_mfma_f32_16x16x32_bf16 v[96:99], v[76:79], v[44:47], v[96:99]
    ds_read_b64_tr_b16 v[60:61], v142 offset:160
    ds_read_b64_tr_b16 v[62:63], v142 offset:4768
    ds_read_b64_tr_b16 v[64:65], v142 offset:192
    v_mfma_f32_16x16x32_bf16 v[116:119], v[76:79], v[48:51], v[116:119]
    ds_read_b64_tr_b16 v[66:67], v142 offset:4800
    ds_read_b64_tr_b16 v[68:69], v142 offset:224
    ds_read_b64_tr_b16 v[70:71], v142 offset:4832
    v_mfma_f32_16x16x32_bf16 v[100:103], v[80:83], v[44:47], v[100:103]
    v_mfma_f32_16x16x32_bf16 v[120:123], v[80:83], v[48:51], v[120:123]
    v_mfma_f32_16x16x32_bf16 v[104:107], v[84:87], v[44:47], v[104:107]
    v_mfma_f32_16x16x32_bf16 v[124:127], v[84:87], v[48:51], v[124:127]
    v_mfma_f32_16x16x32_bf16 v[108:111], v[88:91], v[44:47], v[108:111]
    v_mfma_f32_16x16x32_bf16 v[128:131], v[88:91], v[48:51], v[128:131]
    s_waitcnt lgkmcnt(0)
    v_mfma_f32_16x16x32_bf16 v[92:95], v[52:55], v[36:39], v[92:95]
    ds_read_b128 v[44:47], v141 offset:0
    ds_read_b128 v[48:51], v141 offset:2048
    ds_read_b64_tr_b16 v[72:73], v142 offset:9216
    v_mfma_f32_16x16x32_bf16 v[112:115], v[52:55], v[40:43], v[112:115]
    ds_read_b64_tr_b16 v[74:75], v142 offset:13824
    ds_read_b64_tr_b16 v[76:77], v142 offset:9248
    ds_read_b64_tr_b16 v[78:79], v142 offset:13856
    v_mfma_f32_16x16x32_bf16 v[96:99], v[56:59], v[36:39], v[96:99]
    ds_read_b64_tr_b16 v[80:81], v142 offset:9376
    ds_read_b64_tr_b16 v[82:83], v142 offset:13984
    ds_read_b64_tr_b16 v[84:85], v142 offset:9408
    v_mfma_f32_16x16x32_bf16 v[116:119], v[56:59], v[40:43], v[116:119]
    ds_read_b64_tr_b16 v[86:87], v142 offset:14016
    ds_read_b64_tr_b16 v[88:89], v142 offset:9440
    ds_read_b64_tr_b16 v[90:91], v142 offset:14048
    v_mfma_f32_16x16x32_bf16 v[100:103], v[60:63], v[36:39], v[100:103]
    v_mfma_f32_16x16x32_bf16 v[120:123], v[60:63], v[40:43], v[120:123]
    v_mfma_f32_16x16x32_bf16 v[104:107], v[64:67], v[36:39], v[104:107]
    v_mfma_f32_16x16x32_bf16 v[124:127], v[64:67], v[40:43], v[124:127]
    v_mfma_f32_16x16x32_bf16 v[108:111], v[68:71], v[36:39], v[108:111]
    v_mfma_f32_16x16x32_bf16 v[128:131], v[68:71], v[40:43], v[128:131]
    s_waitcnt lgkmcnt(0)
    v_mfma_f32_16x16x32_bf16 v[92:95], v[72:75], v[44:47], v[92:95]
    v_mfma_f32_16x16x32_bf16 v[112:115], v[72:75], v[48:51], v[112:115]
    v_mfma_f32_16x16x32_bf16 v[96:99], v[76:79], v[44:47], v[96:99]
    v_mfma_f32_16x16x32_bf16 v[116:119], v[76:79], v[48:51], v[116:119]
    v_mfma_f32_16x16x32_bf16 v[100:103], v[80:83], v[44:47], v[100:103]
    v_mfma_f32_16x16x32_bf16 v[120:123], v[80:83], v[48:51], v[120:123]
    v_mfma_f32_16x16x32_bf16 v[104:107], v[84:87], v[44:47], v[104:107]
    v_mfma_f32_16x16x32_bf16 v[124:127], v[84:87], v[48:51], v[124:127]
    v_mfma_f32_16x16x32_bf16 v[108:111], v[88:91], v[44:47], v[108:111]
    v_mfma_f32_16x16x32_bf16 v[128:131], v[88:91], v[48:51], v[128:131]
    s_lshl_b32 s16, s14, 5
    v_add_u32 v20, s16, v2
    v_mul_u32_u24 v20, 296, v20
    v_lshl_add_u32 v20, v3, 3, v20
    v_add_u32 v20, 73728, v20
    s_barrier
    s_mov_b32 s16, 0x3eae1a93
    v_mul_f32 v92, s16, v92
    v_mul_f32 v93, s16, v93
    v_mul_f32 v94, s16, v94
    v_mul_f32 v95, s16, v95
    v_cvt_pk_bf16_f32 v92, v92, v93
    v_cvt_pk_bf16_f32 v93, v94, v95
    ds_write_b64 v20, v[92:93] offset:0
    v_mul_f32 v112, s16, v112
    v_mul_f32 v113, s16, v113
    v_mul_f32 v114, s16, v114
    v_mul_f32 v115, s16, v115
    v_cvt_pk_bf16_f32 v112, v112, v113
    v_cvt_pk_bf16_f32 v113, v114, v115
    ds_write_b64 v20, v[112:113] offset:4736
    v_mul_f32 v96, s16, v96
    v_mul_f32 v97, s16, v97
    v_mul_f32 v98, s16, v98
    v_mul_f32 v99, s16, v99
    v_cvt_pk_bf16_f32 v96, v96, v97
    v_cvt_pk_bf16_f32 v97, v98, v99
    ds_write_b64 v20, v[96:97] offset:32
    v_mul_f32 v116, s16, v116
    v_mul_f32 v117, s16, v117
    v_mul_f32 v118, s16, v118
    v_mul_f32 v119, s16, v119
    v_cvt_pk_bf16_f32 v116, v116, v117
    v_cvt_pk_bf16_f32 v117, v118, v119
    ds_write_b64 v20, v[116:117] offset:4768
    v_mul_f32 v100, s16, v100
    v_mul_f32 v101, s16, v101
    v_mul_f32 v102, s16, v102
    v_mul_f32 v103, s16, v103
    v_cvt_pk_bf16_f32 v100, v100, v101
    v_cvt_pk_bf16_f32 v101, v102, v103
    ds_write_b64 v20, v[100:101] offset:160
    v_mul_f32 v120, s16, v120
    v_mul_f32 v121, s16, v121
    v_mul_f32 v122, s16, v122
    v_mul_f32 v123, s16, v123
    v_cvt_pk_bf16_f32 v120, v120, v121
    v_cvt_pk_bf16_f32 v121, v122, v123
    ds_write_b64 v20, v[120:121] offset:4896
    v_mul_f32 v104, s16, v104
    v_mul_f32 v105, s16, v105
    v_mul_f32 v106, s16, v106
    v_mul_f32 v107, s16, v107
    v_cvt_pk_bf16_f32 v104, v104, v105
    v_cvt_pk_bf16_f32 v105, v106, v107
    ds_write_b64 v20, v[104:105] offset:192
    v_mul_f32 v124, s16, v124
    v_mul_f32 v125, s16, v125
    v_mul_f32 v126, s16, v126
    v_mul_f32 v127, s16, v127
    v_cvt_pk_bf16_f32 v124, v124, v125
    v_cvt_pk_bf16_f32 v125, v126, v127
    ds_write_b64 v20, v[124:125] offset:4928
    v_mul_f32 v108, s16, v108
    v_mul_f32 v109, s16, v109
    v_mul_f32 v110, s16, v110
    v_mul_f32 v111, s16, v111
    v_cvt_pk_bf16_f32 v108, v108, v109
    v_cvt_pk_bf16_f32 v109, v110, v111
    ds_write_b64 v20, v[108:109] offset:224
    v_mul_f32 v128, s16, v128
    v_mul_f32 v129, s16, v129
    v_mul_f32 v130, s16, v130
    v_mul_f32 v131, s16, v131
    v_cvt_pk_bf16_f32 v128, v128, v129
    v_cvt_pk_bf16_f32 v129, v130, v131
    ds_write_b64 v20, v[128:129] offset:4960
    s_mul_i32 s16, s8, 36
    s_add_u32 s16, s16, 73728
    v_and_b32 v21, 31, v1
    v_mul_u32_u24 v22, 296, v21
    v_add_u32 v22, s16, v22
    v_lshrrev_b32 v23, 5, v1
    v_lshl_add_u32 v24, v23, 4, v22
    v_mul_u32_u24 v25, 9472, v23
    v_add_u32 v25, v25, v22
    v_lshlrev_b32 v26, 4, v1
    v_mul_u32_u24 v27, 36864, v23
    v_lshl_add_u32 v27, v21, 2, v27
    s_lshl_b32 s16, s69, 7
    s_lshl_b32 s17, s70, 3
    s_add_u32 s16, s16, s17
    s_add_u32 s16, s16, s8
    s_mul_i32 s16, s16, 1152
    s_add_u32 s16, s16, 0x0
    s_add_u32 s76, s4, s16
    s_addc_u32 s77, s5, 0
    s_waitcnt lgkmcnt(0)
    s_barrier
    v_add_u32 v28, 0, v24
    ds_read2_b32 v[36:37], v28 offset0:0 offset1:1
    ds_read2_b32 v[38:39], v28 offset0:2 offset1:3
    v_add_u32 v28, 9472, v24
    ds_read2_b32 v[40:41], v28 offset0:0 offset1:1
    ds_read2_b32 v[42:43], v28 offset0:2 offset1:3
    v_add_u32 v28, 18944, v24
    ds_read2_b32 v[44:45], v28 offset0:0 offset1:1
    ds_read2_b32 v[46:47], v28 offset0:2 offset1:3
    v_add_u32 v28, 28416, v24
    ds_read2_b32 v[48:49], v28 offset0:0 offset1:1
    ds_read2_b32 v[50:51], v28 offset0:2 offset1:3
    ds_read_b32 v52, v25 offset:32
    ds_read_b32 v53, v25 offset:18976
    s_waitcnt lgkmcnt(0)
    global_store_dwordx4 v26, v[36:39], s[76:77] sc1
    s_add_u32 s76, s76, 36864
    s_addc_u32 s77, s77, 0
    global_store_dwordx4 v26, v[40:43], s[76:77] sc1
    s_add_u32 s76, s76, 36864
    s_addc_u32 s77, s77, 0
    global_store_dwordx4 v26, v[44:47], s[76:77] sc1
    s_add_u32 s76, s76, 36864
    s_addc_u32 s77, s77, 0
    global_store_dwordx4 v26, v[48:51], s[76:77] sc1
    s_add_u32 s76, s76, 36864
    s_addc_u32 s77, s77, 0
    s_sub_u32 s76, s76, 147456
    s_subb_u32 s77, s77, 0
    global_store_dword v27, v52, s[76:77] offset:1024 sc1
    s_add_u32 s76, s76, 73728
    s_addc_u32 s77, s77, 0
    global_store_dword v27, v53, s[76:77] offset:1024 sc1
    s_branch L_A_qj
L_A_q1:
    s_waitcnt vmcnt(14)
    s_barrier
    v_add_u32 v140, 0, v137
    v_add_u32 v141, 0, v138
    v_add_u32 v142, 0, v139
    ds_read_b128 v[36:39], v140 offset:0
    ds_read_b128 v[40:43], v140 offset:2048
    ds_read_b64_tr_b16 v[52:53], v142 offset:64
    ds_read_b64_tr_b16 v[54:55], v142 offset:4672
    ds_read_b64_tr_b16 v[56:57], v142 offset:96
    ds_read_b64_tr_b16 v[58:59], v142 offset:4704
    ds_read_b64_tr_b16 v[60:61], v142 offset:128
    ds_read_b64_tr_b16 v[62:63], v142 offset:4736
    ds_read_b64_tr_b16 v[64:65], v142 offset:256
    ds_read_b64_tr_b16 v[66:67], v142 offset:4864
    s_waitcnt lgkmcnt(0)
    v_mfma_f32_16x16x32_bf16 v[92:95], v[52:55], v[36:39], 0
    ds_read_b128 v[44:47], v141 offset:0
    ds_read_b128 v[48:51], v141 offset:2048
    ds_read_b64_tr_b16 v[72:73], v142 offset:9280
    v_mfma_f32_16x16x32_bf16 v[112:115], v[52:55], v[40:43], 0
    ds_read_b64_tr_b16 v[74:75], v142 offset:13888
    ds_read_b64_tr_b16 v[76:77], v142 offset:9312
    ds_read_b64_tr_b16 v[78:79], v142 offset:13920
    v_mfma_f32_16x16x32_bf16 v[96:99], v[56:59], v[36:39], 0
    ds_read_b64_tr_b16 v[80:81], v142 offset:9344
    ds_read_b64_tr_b16 v[82:83], v142 offset:13952
    ds_read_b64_tr_b16 v[84:85], v142 offset:9472
    s_add_u32 m0, s96, 104448
    v_mfma_f32_16x16x32_bf16 v[116:119], v[56:59], v[40:43], 0
    ds_read_b64_tr_b16 v[86:87], v142 offset:14080
    buffer_load_dwordx4 v134, s[44:47], s99 offen lds
    v_mfma_f32_16x16x32_bf16 v[100:103], v[60:63], v[36:39], 0
    s_add_u32 m0, s96, 105472
    v_mfma_f32_16x16x32_bf16 v[120:123], v[60:63], v[40:43], 0
    buffer_load_dwordx4 v135, s[44:47], s99 offen lds
    v_mfma_f32_16x16x32_bf16 v[104:107], v[64:67], v[36:39], 0
    s_add_u32 m0, s97, 120832
    v_mfma_f32_16x16x32_bf16 v[124:127], v[64:67], v[40:43], 0
    buffer_load_dwordx4 v136, s[48:51], s100 offen lds
    s_add_u32 m0, s97, 121856
    s_nop 0
    buffer_load_dwordx4 v143, s[48:51], s100 offen lds
    s_add_u32 m0, s98, 137216
    s_cmp_lt_u32 s8, 2
    s_cbranch_scc0 L_B_ex22
    buffer_load_dwordx4 v144, s[48:51], s100 offen lds
L_B_ex22:
    s_add_u32 s99, s99, 128
    s_add_u32 s100, s100, s101
    s_waitcnt vmcnt(14)
    s_waitcnt lgkmcnt(0)
    s_barrier
    v_add_u32 v140, 34816, v137
    v_add_u32 v141, 34816, v138
    v_add_u32 v142, 34816, v139
    v_mfma_f32_16x16x32_bf16 v[92:95], v[72:75], v[44:47], v[92:95]
    ds_read_b128 v[36:39], v140 offset:0
    ds_read_b128 v[40:43], v140 offset:2048
    ds_read_b64_tr_b16 v[52:53], v142 offset:64
    v_mfma_f32_16x16x32_bf16 v[112:115], v[72:75], v[48:51], v[112:115]
    ds_read_b64_tr_b16 v[54:55], v142 offset:4672
    ds_read_b64_tr_b16 v[56:57], v142 offset:96
    ds_read_b64_tr_b16 v[58:59], v142 offset:4704
    v_mfma_f32_16x16x32_bf16 v[96:99], v[76:79], v[44:47], v[96:99]
    ds_read_b64_tr_b16 v[60:61], v142 offset:128
    ds_read_b64_tr_b16 v[62:63], v142 offset:4736
    ds_read_b64_tr_b16 v[64:65], v142 offset:256
    s_add_u32 m0, s96, 0
    v_mfma_f32_16x16x32_bf16 v[116:119], v[76:79], v[48:51], v[116:119]
    ds_read_b64_tr_b16 v[66:67], v142 offset:4864
    buffer_load_dwordx4 v134, s[44:47], s99 offen lds
    v_mfma_f32_16x16x32_bf16 v[100:103], v[80:83], v[44:47], v[100:103]
    s_add_u32 m0, s96, 1024
    v_mfma_f32_16x16x32_bf16 v[120:123], v[80:83], v[48:51], v[120:123]
    buffer_load_dwordx4 v135, s[44:47], s99 offen lds
    v_mfma_f32_16x16x32_bf16 v[104:107], v[84:87], v[44:47], v[104:107]
    s_add_u32 m0, s97, 16384
    v_mfma_f32_16x16x32_bf16 v[124:127], v[84:87], v[48:51], v[124:127]
    buffer_load_dwordx4 v136, s[48:51], s100 offen lds
    s_waitcnt lgkmcnt(0)
    v_mfma_f32_16x16x32_bf16 v[92:95], v[52:55], v[36:39], v[92:95]
    ds_read_b128 v[44:47], v141 offset:0
    ds_read_b128 v[48:51], v141 offset:2048
    ds_read_b64_tr_b16 v[72:73], v142 offset:9280
    v_mfma_f32_16x16x32_bf16 v[112:115], v[52:55], v[40:43], v[112:115]
    ds_read_b64_tr_b16 v[74:75], v142 offset:13888
    ds_read_b64_tr_b16 v[76:77], v142 offset:9312
    ds_read_b64_tr_b16 v[78:79], v142 offset:13920
    v_mfma_f32_16x16x32_bf16 v[96:99], v[56:59], v[36:39], v[96:99]
    ds_read_b64_tr_b16 v[80:81], v142 offset:9344
    ds_read_b64_tr_b16 v[82:83], v142 offset:13952
    ds_read_b64_tr_b16 v[84:85], v142 offset:9472
    s_add_u32 m0, s97, 17408
    v_mfma_f32_16x16x32_bf16 v[116:119], v[56:59], v[40:43], v[116:119]
    ds_read_b64_tr_b16 v[86:87], v142 offset:14080
    buffer_load_dwordx4 v143, s[48:51], s100 offen lds
    v_mfma_f32_16x16x32_bf16 v[100:103], v[60:63], v[36:39], v[100:103]
    s_add_u32 m0, s98, 32768
    s_cmp_lt_u32 s8, 2
    s_cbranch_scc0 L_B_ex23
    buffer_load_dwordx4 v144, s[48:51], s100 offen lds
L_B_ex23:
    s_add_u32 s99, s99, 128
    s_add_u32 s100, s100, s101
    v_mfma_f32_16x16x32_bf16 v[120:123], v[60:63], v[40:43], v[120:123]
    v_mfma_f32_16x16x32_bf16 v[104:107], v[64:67], v[36:39], v[104:107]
    v_mfma_f32_16x16x32_bf16 v[124:127], v[64:67], v[40:43], v[124:127]
    s_waitcnt vmcnt(14)
    s_waitcnt lgkmcnt(0)
    s_barrier
    v_mov_b32 v210, 0
    global_load_dword v211, v210, s[6:7] sc1
    v_add_u32 v140, 69632, v137
    v_add_u32 v141, 69632, v138
    v_add_u32 v142, 69632, v139
    v_mfma_f32_16x16x32_bf16 v[92:95], v[72:75], v[44:47], v[92:95]
    ds_read_b128 v[36:39], v140 offset:0
    ds_read_b128 v[40:43], v140 offset:2048
    ds_read_b64_tr_b16 v[52:53], v142 offset:64
    v_mfma_f32_16x16x32_bf16 v[112:115], v[72:75], v[48:51], v[112:115]
    ds_read_b64_tr_b16 v[54:55], v142 offset:4672
    ds_read_b64_tr_b16 v[56:57], v142 offset:96
    ds_read_b64_tr_b16 v[58:59], v142 offset:4704
    v_mfma_f32_16x16x32_bf16 v[96:99], v[76:79], v[44:47], v[96:99]
    ds_read_b64_tr_b16 v[60:61], v142 offset:128
    ds_read_b64_tr_b16 v[62:63], v142 offset:4736
    ds_read_b64_tr_b16 v[64:65], v142 offset:256
    s_add_u32 m0, s96, 34816
    v_mfma_f32_16x16x32_bf16 v[116:119], v[76:79], v[48:51], v[116:119]
    ds_read_b64_tr_b16 v[66:67], v142 offset:4864
    buffer_load_dwordx4 v134, s[44:47], s99 offen lds
    v_mfma_f32_16x16x32_bf16 v[100:103], v[80:83], v[44:47], v[100:103]
    s_add_u32 m0, s96, 35840
    v_mfma_f32_16x16x32_bf16 v[120:123], v[80:83], v[48:51], v[120:123]
    buffer_load_dwordx4 v135, s[44:47], s99 offen lds
    v_mfma_f32_16x16x32_bf16 v[104:107], v[84:87], v[44:47], v[104:107]
    s_add_u32 m0, s97, 51200
    v_mfma_f32_16x16x32_bf16 v[124:127], v[84:87], v[48:51], v[124:127]
    buffer_load_dwordx4 v136, s[48:51], s100 offen lds
    s_waitcnt lgkmcnt(0)
    v_mfma_f32_16x16x32_bf16 v[92:95], v[52:55], v[36:39], v[92:95]
    ds_read_b128 v[44:47], v141 offset:0
    ds_read_b128 v[48:51], v141 offset:2048
    ds_read_b64_tr_b16 v[72:73], v142 offset:9280
    v_mfma_f32_16x16x32_bf16 v[112:115], v[52:55], v[40:43], v[112:115]
    ds_read_b64_tr_b16 v[74:75], v142 offset:13888
    ds_read_b64_tr_b16 v[76:77], v142 offset:9312
    ds_read_b64_tr_b16 v[78:79], v142 offset:13920
    v_mfma_f32_16x16x32_bf16 v[96:99], v[56:59], v[36:39], v[96:99]
    ds_read_b64_tr_b16 v[80:81], v142 offset:9344
    ds_read_b64_tr_b16 v[82:83], v142 offset:13952
    ds_read_b64_tr_b16 v[84:85], v142 offset:9472
    s_add_u32 m0, s97, 52224
    v_mfma_f32_16x16x32_bf16 v[116:119], v[56:59], v[40:43], v[116:119]
    ds_read_b64_tr_b16 v[86:87], v142 offset:14080
    buffer_load_dwordx4 v143, s[48:51], s100 offen lds
    v_mfma_f32_16x16x32_bf16 v[100:103], v[60:63], v[36:39], v[100:103]
    s_add_u32 m0, s98, 67584
    s_cmp_lt_u32 s8, 2
    s_cbranch_scc0 L_B_ex24
    buffer_load_dwordx4 v144, s[48:51], s100 offen lds
L_B_ex24:
    s_add_u32 s99, s99, 128
    s_add_u32 s100, s100, s101
    v_mfma_f32_16x16x32_bf16 v[120:123], v[60:63], v[40:43], v[120:123]
    v_mfma_f32_16x16x32_bf16 v[104:107], v[64:67], v[36:39], v[104:107]
    v_mfma_f32_16x16x32_bf16 v[124:127], v[64:67], v[40:43], v[124:127]
    s_waitcnt vmcnt(9)
    s_waitcnt lgkmcnt(0)
    s_barrier
    s_cmp_eq_u32 s60, 0
    s_cbranch_scc1 L_WF_post_end4
    v_lshrrev_b32 v20, 2, v2
    v_lshl_add_u32 v20, v3, 2, v20
    v_and_b32 v21, 3, v2
    v_lshlrev_b32 v21, 3, v21
    v_mul_u32_u24 v20, 288, v20
    v_add_u32 v20, v20, v21
    s_lshl_b32 s16, s8, 5
    s_add_u32 s16, s16, 139264
    v_add_u32 v20, s16, v20
    v_lshlrev_b32 v21, 4, v1
    ds_read_b64_tr_b16 v[28:29], v20
    ds_read_b64_tr_b16 v[30:31], v20 offset:4608
    ds_read_b64_tr_b16 v[32:33], v20 offset:256
    ds_read_b64_tr_b16 v[34:35], v20 offset:4864
    s_waitcnt lgkmcnt(0)
    global_store_dwordx4 v21, v[28:31], s[22:23] sc1
    s_cmp_lg_u32 s8, 0
    s_cbranch_scc1 L_WF_post_end4
    s_add_u32 s22, s22, 147456
    s_addc_u32 s23, s23, 0
    global_store_dwordx4 v21, v[32:35], s[22:23] sc1
L_WF_post_end4:
    v_and_b32 v4, 31, v1
    v_lshrrev_b32 v5, 5, v1
    v_lshlrev_b32 v6, 4, v1
    s_lshl_b32 s16, s14, 1
    s_lshl_b32 s54, s12, 3
    s_add_u32 s54, s54, s16
    s_add_u32 s55, s54, s13
    s_mov_b32 s64, -1
    s_mov_b32 s65, 0
    s_mov_b32 s66, 0x7ffff
    s_mov_b32 s67, 0x7ffff
    v_mov_b32 v242, -1
    v_mov_b32 v243, 0
    s_add_u32 s62, s4, 0x4b0000
    s_addc_u32 s63, s5, 0
    s_add_u32 s16, s8, 0
    s_lshl_b32 s24, s16, 10
    s_mov_b32 s29, s24
    s_cmp_ge_u32 s16, 20
    s_cselect_b32 s17, 59392, 0
    s_add_u32 s24, s24, s17
    s_cmp_ge_u32 s16, 20
    s_cselect_b32 s17, 4294966784, 0
    s_add_u32 s29, s29, s17
    s_add_u32 s16, s8, 8
    s_lshl_b32 s25, s16, 10
    s_mov_b32 s30, s25
    s_cmp_ge_u32 s16, 20
    s_cselect_b32 s17, 59392, 0
    s_add_u32 s25, s25, s17
    s_cmp_ge_u32 s16, 20
    s_cselect_b32 s17, 4294966784, 0
    s_add_u32 s30, s30, s17
    s_add_u32 s16, s8, 16
    s_lshl_b32 s26, s16, 10
    s_mov_b32 s31, s26
    s_cmp_ge_u32 s16, 20
    s_cselect_b32 s17, 59392, 0
    s_add_u32 s26, s26, s17
    s_cmp_ge_u32 s16, 20
    s_cselect_b32 s17, 4294966784, 0
    s_add_u32 s31, s31, s17
    s_add_u32 s16, s8, 24
    s_lshl_b32 s27, s16, 10
    s_mov_b32 s36, s27
    s_cmp_ge_u32 s16, 20
    s_cselect_b32 s17, 59392, 0
    s_add_u32 s27, s27, s17
    s_cmp_ge_u32 s16, 20
    s_cselect_b32 s17, 4294966784, 0
    s_add_u32 s36, s36, s17
    s_add_u32 s16, s8, 32
    s_lshl_b32 s28, s16, 10
    s_mov_b32 s37, s28
    s_cmp_ge_u32 s16, 20
    s_cselect_b32 s17, 59392, 0
    s_add_u32 s28, s28, s17
    s_cmp_ge_u32 s16, 20
    s_cselect_b32 s17, 4294966784, 0
    s_add_u32 s37, s37, s17
    s_add_u32 s16, s4, 0x480000
    s_addc_u32 s17, s5, 0
    s_mov_b32 s32, s16
    s_and_b32 s33, s17, 0xffff
    s_mov_b32 s34, 163840
    s_mov_b32 s35, 0x20000
    s_mul_i32 s16, s11, 73728
    s_add_u32 s16, s16, 0x890000
    s_lshr_b32 s17, s55, 1
    s_lshl_b32 s17, s17, 10
    s_and_b32 s18, s55, 1
    s_lshl_b32 s18, s18, 9
    s_add_u32 s17, s17, s18
    s_add_u32 s17, s17, s16
    s_add_u32 s56, s4, s17
    s_addc_u32 s57, s5, 0
    s_lshr_b32 s17, s55, 4
    s_add_u32 s17, s17, 16
    s_lshl_b32 s17, s17, 10
    s_lshr_b32 s18, s55, 2
    s_and_b32 s18, s18, 3
    s_lshl_b32 s18, s18, 8
    s_add_u32 s17, s17, s18
    s_and_b32 s18, s55, 3
    s_lshl_b32 s18, s18, 2
    s_add_u32 s17, s17, s18
    s_add_u32 s17, s17, s16
    s_add_u32 s58, s4, s17
    s_addc_u32 s59, s5, 0
    v_lshrrev_b32 v16, 4, v4
    v_mul_u32_u24 v16, 36864, v16
    v_and_b32 v7, 15, v4
    v_lshl_add_u32 v7, v7, 4, v16
    v_add_u32 v140, 104448, v137
    v_add_u32 v141, 104448, v138
    v_add_u32 v142, 104448, v139
    v_mfma_f32_16x16x32_bf16 v[92:95], v[72:75], v[44:47], v[92:95]
    ds_read_b128 v[36:39], v140 offset:0
    ds_read_b128 v[40:43], v140 offset:2048
    ds_read_b64_tr_b16 v[52:53], v142 offset:64
    v_mfma_f32_16x16x32_bf16 v[112:115], v[72:75], v[48:51], v[112:115]
    ds_read_b64_tr_b16 v[54:55], v142 offset:4672
    ds_read_b64_tr_b16 v[56:57], v142 offset:96
    ds_read_b64_tr_b16 v[58:59], v142 offset:4704
    v_mfma_f32_16x16x32_bf16 v[96:99], v[76:79], v[44:47], v[96:99]
    ds_read_b64_tr_b16 v[60:61], v142 offset:128
    ds_read_b64_tr_b16 v[62:63], v142 offset:4736
    ds_read_b64_tr_b16 v[64:65], v142 offset:256
    s_add_u32 m0, s96, 69632
    v_mfma_f32_16x16x32_bf16 v[116:119], v[76:79], v[48:51], v[116:119]
    ds_read_b64_tr_b16 v[66:67], v142 offset:4864
    buffer_load_dwordx4 v134, s[44:47], s99 offen lds
    v_mfma_f32_16x16x32_bf16 v[100:103], v[80:83], v[44:47], v[100:103]
    s_add_u32 m0, s96, 70656
    v_mfma_f32_16x16x32_bf16 v[120:123], v[80:83], v[48:51], v[120:123]
    buffer_load_dwordx4 v135, s[44:47], s99 offen lds
    v_mfma_f32_16x16x32_bf16 v[104:107], v[84:87], v[44:47], v[104:107]
    s_add_u32 m0, s97, 86016
    v_mfma_f32_16x16x32_bf16 v[124:127], v[84:87], v[48:51], v[124:127]
    buffer_load_dwordx4 v136, s[48:51], s100 offen lds
    s_waitcnt lgkmcnt(0)
    v_mfma_f32_16x16x32_bf16 v[92:95], v[52:55], v[36:39], v[92:95]
    ds_read_b128 v[44:47], v141 offset:0
    ds_read_b128 v[48:51], v141 offset:2048
    ds_read_b64_tr_b16 v[72:73], v142 offset:9280
    v_mfma_f32_16x16x32_bf16 v[112:115], v[52:55], v[40:43], v[112:115]
    ds_read_b64_tr_b16 v[74:75], v142 offset:13888
    ds_read_b64_tr_b16 v[76:77], v142 offset:9312
    ds_read_b64_tr_b16 v[78:79], v142 offset:13920
    v_mfma_f32_16x16x32_bf16 v[96:99], v[56:59], v[36:39], v[96:99]
    ds_read_b64_tr_b16 v[80:81], v142 offset:9344
    ds_read_b64_tr_b16 v[82:83], v142 offset:13952
    ds_read_b64_tr_b16 v[84:85], v142 offset:9472
    s_add_u32 m0, s97, 87040
    v_mfma_f32_16x16x32_bf16 v[116:119], v[56:59], v[40:43], v[116:119]
    ds_read_b64_tr_b16 v[86:87], v142 offset:14080
    buffer_load_dwordx4 v143, s[48:51], s100 offen lds
    v_mfma_f32_16x16x32_bf16 v[100:103], v[60:63], v[36:39], v[100:103]
    s_add_u32 m0, s98, 102400
    s_cmp_lt_u32 s8, 2
    s_cbranch_scc0 L_B_ex25
    buffer_load_dwordx4 v144, s[48:51], s100 offen lds
L_B_ex25:
    s_add_u32 s99, s99, 128
    s_add_u32 s100, s100, s101
    v_mfma_f32_16x16x32_bf16 v[120:123], v[60:63], v[40:43], v[120:123]
    v_mfma_f32_16x16x32_bf16 v[104:107], v[64:67], v[36:39], v[104:107]
    v_mfma_f32_16x16x32_bf16 v[124:127], v[64:67], v[40:43], v[124:127]
    s_waitcnt vmcnt(9)
    s_waitcnt lgkmcnt(0)
    s_barrier
    v_add_u32 v140, 0, v137
    v_add_u32 v141, 0, v138
    v_add_u32 v142, 0, v139
    v_mfma_f32_16x16x32_bf16 v[92:95], v[72:75], v[44:47], v[92:95]
    ds_read_b128 v[36:39], v140 offset:0
    ds_read_b128 v[40:43], v140 offset:2048
    ds_read_b64_tr_b16 v[52:53], v142 offset:64
    v_mfma_f32_16x16x32_bf16 v[112:115], v[72:75], v[48:51], v[112:115]
    ds_read_b64_tr_b16 v[54:55], v142 offset:4672
    ds_read_b64_tr_b16 v[56:57], v142 offset:96
    ds_read_b64_tr_b16 v[58:59], v142 offset:4704
    v_mfma_f32_16x16x32_bf16 v[96:99], v[76:79], v[44:47], v[96:99]
    ds_read_b64_tr_b16 v[60:61], v142 offset:128
    ds_read_b64_tr_b16 v[62:63], v142 offset:4736
    ds_read_b64_tr_b16 v[64:65], v142 offset:256
    s_add_u32 m0, s96, 104448
    v_mfma_f32_16x16x32_bf16 v[116:119], v[76:79], v[48:51], v[116:119]
    ds_read_b64_tr_b16 v[66:67], v142 offset:4864
    buffer_load_dwordx4 v134, s[44:47], s99 offen lds
    v_mfma_f32_16x16x32_bf16 v[100:103], v[80:83], v[44:47], v[100:103]
    s_add_u32 m0, s96, 105472
    v_mfma_f32_16x16x32_bf16 v[120:123], v[80:83], v[48:51], v[120:123]
    buffer_load_dwordx4 v135, s[44:47], s99 offen lds
    v_mfma_f32_16x16x32_bf16 v[104:107], v[84:87], v[44:47], v[104:107]
    s_add_u32 m0, s97, 120832
    v_mfma_f32_16x16x32_bf16 v[124:127], v[84:87], v[48:51], v[124:127]
    buffer_load_dwordx4 v136, s[48:51], s100 offen lds
    s_waitcnt lgkmcnt(0)
    v_mfma_f32_16x16x32_bf16 v[92:95], v[52:55], v[36:39], v[92:95]
    ds_read_b128 v[44:47], v141 offset:0
    ds_read_b128 v[48:51], v141 offset:2048
    ds_read_b64_tr_b16 v[72:73], v142 offset:9280
    v_mfma_f32_16x16x32_bf16 v[112:115], v[52:55], v[40:43], v[112:115]
    ds_read_b64_tr_b16 v[74:75], v142 offset:13888
    ds_read_b64_tr_b16 v[76:77], v142 offset:9312
    ds_read_b64_tr_b16 v[78:79], v142 offset:13920
    v_mfma_f32_16x16x32_bf16 v[96:99], v[56:59], v[36:39], v[96:99]
    ds_read_b64_tr_b16 v[80:81], v142 offset:9344
    ds_read_b64_tr_b16 v[82:83], v142 offset:13952
    ds_read_b64_tr_b16 v[84:85], v142 offset:9472
    s_add_u32 m0, s97, 121856
    v_mfma_f32_16x16x32_bf16 v[116:119], v[56:59], v[40:43], v[116:119]
    ds_read_b64_tr_b16 v[86:87], v142 offset:14080
    buffer_load_dwordx4 v143, s[48:51], s100 offen lds
    v_mfma_f32_16x16x32_bf16 v[100:103], v[60:63], v[36:39], v[100:103]
    s_add_u32 m0, s98, 137216
    s_cmp_lt_u32 s8, 2
    s_cbranch_scc0 L_B_ex26
    buffer_load_dwordx4 v144, s[48:51], s100 offen lds
L_B_ex26:
    s_add_u32 s99, s99, 128
    s_add_u32 s100, s100, s101
    v_mfma_f32_16x16x32_bf16 v[120:123], v[60:63], v[40:43], v[120:123]
    v_mfma_f32_16x16x32_bf16 v[104:107], v[64:67], v[36:39], v[104:107]
    v_mfma_f32_16x16x32_bf16 v[124:127], v[64:67], v[40:43], v[124:127]
    s_waitcnt vmcnt(8)
    s_waitcnt lgkmcnt(0)
    s_barrier
    v_add_u32 v140, 34816, v137
    v_add_u32 v141, 34816, v138
    v_add_u32 v142, 34816, v139
    v_mfma_f32_16x16x32_bf16 v[92:95], v[72:75], v[44:47], v[92:95]
    ds_read_b128 v[36:39], v140 offset:0
    ds_read_b128 v[40:43], v140 offset:2048
    ds_read_b64_tr_b16 v[52:53], v142 offset:64
    v_mfma_f32_16x16x32_bf16 v[112:115], v[72:75], v[48:51], v[112:115]
    ds_read_b64_tr_b16 v[54:55], v142 offset:4672
    ds_read_b64_tr_b16 v[56:57], v142 offset:96
    ds_read_b64_tr_b16 v[58:59], v142 offset:4704
    v_mfma_f32_16x16x32_bf16 v[96:99], v[76:79], v[44:47], v[96:99]
    ds_read_b64_tr_b16 v[60:61], v142 offset:128
    ds_read_b64_tr_b16 v[62:63], v142 offset:4736
    ds_read_b64_tr_b16 v[64:65], v142 offset:256
    s_add_u32 m0, s96, 0
    v_mfma_f32_16x16x32_bf16 v[116:119], v[76:79], v[48:51], v[116:119]
    ds_read_b64_tr_b16 v[66:67], v142 offset:4864
    buffer_load_dwordx4 v134, s[44:47], s99 offen lds
    v_mfma_f32_16x16x32_bf16 v[100:103], v[80:83], v[44:47], v[100:103]
    s_add_u32 m0, s96, 1024
    v_mfma_f32_16x16x32_bf16 v[120:123], v[80:83], v[48:51], v[120:123]
    buffer_load_dwordx4 v135, s[44:47], s99 offen lds
    v_mfma_f32_16x16x32_bf16 v[104:107], v[84:87], v[44:47], v[104:107]
    s_add_u32 m0, s97, 16384
    v_mfma_f32_16x16x32_bf16 v[124:127], v[84:87], v[48:51], v[124:127]
    buffer_load_dwordx4 v136, s[48:51], s100 offen lds
    s_waitcnt lgkmcnt(0)
    v_mfma_f32_16x16x32_bf16 v[92:95], v[52:55], v[36:39], v[92:95]
    ds_read_b128 v[44:47], v141 offset:0
    ds_read_b128 v[48:51], v141 offset:2048
    ds_read_b64_tr_b16 v[72:73], v142 offset:9280
    v_mfma_f32_16x16x32_bf16 v[112:115], v[52:55], v[40:43], v[112:115]
    ds_read_b64_tr_b16 v[74:75], v142 offset:13888
    ds_read_b64_tr_b16 v[76:77], v142 offset:9312
    ds_read_b64_tr_b16 v[78:79], v142 offset:13920
    v_mfma_f32_16x16x32_bf16 v[96:99], v[56:59], v[36:39], v[96:99]
    ds_read_b64_tr_b16 v[80:81], v142 offset:9344
    ds_read_b64_tr_b16 v[82:83], v142 offset:13952
    ds_read_b64_tr_b16 v[84:85], v142 offset:9472
    s_add_u32 m0, s97, 17408
    v_mfma_f32_16x16x32_bf16 v[116:119], v[56:59], v[40:43], v[116:119]
    ds_read_b64_tr_b16 v[86:87], v142 offset:14080
    buffer_load_dwordx4 v143, s[48:51], s100 offen lds
    v_mfma_f32_16x16x32_bf16 v[100:103], v[60:63], v[36:39], v[100:103]
    s_add_u32 m0, s98, 32768
    s_cmp_lt_u32 s8, 2
    s_cbranch_scc0 L_B_ex27
    buffer_load_dwordx4 v144, s[48:51], s100 offen lds
L_B_ex27:
    s_add_u32 s99, s99, 128
    s_add_u32 s100, s100, s101
    v_mfma_f32_16x16x32_bf16 v[120:123], v[60:63], v[40:43], v[120:123]
    v_mfma_f32_16x16x32_bf16 v[104:107], v[64:67], v[36:39], v[104:107]
    v_mfma_f32_16x16x32_bf16 v[124:127], v[64:67], v[40:43], v[124:127]
    s_waitcnt vmcnt(8)
    s_waitcnt lgkmcnt(0)
    s_barrier
    s_mov_b32 s21, 0
L_non3:
    v_readfirstlane_b32 s3, v211
    s_add_u32 s21, s21, 1
    s_cmp_lg_u32 s3, 0
    s_cbranch_scc1 L_non3_ok
    s_sleep 8
    global_load_dword v211, v210, s[6:7] sc1
    s_waitcnt vmcnt(0)
    s_cmp_lt_u32 s21, 0x40000
    s_cbranch_scc1 L_non3
L_non3_ok:
    v_add_u32 v140, 69632, v137
    v_add_u32 v141, 69632, v138
    v_add_u32 v142, 69632, v139
    v_mfma_f32_16x16x32_bf16 v[92:95], v[72:75], v[44:47], v[92:95]
    ds_read_b128 v[36:39], v140 offset:0
    ds_read_b128 v[40:43], v140 offset:2048
    ds_read_b64_tr_b16 v[52:53], v142 offset:64
    v_mfma_f32_16x16x32_bf16 v[112:115], v[72:75], v[48:51], v[112:115]
    ds_read_b64_tr_b16 v[54:55], v142 offset:4672
    ds_read_b64_tr_b16 v[56:57], v142 offset:96
    ds_read_b64_tr_b16 v[58:59], v142 offset:4704
    v_mfma_f32_16x16x32_bf16 v[96:99], v[76:79], v[44:47], v[96:99]
    ds_read_b64_tr_b16 v[60:61], v142 offset:128
    ds_read_b64_tr_b16 v[62:63], v142 offset:4736
    ds_read_b64_tr_b16 v[64:65], v142 offset:256
    v_mfma_f32_16x16x32_bf16 v[116:119], v[76:79], v[48:51], v[116:119]
    ds_read_b64_tr_b16 v[66:67], v142 offset:4864
    v_mfma_f32_16x16x32_bf16 v[100:103], v[80:83], v[44:47], v[100:103]
    v_mfma_f32_16x16x32_bf16 v[120:123], v[80:83], v[48:51], v[120:123]
    v_mfma_f32_16x16x32_bf16 v[104:107], v[84:87], v[44:47], v[104:107]
    v_mfma_f32_16x16x32_bf16 v[124:127], v[84:87], v[48:51], v[124:127]
    s_waitcnt lgkmcnt(0)
    v_mfma_f32_16x16x32_bf16 v[92:95], v[52:55], v[36:39], v[92:95]
    ds_read_b128 v[44:47], v141 offset:0
    ds_read_b128 v[48:51], v141 offset:2048
    ds_read_b64_tr_b16 v[72:73], v142 offset:9280
    v_mfma_f32_16x16x32_bf16 v[112:115], v[52:55], v[40:43], v[112:115]
    ds_read_b64_tr_b16 v[74:75], v142 offset:13888
    ds_read_b64_tr_b16 v[76:77], v142 offset:9312
    ds_read_b64_tr_b16 v[78:79], v142 offset:13920
    v_mfma_f32_16x16x32_bf16 v[96:99], v[56:59], v[36:39], v[96:99]
    ds_read_b64_tr_b16 v[80:81], v142 offset:9344
    ds_read_b64_tr_b16 v[82:83], v142 offset:13952
    ds_read_b64_tr_b16 v[84:85], v142 offset:9472
    v_mfma_f32_16x16x32_bf16 v[116:119], v[56:59], v[40:43], v[116:119]
    ds_read_b64_tr_b16 v[86:87], v142 offset:14080
    v_mfma_f32_16x16x32_bf16 v[100:103], v[60:63], v[36:39], v[100:103]
    v_mfma_f32_16x16x32_bf16 v[120:123], v[60:63], v[40:43], v[120:123]
    v_mfma_f32_16x16x32_bf16 v[104:107], v[64:67], v[36:39], v[104:107]
    v_mfma_f32_16x16x32_bf16 v[124:127], v[64:67], v[40:43], v[124:127]
    s_waitcnt vmcnt(4)
    s_waitcnt lgkmcnt(0)
    s_barrier
    v_add_u32 v140, 104448, v137
    v_add_u32 v141, 104448, v138
    v_add_u32 v142, 104448, v139
    v_mfma_f32_16x16x32_bf16 v[92:95], v[72:75], v[44:47], v[92:95]
    ds_read_b128 v[36:39], v140 offset:0
    ds_read_b128 v[40:43], v140 offset:2048
    ds_read_b64_tr_b16 v[52:53], v142 offset:64
    v_mfma_f32_16x16x32_bf16 v[112:115], v[72:75], v[48:51], v[112:115]
    ds_read_b64_tr_b16 v[54:55], v142 offset:4672
    ds_read_b64_tr_b16 v[56:57], v142 offset:96
    ds_read_b64_tr_b16 v[58:59], v142 offset:4704
    v_mfma_f32_16x16x32_bf16 v[96:99], v[76:79], v[44:47], v[96:99]
    ds_read_b64_tr_b16 v[60:61], v142 offset:128
    ds_read_b64_tr_b16 v[62:63], v142 offset:4736
    ds_read_b64_tr_b16 v[64:65], v142 offset:256
    v_mfma_f32_16x16x32_bf16 v[116:119], v[76:79], v[48:51], v[116:119]
    ds_read_b64_tr_b16 v[66:67], v142 offset:4864
    v_mfma_f32_16x16x32_bf16 v[100:103], v[80:83], v[44:47], v[100:103]
    v_mfma_f32_16x16x32_bf16 v[120:123], v[80:83], v[48:51], v[120:123]
    v_mfma_f32_16x16x32_bf16 v[104:107], v[84:87], v[44:47], v[104:107]
    v_mfma_f32_16x16x32_bf16 v[124:127], v[84:87], v[48:51], v[124:127]
    s_waitcnt lgkmcnt(0)
    v_mfma_f32_16x16x32_bf16 v[92:95], v[52:55], v[36:39], v[92:95]
    ds_read_b128 v[44:47], v141 offset:0
    ds_read_b128 v[48:51], v141 offset:2048
    ds_read_b64_tr_b16 v[72:73], v142 offset:9280
    v_mfma_f32_16x16x32_bf16 v[112:115], v[52:55], v[40:43], v[112:115]
    ds_read_b64_tr_b16 v[74:75], v142 offset:13888
    ds_read_b64_tr_b16 v[76:77], v142 offset:9312
    ds_read_b64_tr_b16 v[78:79], v142 offset:13920
    v_mfma_f32_16x16x32_bf16 v[96:99], v[56:59], v[36:39], v[96:99]
    ds_read_b64_tr_b16 v[80:81], v142 offset:9344
    ds_read_b64_tr_b16 v[82:83], v142 offset:13952
    ds_read_b64_tr_b16 v[84:85], v142 offset:9472
    v_mfma_f32_16x16x32_bf16 v[116:119], v[56:59], v[40:43], v[116:119]
    ds_read_b64_tr_b16 v[86:87], v142 offset:14080
    v_mfma_f32_16x16x32_bf16 v[100:103], v[60:63], v[36:39], v[100:103]
    v_mfma_f32_16x16x32_bf16 v[120:123], v[60:63], v[40:43], v[120:123]
    v_mfma_f32_16x16x32_bf16 v[104:107], v[64:67], v[36:39], v[104:107]
    v_mfma_f32_16x16x32_bf16 v[124:127], v[64:67], v[40:43], v[124:127]
    s_waitcnt vmcnt(0)
    s_waitcnt lgkmcnt(0)
    s_barrier
    v_add_u32 v140, 0, v137
    v_add_u32 v141, 0, v138
    v_add_u32 v142, 0, v139
    v_mfma_f32_16x16x32_bf16 v[92:95], v[72:75], v[44:47], v[92:95]
    ds_read_b128 v[36:39], v140 offset:0
    ds_read_b128 v[40:43], v140 offset:2048
    ds_read_b64_tr_b16 v[52:53], v142 offset:64
    v_mfma_f32_16x16x32_bf16 v[112:115], v[72:75], v[48:51], v[112:115]
    ds_read_b64_tr_b16 v[54:55], v142 offset:4672
    ds_read_b64_tr_b16 v[56:57], v142 offset:96
    ds_read_b64_tr_b16 v[58:59], v142 offset:4704
    v_mfma_f32_16x16x32_bf16 v[96:99], v[76:79], v[44:47], v[96:99]
    ds_read_b64_tr_b16 v[60:61], v142 offset:128
    ds_read_b64_tr_b16 v[62:63], v142 offset:4736
    ds_read_b64_tr_b16 v[64:65], v142 offset:256
    v_mfma_f32_16x16x32_bf16 v[116:119], v[76:79], v[48:51], v[116:119]
    ds_read_b64_tr_b16 v[66:67], v142 offset:4864
    v_mfma_f32_16x16x32_bf16 v[100:103], v[80:83], v[44:47], v[100:103]
    v_mfma_f32_16x16x32_bf16 v[120:123], v[80:83], v[48:51], v[120:123]
    v_mfma_f32_16x16x32_bf16 v[104:107], v[84:87], v[44:47], v[104:107]
    v_mfma_f32_16x16x32_bf16 v[124:127], v[84:87], v[48:51], v[124:127]
    s_waitcnt lgkmcnt(0)
    v_mfma_f32_16x16x32_bf16 v[92:95], v[52:55], v[36:39], v[92:95]
    ds_read_b128 v[44:47], v141 offset:0
    ds_read_b128 v[48:51], v141 offset:2048
    ds_read_b64_tr_b16 v[72:73], v142 offset:9280
    v_mfma_f32_16x16x32_bf16 v[112:115], v[52:55], v[40:43], v[112:115]
    ds_read_b64_tr_b16 v[74:75], v142 offset:13888
    ds_read_b64_tr_b16 v[76:77], v142 offset:9312
    ds_read_b64_tr_b16 v[78:79], v142 offset:13920
    v_mfma_f32_16x16x32_bf16 v[96:99], v[56:59], v[36:39], v[96:99]
    ds_read_b64_tr_b16 v[80:81], v142 offset:9344
    ds_read_b64_tr_b16 v[82:83], v142 offset:13952
    ds_read_b64_tr_b16 v[84:85], v142 offset:9472
    v_mfma_f32_16x16x32_bf16 v[116:119], v[56:59], v[40:43], v[116:119]
    ds_read_b64_tr_b16 v[86:87], v142 offset:14080
    v_mfma_f32_16x16x32_bf16 v[100:103], v[60:63], v[36:39], v[100:103]
    v_mfma_f32_16x16x32_bf16 v[120:123], v[60:63], v[40:43], v[120:123]
    v_mfma_f32_16x16x32_bf16 v[104:107], v[64:67], v[36:39], v[104:107]
    v_mfma_f32_16x16x32_bf16 v[124:127], v[64:67], v[40:43], v[124:127]
    s_waitcnt lgkmcnt(0)
    v_mfma_f32_16x16x32_bf16 v[92:95], v[72:75], v[44:47], v[92:95]
    v_mfma_f32_16x16x32_bf16 v[112:115], v[72:75], v[48:51], v[112:115]
    v_mfma_f32_16x16x32_bf16 v[96:99], v[76:79], v[44:47], v[96:99]
    v_mfma_f32_16x16x32_bf16 v[116:119], v[76:79], v[48:51], v[116:119]
    v_mfma_f32_16x16x32_bf16 v[100:103], v[80:83], v[44:47], v[100:103]
    v_mfma_f32_16x16x32_bf16 v[120:123], v[80:83], v[48:51], v[120:123]
    v_mfma_f32_16x16x32_bf16 v[104:107], v[84:87], v[44:47], v[104:107]
    v_mfma_f32_16x16x32_bf16 v[124:127], v[84:87], v[48:51], v[124:127]
    s_lshl_b32 s16, s14, 5
    v_add_u32 v20, s16, v2
    v_mul_u32_u24 v20, 296, v20
    v_lshl_add_u32 v20, v3, 3, v20
    v_add_u32 v20, 73728, v20
    s_barrier
    s_mov_b32 s16, 0x3eae1a93
    v_mul_f32 v92, s16, v92
    v_mul_f32 v93, s16, v93
    v_mul_f32 v94, s16, v94
    v_mul_f32 v95, s16, v95
    v_cvt_pk_bf16_f32 v92, v92, v93
    v_cvt_pk_bf16_f32 v93, v94, v95
    ds_write_b64 v20, v[92:93] offset:64
    v_mul_f32 v112, s16, v112
    v_mul_f32 v113, s16, v113
    v_mul_f32 v114, s16, v114
    v_mul_f32 v115, s16, v115
    v_cvt_pk_bf16_f32 v112, v112, v113
    v_cvt_pk_bf16_f32 v113, v114, v115
    ds_write_b64 v20, v[112:113] offset:4800
    v_mul_f32 v96, s16, v96
    v_mul_f32 v97, s16, v97
    v_mul_f32 v98, s16, v98
    v_mul_f32 v99, s16, v99
    v_cvt_pk_bf16_f32 v96, v96, v97
    v_cvt_pk_bf16_f32 v97, v98, v99
    ds_write_b64 v20, v[96:97] offset:96
    v_mul_f32 v116, s16, v116
    v_mul_f32 v117, s16, v117
    v_mul_f32 v118, s16, v118
    v_mul_f32 v119, s16, v119
    v_cvt_pk_bf16_f32 v116, v116, v117
    v_cvt_pk_bf16_f32 v117, v118, v119
    ds_write_b64 v20, v[116:117] offset:4832
    v_mul_f32 v100, s16, v100
    v_mul_f32 v101, s16, v101
    v_mul_f32 v102, s16, v102
    v_mul_f32 v103, s16, v103
    v_cvt_pk_bf16_f32 v100, v100, v101
    v_cvt_pk_bf16_f32 v101, v102, v103
    ds_write_b64 v20, v[100:101] offset:128
    v_mul_f32 v120, s16, v120
    v_mul_f32 v121, s16, v121
    v_mul_f32 v122, s16, v122
    v_mul_f32 v123, s16, v123
    v_cvt_pk_bf16_f32 v120, v120, v121
    v_cvt_pk_bf16_f32 v121, v122, v123
    ds_write_b64 v20, v[120:121] offset:4864
    v_mul_f32 v104, s16, v104
    v_mul_f32 v105, s16, v105
    v_mul_f32 v106, s16, v106
    v_mul_f32 v107, s16, v107
    v_cvt_pk_bf16_f32 v104, v104, v105
    v_cvt_pk_bf16_f32 v105, v106, v107
    ds_write_b64 v20, v[104:105] offset:256
    v_mul_f32 v124, s16, v124
    v_mul_f32 v125, s16, v125
    v_mul_f32 v126, s16, v126
    v_mul_f32 v127, s16, v127
    v_cvt_pk_bf16_f32 v124, v124, v125
    v_cvt_pk_bf16_f32 v125, v126, v127
    ds_write_b64 v20, v[124:125] offset:4992
    s_mul_i32 s16, s8, 36
    s_add_u32 s16, s16, 73728
    v_and_b32 v21, 31, v1
    v_mul_u32_u24 v22, 296, v21
    v_add_u32 v22, s16, v22
    v_lshrrev_b32 v23, 5, v1
    v_lshl_add_u32 v24, v23, 4, v22
    v_mul_u32_u24 v25, 9472, v23
    v_add_u32 v25, v25, v22
    v_lshlrev_b32 v26, 4, v1
    v_mul_u32_u24 v27, 36864, v23
    v_lshl_add_u32 v27, v21, 2, v27
    s_lshl_b32 s16, s69, 7
    s_lshl_b32 s17, s70, 3
    s_add_u32 s16, s16, s17
    s_add_u32 s16, s16, s8
    s_mul_i32 s16, s16, 1152
    s_add_u32 s16, s16, 0x0
    s_add_u32 s76, s4, s16
    s_addc_u32 s77, s5, 0
    s_waitcnt lgkmcnt(0)
    s_barrier
    v_add_u32 v28, 0, v24
    ds_read2_b32 v[36:37], v28 offset0:0 offset1:1
    ds_read2_b32 v[38:39], v28 offset0:2 offset1:3
    v_add_u32 v28, 9472, v24
    ds_read2_b32 v[40:41], v28 offset0:0 offset1:1
    ds_read2_b32 v[42:43], v28 offset0:2 offset1:3
    v_add_u32 v28, 18944, v24
    ds_read2_b32 v[44:45], v28 offset0:0 offset1:1
    ds_read2_b32 v[46:47], v28 offset0:2 offset1:3
    v_add_u32 v28, 28416, v24
    ds_read2_b32 v[48:49], v28 offset0:0 offset1:1
    ds_read2_b32 v[50:51], v28 offset0:2 offset1:3
    ds_read_b32 v52, v25 offset:32
    ds_read_b32 v53, v25 offset:18976
    s_waitcnt lgkmcnt(0)
    global_store_dwordx4 v26, v[36:39], s[76:77] sc1
    s_add_u32 s76, s76, 36864
    s_addc_u32 s77, s77, 0
    global_store_dwordx4 v26, v[40:43], s[76:77] sc1
    s_add_u32 s76, s76, 36864
    s_addc_u32 s77, s77, 0
    global_store_dwordx4 v26, v[44:47], s[76:77] sc1
    s_add_u32 s76, s76, 36864
    s_addc_u32 s77, s77, 0
    global_store_dwordx4 v26, v[48:51], s[76:77] sc1
    s_add_u32 s76, s76, 36864
    s_addc_u32 s77, s77, 0
    s_sub_u32 s76, s76, 147456
    s_subb_u32 s77, s77, 0
    global_store_dword v27, v52, s[76:77] offset:1024 sc1
    s_add_u32 s76, s76, 73728
    s_addc_u32 s77, s77, 0
    global_store_dword v27, v53, s[76:77] offset:1024 sc1
L_A_qj:
    s_waitcnt vmcnt(0)
    s_lshl_b32 s17, s69, 2
    s_add_u32 s17, s17, s70
    s_lshl_b32 s17, s17, 3
    s_add_u32 s17, s17, s8
    s_lshl_b32 s17, s17, 7
    s_add_u32 s17, s17, 0xf40000
    v_mov_b32 v16, s17
    v_mov_b32 v17, s3
    s_mov_b32 exec_lo, 1
    s_mov_b32 exec_hi, 0
    global_store_dword v16, v17, s[4:5] sc1
    s_mov_b64 exec, -1
    v_lshlrev_b32 v236, 7, v1
    v_add_u32 v236, 0xf10000, v236
    s_cmp_lg_u32 s8, 0
    s_cbranch_scc1 L_pa_iAqx
    global_load_dword v232, v236, s[4:5] sc1
L_pa_iAqx:
    s_cmp_lg_u32 s8, 0
    s_cbranch_scc1 L_pa_cAqx
    s_mov_b32 s21, 0
L_pa_wAqx_spin:
    s_waitcnt vmcnt(0)
    v_cmp_eq_u32 vcc, s3, v232
    s_add_u32 s21, s21, 1
    s_cmp_eq_u64 vcc, -1
    s_cbranch_scc1 L_pa_wAqx_ok
    s_sleep 2
    global_load_dword v232, v236, s[4:5] sc1
    s_cmp_lt_u32 s21, 0x40000
    s_cbranch_scc1 L_pa_wAqx_spin
L_pa_wAqx_ok:
L_pa_cAqx:
    s_barrier
    s_mov_b32 s96, -1
    s_mov_b32 s98, -1
    s_cmp_eq_u32 s8, 3
    s_cselect_b32 s97, 0, -1
    s_cmp_eq_u32 s8, 7
    s_cselect_b32 s99, 0, -1
    v_lshlrev_b32 v237, 4, v1
    s_add_u32 m0, s29, 119808
    s_mov_b32 s52, s24
    buffer_load_dwordx4 v237, s[32:35], s52 offen sc1 lds
    s_add_u32 m0, s30, 119808
    s_mov_b32 s52, s25
    buffer_load_dwordx4 v237, s[32:35], s52 offen sc1 lds
    s_add_u32 m0, s31, 119808
    s_mov_b32 s52, s26
    s_mov_b64 exec, s[96:97]
    buffer_load_dwordx4 v237, s[32:35], s52 offen sc1 lds
    s_mov_b64 exec, -1
    s_add_u32 m0, s36, 119808
    s_mov_b32 s52, s27
    buffer_load_dwordx4 v237, s[32:35], s52 offen sc1 lds
    s_add_u32 m0, s37, 119808
    s_mov_b32 s52, s28
    s_mov_b64 exec, s[98:99]
    buffer_load_dwordx4 v237, s[32:35], s52 offen sc1 lds
    s_mov_b64 exec, -1
    v_and_b32 v236, 31, v1
    s_lshl_b32 s16, s8, 5
    v_add_u32 v236, s16, v236
    v_lshlrev_b32 v236, 7, v236
    v_add_u32 v236, 0xd10000, v236
    s_mov_b32 exec_hi, 0
    global_load_dword v224, v236, s[4:5] sc1
    s_mov_b64 exec, -1
    s_lshl_b32 s16, s11, 7
    s_add_u32 s16, s16, 0x4a9000
    v_and_b32 v236, 31, v1
    v_lshlrev_b32 v236, 2, v236
    v_add_u32 v236, s16, v236
    global_load_dword v228, v236, s[4:5] sc1
    s_and_b32 s16, s11, 0xfc
    s_add_u32 s16, s16, s12
    s_lshl_b32 s16, s16, 3
    s_lshl_b32 s17, s14, 1
    s_add_u32 s16, s16, s17
    v_and_b32 v238, 1, v1
    v_add_u32 v238, s16, v238
    v_lshlrev_b32 v238, 7, v238
    v_add_u32 v238, 0xf40000, v238
    global_load_dword v239, v238, s[4:5] sc1
    s_waitcnt vmcnt(1)
    s_branch L_B_done
L_f2_bq:
    s_waitcnt lgkmcnt(0)
    s_and_b32 s16, s9, 1
    s_lshl_b32 s16, s16, 3
    s_and_b32 s69, s15, 7
    s_add_u32 s69, s69, s16
    s_waitcnt lgkmcnt(0)
    s_lshl_b32 s23, s69, 2
    s_lshr_b32 s16, s9, 1
    s_add_u32 s23, s23, s16
    v_lshrrev_b32 v20, 3, v1
    s_lshl_b32 s16, s14, 3
    v_add_u32 v20, s16, v20
    s_lshl_b32 s16, s14, 2
    v_add_u32 v21, s16, v3
    v_and_b32 v21, 7, v21
    v_and_b32 v22, 7, v1
    v_xor_b32 v21, v21, v22
    v_lshlrev_b32 v21, 4, v21
    v_mul_u32_u24 v20, 1152, v20
    v_add_u32 v4, v20, v21
    s_mul_i32 s16, s23, 36864
    s_add_u32 s17, s40, s16
    s_addc_u32 s18, s41, 0
    s_mov_b32 s24, s17
    s_and_b32 s25, s18, 0xffff
    s_mov_b32 s26, 36864
    s_mov_b32 s27, 0x20000
    s_lshr_b32 s19, s8, 2
    s_cmp_eq_u32 s19, 0
    s_cselect_b32 s17, s44, s46
    s_cselect_b32 s18, s45, s47
    s_mov_b32 s32, s17
    s_and_b32 s33, s18, 0xffff
    s_mov_b32 s34, 20736
    s_mov_b32 s35, 0x20000
    s_mov_b32 s28, s56
    s_and_b32 s29, s57, 0xffff
    s_mov_b32 s30, 1152
    s_mov_b32 s31, 0x20000
    s_and_b32 s16, s8, 1
    s_lshl_b32 s16, s16, 5
    v_lshrrev_b32 v20, 1, v1
    v_add_u32 v20, s16, v20
    v_and_b32 v23, 0x23, v20
    v_bfe_u32 v24, v20, 2, 2
    v_lshl_add_u32 v23, v24, 3, v23
    v_bfe_u32 v24, v20, 4, 1
    v_lshl_add_u32 v23, v24, 2, v23
    v_mul_u32_u24 v23, 36, v23
    v_and_b32 v21, 1, v1
    v_lshlrev_b32 v21, 4, v21
    s_bitcmp1_b32 s8, 1
    s_cselect_b64 vcc, -1, 0
    v_mov_b32 v22, 32
    v_cndmask_b32 v21, v21, v22, vcc
    v_add_u32 v5, v23, v21
    s_lshl_b32 s20, s8, 10
    s_mov_b32 s58, 0
    s_mov_b32 s59, s20
    s_lshl_b32 s16, s13, 7
    s_add_u32 s16, s16, 0
    s_lshl_b32 s17, s8, 10
    s_add_u32 m0, s17, 36864
    s_nop 0
    buffer_load_dwordx4 v4, s[24:27], s16 offen lds
    s_add_u32 m0, s59, 73728
    s_nop 0
    buffer_load_dwordx4 v5, s[32:35], s58 offen lds
    s_add_u32 s58, s58, 2304
    s_and_b32 s16, s8, 1
    s_lshl_b32 s16, s16, 10
    v_lshlrev_b32 v6, 4, v1
    v_add_u32 v6, s16, v6
    s_add_u32 m0, s16, 147456
    s_cmp_lt_u32 s8, 2
    s_cbranch_scc0 L_M_nogate
    buffer_load_dwordx4 v6, s[28:31], 0 offen lds
L_M_nogate:
    s_lshl_b32 s16, s13, 7
    s_add_u32 s16, s16, 256
    s_lshl_b32 s17, s8, 10
    s_add_u32 m0, s17, 45056
    s_nop 0
    buffer_load_dwordx4 v4, s[24:27], s16 offen lds
    s_add_u32 m0, s59, 81920
    s_nop 0
    buffer_load_dwordx4 v5, s[32:35], s58 offen lds
    s_add_u32 s58, s58, 2304
    s_add_u32 m0, s59, 90112
    s_nop 0
    buffer_load_dwordx4 v5, s[32:35], s58 offen lds
    s_add_u32 s58, s58, 2304
    s_lshl_b32 s16, s13, 7
    s_add_u32 s16, s16, 512
    s_lshl_b32 s17, s8, 10
    s_add_u32 m0, s17, 53248
    s_nop 0
    buffer_load_dwordx4 v4, s[24:27], s16 offen lds
    s_add_u32 m0, s59, 98304
    s_nop 0
    buffer_load_dwordx4 v5, s[32:35], s58 offen lds
    s_add_u32 s58, s58, 2304
    s_add_u32 m0, s59, 106496
    s_nop 0
    buffer_load_dwordx4 v5, s[32:35], s58 offen lds
    s_add_u32 s58, s58, 2304
    s_lshl_b32 s16, s13, 7
    s_add_u32 s16, s16, 768
    s_lshl_b32 s17, s8, 10
    s_add_u32 m0, s17, 61440
    s_nop 0
    buffer_load_dwordx4 v4, s[24:27], s16 offen lds
    s_add_u32 m0, s59, 114688
    s_nop 0
    buffer_load_dwordx4 v5, s[32:35], s58 offen lds
    s_add_u32 s58, s58, 2304
    s_add_u32 m0, s59, 122880
    s_nop 0
    buffer_load_dwordx4 v5, s[32:35], s58 offen lds
    s_add_u32 s58, s58, 2304
    s_mov_b32 s16, 1024
    s_lshl_b32 s17, s14, 10
    s_add_u32 m0, s17, 69632
    s_nop 0
    buffer_load_dwordx4 v4, s[24:27], s16 offen lds
    s_add_u32 m0, s59, 131072
    s_nop 0
    buffer_load_dwordx4 v5, s[32:35], s58 offen lds
    s_add_u32 s58, s58, 2304
    s_add_u32 m0, s59, 139264
    s_nop 0
    buffer_load_dwordx4 v5, s[32:35], s58 offen lds
    s_add_u32 s58, s58, 2304
    s_barrier
    s_and_b32 s16, s9, 1
    s_lshl_b32 s16, s16, 3
    s_and_b32 s69, s15, 7
    s_add_u32 s69, s69, s16
    s_lshr_b32 s19, s15, 3
    s_lshr_b32 s17, s9, 1
    s_lshl_b32 s18, s17, 1
    s_add_u32 s18, s18, s19
    s_sub_u32 s18, s18, 1
    s_add_u32 s20, s19, 1
    s_and_b32 s20, s20, 3
    s_cmp_lt_u32 s20, 2
    s_cselect_b32 s70, s17, s18
    s_lshl_b32 s96, s8, 11
    s_lshl_b32 s97, s8, 11
    s_and_b32 s98, s8, 1
    s_lshl_b32 s98, s98, 10
    s_mov_b32 s99, 0
    v_lshrrev_b32 v20, 3, v1
    v_and_b32 v21, 7, v1
    s_lshl_b32 s16, s8, 4
    v_add_u32 v22, 0, v20
    v_add_u32 v22, s16, v22
    v_add_u32 v23, 0, v3
    v_xor_b32 v23, v23, v21
    v_lshlrev_b32 v23, 4, v23
    v_mul_u32_u24 v22, 1152, v22
    v_add_u32 v134, v22, v23
    v_add_u32 v22, 8, v20
    v_add_u32 v22, s16, v22
    v_add_u32 v23, 4, v3
    v_xor_b32 v23, v23, v21
    v_lshlrev_b32 v23, 4, v23
    v_mul_u32_u24 v22, 1152, v22
    v_add_u32 v135, v22, v23
    s_lshr_b32 s19, s15, 3
    s_mul_i32 s16, s70, 288
    s_mul_i32 s17, s70, 144
    s_add_u32 s17, s17, 1152
    s_add_u32 s20, s19, 1
    s_and_b32 s20, s20, 3
    s_cmp_lt_u32 s20, 2
    s_cselect_b32 s66, s16, s17
    s_cselect_b32 s67, 0, 1008
    s_mov_b32 s68, 3456
    s_cmp_eq_u32 s19, 3
    s_cselect_b32 s68, 1152, s68
    s_lshl_b32 s101, s68, 6
    s_lshl_b32 s16, s8, 7
    s_add_u32 s16, s16, 0
    v_add_u32 v20, s16, v1
    v_mul_u32_u24 v21, 3641, v20
    v_lshrrev_b32 v21, 16, v21
    v_mad_i32_i24 v22, v21, -16, v20
    v_mad_i32_i24 v22, v21, -2, v22
    v_and_b32 v23, 0x23, v21
    v_bfe_u32 v24, v21, 2, 2
    v_lshl_add_u32 v23, v24, 3, v23
    v_bfe_u32 v24, v21, 4, 1
    v_lshl_add_u32 v23, v24, 2, v23
    v_mul_lo_u32 v23, v23, s68
    v_lshlrev_b32 v24, 4, v22
    v_add_u32 v23, v23, v24
    v_add_u32 v23, s66, v23
    v_cmp_lt_u32 vcc, 8, v22
    v_add_u32 v24, s67, v23
    s_nop 0
    v_cndmask_b32 v136, v23, v24, vcc
    s_lshl_b32 s16, s8, 7
    s_add_u32 s16, s16, 64
    v_add_u32 v20, s16, v1
    v_mul_u32_u24 v21, 3641, v20
    v_lshrrev_b32 v21, 16, v21
    v_mad_i32_i24 v22, v21, -16, v20
    v_mad_i32_i24 v22, v21, -2, v22
    v_and_b32 v23, 0x23, v21
    v_bfe_u32 v24, v21, 2, 2
    v_lshl_add_u32 v23, v24, 3, v23
    v_bfe_u32 v24, v21, 4, 1
    v_lshl_add_u32 v23, v24, 2, v23
    v_mul_lo_u32 v23, v23, s68
    v_lshlrev_b32 v24, 4, v22
    v_add_u32 v23, v23, v24
    v_add_u32 v23, s66, v23
    v_cmp_lt_u32 vcc, 8, v22
    v_add_u32 v24, s67, v23
    s_nop 0
    v_cndmask_b32 v143, v23, v24, vcc
    s_and_b32 s16, s8, 1
    s_lshl_b32 s16, s16, 6
    s_add_u32 s16, s16, 1024
    v_add_u32 v20, s16, v1
    v_mul_u32_u24 v21, 3641, v20
    v_lshrrev_b32 v21, 16, v21
    v_mad_i32_i24 v22, v21, -16, v20
    v_mad_i32_i24 v22, v21, -2, v22
    v_and_b32 v23, 0x23, v21
    v_bfe_u32 v24, v21, 2, 2
    v_lshl_add_u32 v23, v24, 3, v23
    v_bfe_u32 v24, v21, 4, 1
    v_lshl_add_u32 v23, v24, 2, v23
    v_mul_lo_u32 v23, v23, s68
    v_lshlrev_b32 v24, 4, v22
    v_add_u32 v23, v23, v24
    v_add_u32 v23, s66, v23
    v_cmp_lt_u32 vcc, 8, v22
    v_add_u32 v24, s67, v23
    s_nop 0
    v_cndmask_b32 v144, v23, v24, vcc
    v_lshrrev_b32 v21, 1, v2
    v_xor_b32 v20, v3, v21
    v_lshlrev_b32 v20, 4, v20
    v_lshl_add_u32 v20, v2, 7, v20
    s_lshl_b32 s16, s14, 12
    v_add_u32 v137, s16, v20
    v_xor_b32 v138, 64, v137
    v_lshrrev_b32 v20, 2, v2
    v_lshl_add_u32 v20, v3, 2, v20
    v_and_b32 v21, 3, v2
    v_lshlrev_b32 v21, 3, v21
    v_mul_u32_u24 v139, 288, v20
    v_add_u32 v139, v139, v21
    v_add_u32 v139, 16384, v139
    s_mul_i32 s16, s69, 147456
    s_add_u32 s17, s40, s16
    s_addc_u32 s18, s41, 0
    s_mov_b32 s44, s17
    s_and_b32 s45, s18, 0xffff
    s_mov_b32 s46, 147456
    s_mov_b32 s47, 0x20000
    s_lshr_b32 s71, s15, 3
    s_cmp_eq_u32 s71, 3
    s_cselect_b32 s17, s42, s52
    s_cselect_b32 s18, s43, s53
    s_mov_b32 s48, s17
    s_and_b32 s49, s18, 0xffff
    s_mov_b32 s50, 1990656
    s_mov_b32 s51, 0x20000
    s_cmp_eq_u32 s71, 3
    s_cselect_b32 s50, 663552, s50
    s_mov_b32 s100, 0
    s_add_u32 m0, s96, 0
    s_nop 0
    buffer_load_dwordx4 v134, s[44:47], s99 offen lds
    s_add_u32 m0, s96, 1024
    s_nop 0
    buffer_load_dwordx4 v135, s[44:47], s99 offen lds
    s_add_u32 m0, s97, 16384
    s_nop 0
    buffer_load_dwordx4 v136, s[48:51], s100 offen lds
    s_add_u32 m0, s97, 17408
    s_nop 0
    buffer_load_dwordx4 v143, s[48:51], s100 offen lds
    s_add_u32 m0, s98, 32768
    s_cmp_lt_u32 s8, 2
    s_cbranch_scc0 L_B_ex28
    buffer_load_dwordx4 v144, s[48:51], s100 offen lds
L_B_ex28:
    s_add_u32 s99, s99, 128
    s_add_u32 s100, s100, s101
    v_mov_b32 v210, 0
    global_load_dword v211, v210, s[6:7] sc1
    s_lshl_b32 s16, s13, 2
    v_add_u32 v20, s16, v3
    v_lshrrev_b32 v21, 1, v2
    v_xor_b32 v20, v20, v21
    v_lshlrev_b32 v20, 4, v20
    v_lshl_add_u32 v20, v2, 7, v20
    s_lshl_b32 s17, s13, 11
    s_add_u32 s18, s17, 36864
    v_add_u32 v7, s18, v20
    s_xor_b32 s17, s17, 2048
    s_add_u32 s18, s17, 36864
    v_add_u32 v8, s18, v20
    s_lshl_b32 s16, s13, 5
    v_lshrrev_b32 v20, 2, v2
    v_lshl_add_u32 v20, v3, 2, v20
    v_add_u32 v20, s16, v20
    v_and_b32 v21, 3, v2
    v_lshlrev_b32 v21, 3, v21
    v_lshl_add_u32 v9, v20, 5, v21
    s_lshl_b32 s17, s14, 11
    s_add_u32 s17, s17, 73728
    v_add_u32 v9, s17, v9
    s_lshl_b32 s16, s13, 6
    s_add_u32 s16, s16, 147456
    v_lshlrev_b32 v10, 4, v3
    v_add_u32 v10, s16, v10
    v_add_u32 v11, 40960, v9
    s_waitcnt vmcnt(5)
    s_barrier
    ds_read_b128 v[36:39], v7 offset:0
    ds_read_b128 v[40:43], v8 offset:0
    ds_read_b64_tr_b16 v[44:45], v9 offset:0
    ds_read_b64_tr_b16 v[46:47], v9 offset:512
    ds_read_b128 v[48:51], v10 offset:0
    s_waitcnt lgkmcnt(0)
    v_mfma_f32_16x16x32_bf16 v[72:75], v[44:47], v[36:39], 0
    ds_read_b128 v[56:59], v7 offset:4096
    ds_read_b128 v[60:63], v8 offset:4096
    v_mfma_f32_16x16x32_bf16 v[80:83], v[44:47], v[40:43], 0
    ds_read_b64_tr_b16 v[64:65], v9 offset:8192
    ds_read_b64_tr_b16 v[66:67], v9 offset:8704
    v_mfma_f32_16x16x32_bf16 v[76:79], v[48:51], v[36:39], 0
    ds_read_b128 v[68:71], v10 offset:128
    v_mfma_f32_16x16x32_bf16 v[84:87], v[48:51], v[40:43], 0
    s_waitcnt lgkmcnt(0)
    v_mfma_f32_16x16x32_bf16 v[72:75], v[64:67], v[56:59], v[72:75]
    ds_read_b128 v[36:39], v7 offset:8192
    ds_read_b128 v[40:43], v8 offset:8192
    v_mfma_f32_16x16x32_bf16 v[80:83], v[64:67], v[60:63], v[80:83]
    ds_read_b64_tr_b16 v[44:45], v9 offset:16384
    ds_read_b64_tr_b16 v[46:47], v9 offset:16896
    v_mfma_f32_16x16x32_bf16 v[76:79], v[68:71], v[56:59], v[76:79]
    ds_read_b128 v[48:51], v10 offset:256
    v_mfma_f32_16x16x32_bf16 v[84:87], v[68:71], v[60:63], v[84:87]
    s_waitcnt lgkmcnt(0)
    v_mfma_f32_16x16x32_bf16 v[72:75], v[44:47], v[36:39], v[72:75]
    ds_read_b128 v[56:59], v7 offset:12288
    ds_read_b128 v[60:63], v8 offset:12288
    v_mfma_f32_16x16x32_bf16 v[80:83], v[44:47], v[40:43], v[80:83]
    ds_read_b64_tr_b16 v[64:65], v9 offset:24576
    ds_read_b64_tr_b16 v[66:67], v9 offset:25088
    v_mfma_f32_16x16x32_bf16 v[76:79], v[48:51], v[36:39], v[76:79]
    ds_read_b128 v[68:71], v10 offset:384
    v_mfma_f32_16x16x32_bf16 v[84:87], v[48:51], v[40:43], v[84:87]
    s_waitcnt lgkmcnt(0)
    v_mfma_f32_16x16x32_bf16 v[72:75], v[64:67], v[56:59], v[72:75]
    ds_read_b128 v[36:39], v7 offset:16384
    ds_read_b128 v[40:43], v8 offset:16384
    v_mfma_f32_16x16x32_bf16 v[80:83], v[64:67], v[60:63], v[80:83]
    ds_read_b64_tr_b16 v[44:45], v9 offset:32768
    ds_read_b64_tr_b16 v[46:47], v9 offset:33280
    v_mfma_f32_16x16x32_bf16 v[76:79], v[68:71], v[56:59], v[76:79]
    ds_read_b128 v[48:51], v10 offset:512
    v_mfma_f32_16x16x32_bf16 v[84:87], v[68:71], v[60:63], v[84:87]
    s_waitcnt lgkmcnt(0)
    v_mfma_f32_16x16x32_bf16 v[72:75], v[44:47], v[36:39], v[72:75]
    ds_read_b128 v[56:59], v7 offset:20480
    ds_read_b128 v[60:63], v8 offset:20480
    v_mfma_f32_16x16x32_bf16 v[80:83], v[44:47], v[40:43], v[80:83]
    ds_read_b64_tr_b16 v[64:65], v11 offset:0
    ds_read_b64_tr_b16 v[66:67], v11 offset:512
    v_mfma_f32_16x16x32_bf16 v[76:79], v[48:51], v[36:39], v[76:79]
    ds_read_b128 v[68:71], v10 offset:640
    v_mfma_f32_16x16x32_bf16 v[84:87], v[48:51], v[40:43], v[84:87]
    s_waitcnt lgkmcnt(0)
    v_mfma_f32_16x16x32_bf16 v[72:75], v[64:67], v[56:59], v[72:75]
    ds_read_b128 v[36:39], v7 offset:24576
    ds_read_b128 v[40:43], v8 offset:24576
    v_mfma_f32_16x16x32_bf16 v[80:83], v[64:67], v[60:63], v[80:83]
    ds_read_b64_tr_b16 v[44:45], v11 offset:8192
    ds_read_b64_tr_b16 v[46:47], v11 offset:8704
    v_mfma_f32_16x16x32_bf16 v[76:79], v[68:71], v[56:59], v[76:79]
    ds_read_b128 v[48:51], v10 offset:768
    v_mfma_f32_16x16x32_bf16 v[84:87], v[68:71], v[60:63], v[84:87]
    s_waitcnt lgkmcnt(0)
    v_mfma_f32_16x16x32_bf16 v[72:75], v[44:47], v[36:39], v[72:75]
    ds_read_b128 v[56:59], v7 offset:28672
    ds_read_b128 v[60:63], v8 offset:28672
    v_mfma_f32_16x16x32_bf16 v[80:83], v[44:47], v[40:43], v[80:83]
    ds_read_b64_tr_b16 v[64:65], v11 offset:16384
    ds_read_b64_tr_b16 v[66:67], v11 offset:16896
    v_mfma_f32_16x16x32_bf16 v[76:79], v[48:51], v[36:39], v[76:79]
    ds_read_b128 v[68:71], v10 offset:896
    v_mfma_f32_16x16x32_bf16 v[84:87], v[48:51], v[40:43], v[84:87]
    s_waitcnt lgkmcnt(0)
    v_mfma_f32_16x16x32_bf16 v[72:75], v[64:67], v[56:59], v[72:75]
    ds_read_b128 v[36:39], v7 offset:32768
    ds_read_b128 v[40:43], v8 offset:32768
    v_mfma_f32_16x16x32_bf16 v[80:83], v[64:67], v[60:63], v[80:83]
    ds_read_b64_tr_b16 v[44:45], v11 offset:24576
    ds_read_b64_tr_b16 v[46:47], v11 offset:25088
    v_mfma_f32_16x16x32_bf16 v[76:79], v[68:71], v[56:59], v[76:79]
    ds_read_b128 v[48:51], v10 offset:1024
    v_mfma_f32_16x16x32_bf16 v[84:87], v[68:71], v[60:63], v[84:87]
    s_waitcnt lgkmcnt(0)
    v_mfma_f32_16x16x32_bf16 v[72:75], v[44:47], v[36:39], v[72:75]
    v_mfma_f32_16x16x32_bf16 v[80:83], v[44:47], v[40:43], v[80:83]
    v_mfma_f32_16x16x32_bf16 v[76:79], v[48:51], v[36:39], v[76:79]
    v_mfma_f32_16x16x32_bf16 v[84:87], v[48:51], v[40:43], v[84:87]
    s_barrier
    s_add_u32 m0, s96, 34816
    s_nop 0
    buffer_load_dwordx4 v134, s[44:47], s99 offen lds
    s_add_u32 m0, s96, 35840
    s_nop 0
    buffer_load_dwordx4 v135, s[44:47], s99 offen lds
    s_add_u32 m0, s97, 51200
    s_nop 0
    buffer_load_dwordx4 v136, s[48:51], s100 offen lds
    s_add_u32 m0, s97, 52224
    s_nop 0
    buffer_load_dwordx4 v143, s[48:51], s100 offen lds
    s_add_u32 m0, s98, 67584
    s_cmp_lt_u32 s8, 2
    s_cbranch_scc0 L_B_ex29
    buffer_load_dwordx4 v144, s[48:51], s100 offen lds
L_B_ex29:
    s_add_u32 s99, s99, 128
    s_add_u32 s100, s100, s101
    s_lshl_b32 s16, s8, 11
    s_add_u32 s16, s16, 73728
    s_xor_b32 s17, s8, 4
    s_lshl_b32 s17, s17, 11
    s_add_u32 s17, s17, 73728
    v_lshlrev_b32 v20, 4, v1
    v_add_u32 v21, s17, v20
    v_add_u32 v20, s16, v20
    s_nop 1
    ds_write_b128 v20, v[80:83] offset:0
    ds_write_b128 v20, v[84:87] offset:1024
    s_waitcnt lgkmcnt(0)
    s_barrier
    ds_read_b128 v[80:83], v21 offset:0
    ds_read_b128 v[84:87], v21 offset:1024
    s_waitcnt lgkmcnt(0)
    v_add_f32 v72, v72, v80
    v_add_f32 v73, v73, v81
    v_add_f32 v74, v74, v82
    v_add_f32 v75, v75, v83
    v_add_f32 v76, v76, v84
    v_add_f32 v77, v77, v85
    v_add_f32 v78, v78, v86
    v_add_f32 v79, v79, v87
    s_waitcnt vmcnt(4)
    s_mov_b32 s21, 0
L_non4:
    v_readfirstlane_b32 s3, v211
    s_add_u32 s21, s21, 1
    s_cmp_lg_u32 s3, 0
    s_cbranch_scc1 L_non4_ok
    s_sleep 8
    global_load_dword v211, v210, s[6:7] sc1
    s_waitcnt vmcnt(0)
    s_cmp_lt_u32 s21, 0x40000
    s_cbranch_scc1 L_non4
L_non4_ok:
    s_lshr_b32 s18, s23, 3
    s_mul_i32 s18, s18, 19968
    s_add_u32 s18, s18, 0x480000
    s_and_b32 s19, s23, 7
    s_lshl_b32 s20, s13, 4
    v_add_u32 v29, s20, v2
    s_cmp_eq_u32 s14, 0
    s_cbranch_scc1 L_M_p0
    s_cmp_eq_u32 s14, 1
    s_cbranch_scc1 L_M_p1
    s_mul_i32 s16, s19, 1216
    s_add_u32 s16, s16, s18
    s_mul_i32 s17, s13, 608
    s_add_u32 s16, s16, s17
    s_add_u32 s16, s16, 10240
    s_add_u32 s76, s4, s16
    s_addc_u32 s77, s5, 0
    v_bfe_u32 v20, v2, 2, 1
    v_mul_u32_u24 v20, 304, v20
    v_and_b32 v21, 3, v2
    v_lshrrev_b32 v22, 3, v2
    v_lshl_add_u32 v21, v22, 2, v21
    v_lshl_add_u32 v20, v21, 1, v20
    s_cmp_eq_u32 s14, 3
    s_cbranch_scc1 L_M_p3
    v_lshl_add_u32 v20, v3, 6, v20
    v_cvt_pk_bf16_f32 v21, v72, v73
    v_cvt_pk_bf16_f32 v22, v74, v75
    global_store_short v20, v21, s[76:77] sc1
    global_store_short_d16_hi v20, v21, s[76:77] offset:16 sc1
    global_store_short v20, v22, s[76:77] offset:32 sc1
    global_store_short_d16_hi v20, v22, s[76:77] offset:48 sc1
    s_branch L_M_end
L_M_p3:
    v_cvt_pk_bf16_f32 v21, v72, v73
    v_mov_b32 v22, 0x3f80
    s_mov_b32 exec_lo, 0xffff
    s_mov_b32 exec_hi, 0
    global_store_short v20, v21, s[76:77] offset:256 sc1
    global_store_short_d16_hi v20, v21, s[76:77] offset:272 sc1
    global_store_short v20, v22, s[76:77] offset:288 sc1
    s_mov_b64 exec, -1
    s_branch L_M_end
L_M_p0:
    s_lshl_b32 s16, s19, 10
    s_add_u32 s16, s16, s18
    s_add_u32 s76, s4, s16
    s_addc_u32 s77, s5, 0
    v_lshrrev_b32 v20, 1, v3
    v_lshl_add_u32 v20, v20, 5, v29
    v_lshlrev_b32 v20, 4, v20
    v_and_b32 v21, 1, v3
    v_lshl_add_u32 v20, v21, 3, v20
    v_mul_f32 v24, v72, v72
    v_fmac_f32 v24, v73, v73
    v_fmac_f32 v24, v74, v74
    v_fmac_f32 v24, v75, v75
    v_cvt_pk_bf16_f32 v22, v72, v73
    v_cvt_pk_bf16_f32 v23, v74, v75
    global_store_dwordx2 v20, v[22:23], s[76:77] sc1
    v_mov_b32 v25, v24
    s_nop 1
    v_permlane32_swap_b32 v24, v25
    s_nop 1
    v_add_f32 v24, v24, v25
    v_mov_b32 v25, v24
    s_nop 1
    v_permlane16_swap_b32 v24, v25
    s_nop 1
    v_add_f32 v24, v24, v25
    s_mov_b32 s20, 0
    s_branch L_M_pmax
L_M_p1:
    s_lshl_b32 s16, s19, 8
    s_add_u32 s16, s16, s18
    s_add_u32 s16, s16, 8192
    s_add_u32 s76, s4, s16
    s_addc_u32 s77, s5, 0
    v_lshlrev_b32 v20, 3, v29
    v_cvt_pk_bf16_f32 v22, v72, v73
    v_mov_b32 v23, 0x3f803f80
    v_mul_f32 v24, v72, v72
    v_fmac_f32 v24, v73, v73
    v_mul_f32 v25, 0xbfb8aa3b, v76
    v_exp_f32 v25, v25
    s_nop 0
    v_add_f32 v25, 1.0, v25
    v_rcp_f32 v25, v25
    s_mov_b32 exec_lo, 0xffff
    s_mov_b32 exec_hi, 0
    global_store_dwordx2 v20, v[22:23], s[76:77] sc1
    s_lshl_b32 s16, s23, 7
    s_add_u32 s16, s16, 0x4a9000
    s_add_u32 s76, s4, s16
    s_addc_u32 s77, s5, 0
    v_lshlrev_b32 v20, 2, v29
    global_store_dword v20, v25, s[76:77] sc1
    s_mov_b64 exec, -1
    s_mov_b32 s20, 16384
L_M_pmax:
    s_nop 1
    v_max_f32_dpp v24, v24, v24 row_ror:1 row_mask:0xf bank_mask:0xf
    s_nop 1
    v_max_f32_dpp v24, v24, v24 row_ror:2 row_mask:0xf bank_mask:0xf
    s_nop 1
    v_max_f32_dpp v24, v24, v24 row_ror:4 row_mask:0xf bank_mask:0xf
    s_nop 1
    v_max_f32_dpp v24, v24, v24 row_ror:8 row_mask:0xf bank_mask:0xf
    s_lshl_b32 s16, s23, 1
    s_add_u32 s16, s16, s13
    s_lshl_b32 s16, s16, 7
    s_add_u32 s16, s16, s20
    s_add_u32 s16, s16, 0xd10000
    v_mov_b32 v20, s16
    s_mov_b32 exec_lo, 1
    s_mov_b32 exec_hi, 0
    global_store_dword v20, v24, s[4:5] sc1
    s_mov_b64 exec, -1
L_M_end:
    v_and_b32 v4, 31, v1
    v_lshrrev_b32 v5, 5, v1
    v_lshlrev_b32 v6, 4, v1
    s_lshl_b32 s16, s14, 1
    s_lshl_b32 s54, s12, 3
    s_add_u32 s54, s54, s16
    s_add_u32 s55, s54, s13
    s_mov_b32 s64, -1
    s_mov_b32 s65, 0
    s_mov_b32 s66, 0x7ffff
    s_mov_b32 s67, 0x7ffff
    v_mov_b32 v242, -1
    v_mov_b32 v243, 0
    s_add_u32 s62, s4, 0x4b0000
    s_addc_u32 s63, s5, 0
    s_add_u32 s16, s8, 0
    s_lshl_b32 s24, s16, 10
    s_mov_b32 s29, s24
    s_cmp_ge_u32 s16, 20
    s_cselect_b32 s17, 59392, 0
    s_add_u32 s24, s24, s17
    s_cmp_ge_u32 s16, 20
    s_cselect_b32 s17, 4294966784, 0
    s_add_u32 s29, s29, s17
    s_add_u32 s16, s8, 8
    s_lshl_b32 s25, s16, 10
    s_mov_b32 s30, s25
    s_cmp_ge_u32 s16, 20
    s_cselect_b32 s17, 59392, 0
    s_add_u32 s25, s25, s17
    s_cmp_ge_u32 s16, 20
    s_cselect_b32 s17, 4294966784, 0
    s_add_u32 s30, s30, s17
    s_add_u32 s16, s8, 16
    s_lshl_b32 s26, s16, 10
    s_mov_b32 s31, s26
    s_cmp_ge_u32 s16, 20
    s_cselect_b32 s17, 59392, 0
    s_add_u32 s26, s26, s17
    s_cmp_ge_u32 s16, 20
    s_cselect_b32 s17, 4294966784, 0
    s_add_u32 s31, s31, s17
    s_add_u32 s16, s8, 24
    s_lshl_b32 s27, s16, 10
    s_mov_b32 s36, s27
    s_cmp_ge_u32 s16, 20
    s_cselect_b32 s17, 59392, 0
    s_add_u32 s27, s27, s17
    s_cmp_ge_u32 s16, 20
    s_cselect_b32 s17, 4294966784, 0
    s_add_u32 s36, s36, s17
    s_add_u32 s16, s8, 32
    s_lshl_b32 s28, s16, 10
    s_mov_b32 s37, s28
    s_cmp_ge_u32 s16, 20
    s_cselect_b32 s17, 59392, 0
    s_add_u32 s28, s28, s17
    s_cmp_ge_u32 s16, 20
    s_cselect_b32 s17, 4294966784, 0
    s_add_u32 s37, s37, s17
    s_add_u32 s16, s4, 0x480000
    s_addc_u32 s17, s5, 0
    s_mov_b32 s32, s16
    s_and_b32 s33, s17, 0xffff
    s_mov_b32 s34, 163840
    s_mov_b32 s35, 0x20000
    s_mul_i32 s16, s11, 73728
    s_add_u32 s16, s16, 0x890000
    s_lshr_b32 s17, s55, 1
    s_lshl_b32 s17, s17, 10
    s_and_b32 s18, s55, 1
    s_lshl_b32 s18, s18, 9
    s_add_u32 s17, s17, s18
    s_add_u32 s17, s17, s16
    s_add_u32 s56, s4, s17
    s_addc_u32 s57, s5, 0
    s_lshr_b32 s17, s55, 4
    s_add_u32 s17, s17, 16
    s_lshl_b32 s17, s17, 10
    s_lshr_b32 s18, s55, 2
    s_and_b32 s18, s18, 3
    s_lshl_b32 s18, s18, 8
    s_add_u32 s17, s17, s18
    s_and_b32 s18, s55, 3
    s_lshl_b32 s18, s18, 2
    s_add_u32 s17, s17, s18
    s_add_u32 s17, s17, s16
    s_add_u32 s58, s4, s17
    s_addc_u32 s59, s5, 0
    v_lshrrev_b32 v16, 4, v4
    v_mul_u32_u24 v16, 36864, v16
    v_and_b32 v7, 15, v4
    v_lshl_add_u32 v7, v7, 4, v16
    s_cmp_eq_u32 s13, 0
    s_cbranch_scc0 L_B_q1
    s_barrier
    v_add_u32 v140, 0, v137
    v_add_u32 v141, 0, v138
    v_add_u32 v142, 0, v139
    ds_read_b128 v[36:39], v140 offset:0
    ds_read_b128 v[40:43], v140 offset:2048
    ds_read_b64_tr_b16 v[52:53], v142 offset:0
    ds_read_b64_tr_b16 v[54:55], v142 offset:4608
    ds_read_b64_tr_b16 v[56:57], v142 offset:32
    ds_read_b64_tr_b16 v[58:59], v142 offset:4640
    ds_read_b64_tr_b16 v[60:61], v142 offset:160
    ds_read_b64_tr_b16 v[62:63], v142 offset:4768
    ds_read_b64_tr_b16 v[64:65], v142 offset:192
    ds_read_b64_tr_b16 v[66:67], v142 offset:4800
    ds_read_b64_tr_b16 v[68:69], v142 offset:224
    ds_read_b64_tr_b16 v[70:71], v142 offset:4832
    s_waitcnt lgkmcnt(0)
    v_mfma_f32_16x16x32_bf16 v[92:95], v[52:55], v[36:39], 0
    ds_read_b128 v[44:47], v141 offset:0
    ds_read_b128 v[48:51], v141 offset:2048
    ds_read_b64_tr_b16 v[72:73], v142 offset:9216
    v_mfma_f32_16x16x32_bf16 v[112:115], v[52:55], v[40:43], 0
    ds_read_b64_tr_b16 v[74:75], v142 offset:13824
    ds_read_b64_tr_b16 v[76:77], v142 offset:9248
    ds_read_b64_tr_b16 v[78:79], v142 offset:13856
    v_mfma_f32_16x16x32_bf16 v[96:99], v[56:59], v[36:39], 0
    ds_read_b64_tr_b16 v[80:81], v142 offset:9376
    ds_read_b64_tr_b16 v[82:83], v142 offset:13984
    ds_read_b64_tr_b16 v[84:85], v142 offset:9408
    s_add_u32 m0, s96, 69632
    v_mfma_f32_16x16x32_bf16 v[116:119], v[56:59], v[40:43], 0
    ds_read_b64_tr_b16 v[86:87], v142 offset:14016
    ds_read_b64_tr_b16 v[88:89], v142 offset:9440
    ds_read_b64_tr_b16 v[90:91], v142 offset:14048
    buffer_load_dwordx4 v134, s[44:47], s99 offen lds
    v_mfma_f32_16x16x32_bf16 v[100:103], v[60:63], v[36:39], 0
    s_add_u32 m0, s96, 70656
    v_mfma_f32_16x16x32_bf16 v[120:123], v[60:63], v[40:43], 0
    buffer_load_dwordx4 v135, s[44:47], s99 offen lds
    v_mfma_f32_16x16x32_bf16 v[104:107], v[64:67], v[36:39], 0
    s_add_u32 m0, s97, 86016
    v_mfma_f32_16x16x32_bf16 v[124:127], v[64:67], v[40:43], 0
    buffer_load_dwordx4 v136, s[48:51], s100 offen lds
    v_mfma_f32_16x16x32_bf16 v[108:111], v[68:71], v[36:39], 0
    s_add_u32 m0, s97, 87040
    v_mfma_f32_16x16x32_bf16 v[128:131], v[68:71], v[40:43], 0
    buffer_load_dwordx4 v143, s[48:51], s100 offen lds
    s_add_u32 m0, s98, 102400
    s_cmp_lt_u32 s8, 2
    s_cbranch_scc0 L_B_ex30
    buffer_load_dwordx4 v144, s[48:51], s100 offen lds
L_B_ex30:
    s_add_u32 s99, s99, 128
    s_add_u32 s100, s100, s101
    s_add_u32 m0, s96, 104448
    s_nop 0
    buffer_load_dwordx4 v134, s[44:47], s99 offen lds
    s_add_u32 m0, s96, 105472
    s_nop 0
    buffer_load_dwordx4 v135, s[44:47], s99 offen lds
    s_add_u32 m0, s97, 120832
    s_nop 0
    buffer_load_dwordx4 v136, s[48:51], s100 offen lds
    s_add_u32 m0, s97, 121856
    s_nop 0
    buffer_load_dwordx4 v143, s[48:51], s100 offen lds
    s_add_u32 m0, s98, 137216
    s_cmp_lt_u32 s8, 2
    s_cbranch_scc0 L_B_ex31
    buffer_load_dwordx4 v144, s[48:51], s100 offen lds
L_B_ex31:
    s_add_u32 s99, s99, 128
    s_add_u32 s100, s100, s101
    s_waitcnt vmcnt(9)
    s_waitcnt vmcnt(8)
    s_waitcnt lgkmcnt(0)
    s_barrier
    s_lshl_b32 s16, s23, 7
    s_add_u32 s16, s16, 0xf10000
    v_mov_b32 v16, s16
    v_mov_b32 v17, s3
    s_cmp_eq_u32 s8, 0
    s_cselect_b32 exec_lo, 1, 0
    s_mov_b32 exec_hi, 0
    global_store_dword v16, v17, s[4:5] sc1
    s_mov_b64 exec, -1
    v_add_u32 v140, 34816, v137
    v_add_u32 v141, 34816, v138
    v_add_u32 v142, 34816, v139
    v_mfma_f32_16x16x32_bf16 v[92:95], v[72:75], v[44:47], v[92:95]
    ds_read_b128 v[36:39], v140 offset:0
    ds_read_b128 v[40:43], v140 offset:2048
    ds_read_b64_tr_b16 v[52:53], v142 offset:0
    v_mfma_f32_16x16x32_bf16 v[112:115], v[72:75], v[48:51], v[112:115]
    ds_read_b64_tr_b16 v[54:55], v142 offset:4608
    ds_read_b64_tr_b16 v[56:57], v142 offset:32
    ds_read_b64_tr_b16 v[58:59], v142 offset:4640
    v_mfma_f32_16x16x32_bf16 v[96:99], v[76:79], v[44:47], v[96:99]
    ds_read_b64_tr_b16 v[60:61], v142 offset:160
    ds_read_b64_tr_b16 v[62:63], v142 offset:4768
    ds_read_b64_tr_b16 v[64:65], v142 offset:192
    s_add_u32 m0, s96, 0
    v_mfma_f32_16x16x32_bf16 v[116:119], v[76:79], v[48:51], v[116:119]
    ds_read_b64_tr_b16 v[66:67], v142 offset:4800
    ds_read_b64_tr_b16 v[68:69], v142 offset:224
    ds_read_b64_tr_b16 v[70:71], v142 offset:4832
    buffer_load_dwordx4 v134, s[44:47], s99 offen lds
    v_mfma_f32_16x16x32_bf16 v[100:103], v[80:83], v[44:47], v[100:103]
    s_add_u32 m0, s96, 1024
    v_mfma_f32_16x16x32_bf16 v[120:123], v[80:83], v[48:51], v[120:123]
    buffer_load_dwordx4 v135, s[44:47], s99 offen lds
    v_mfma_f32_16x16x32_bf16 v[104:107], v[84:87], v[44:47], v[104:107]
    s_add_u32 m0, s97, 16384
    v_mfma_f32_16x16x32_bf16 v[124:127], v[84:87], v[48:51], v[124:127]
    buffer_load_dwordx4 v136, s[48:51], s100 offen lds
    v_mfma_f32_16x16x32_bf16 v[108:111], v[88:91], v[44:47], v[108:111]
    v_mfma_f32_16x16x32_bf16 v[128:131], v[88:91], v[48:51], v[128:131]
    s_waitcnt lgkmcnt(0)
    v_mfma_f32_16x16x32_bf16 v[92:95], v[52:55], v[36:39], v[92:95]
    ds_read_b128 v[44:47], v141 offset:0
    ds_read_b128 v[48:51], v141 offset:2048
    ds_read_b64_tr_b16 v[72:73], v142 offset:9216
    v_mfma_f32_16x16x32_bf16 v[112:115], v[52:55], v[40:43], v[112:115]
    ds_read_b64_tr_b16 v[74:75], v142 offset:13824
    ds_read_b64_tr_b16 v[76:77], v142 offset:9248
    ds_read_b64_tr_b16 v[78:79], v142 offset:13856
    v_mfma_f32_16x16x32_bf16 v[96:99], v[56:59], v[36:39], v[96:99]
    ds_read_b64_tr_b16 v[80:81], v142 offset:9376
    ds_read_b64_tr_b16 v[82:83], v142 offset:13984
    ds_read_b64_tr_b16 v[84:85], v142 offset:9408
    s_add_u32 m0, s97, 17408
    v_mfma_f32_16x16x32_bf16 v[116:119], v[56:59], v[40:43], v[116:119]
    ds_read_b64_tr_b16 v[86:87], v142 offset:14016
    ds_read_b64_tr_b16 v[88:89], v142 offset:9440
    ds_read_b64_tr_b16 v[90:91], v142 offset:14048
    buffer_load_dwordx4 v143, s[48:51], s100 offen lds
    v_mfma_f32_16x16x32_bf16 v[100:103], v[60:63], v[36:39], v[100:103]
    s_add_u32 m0, s98, 32768
    s_cmp_lt_u32 s8, 2
    s_cbranch_scc0 L_B_ex32
    buffer_load_dwordx4 v144, s[48:51], s100 offen lds
L_B_ex32:
    s_add_u32 s99, s99, 128
    s_add_u32 s100, s100, s101
    v_mfma_f32_16x16x32_bf16 v[120:123], v[60:63], v[40:43], v[120:123]
    v_mfma_f32_16x16x32_bf16 v[104:107], v[64:67], v[36:39], v[104:107]
    v_mfma_f32_16x16x32_bf16 v[124:127], v[64:67], v[40:43], v[124:127]
    v_mfma_f32_16x16x32_bf16 v[108:111], v[68:71], v[36:39], v[108:111]
    v_mfma_f32_16x16x32_bf16 v[128:131], v[68:71], v[40:43], v[128:131]
    s_waitcnt vmcnt(9)
    s_waitcnt lgkmcnt(0)
    s_barrier
    v_add_u32 v140, 69632, v137
    v_add_u32 v141, 69632, v138
    v_add_u32 v142, 69632, v139
    v_mfma_f32_16x16x32_bf16 v[92:95], v[72:75], v[44:47], v[92:95]
    ds_read_b128 v[36:39], v140 offset:0
    ds_read_b128 v[40:43], v140 offset:2048
    ds_read_b64_tr_b16 v[52:53], v142 offset:0
    v_mfma_f32_16x16x32_bf16 v[112:115], v[72:75], v[48:51], v[112:115]
    ds_read_b64_tr_b16 v[54:55], v142 offset:4608
    ds_read_b64_tr_b16 v[56:57], v142 offset:32
    ds_read_b64_tr_b16 v[58:59], v142 offset:4640
    v_mfma_f32_16x16x32_bf16 v[96:99], v[76:79], v[44:47], v[96:99]
    ds_read_b64_tr_b16 v[60:61], v142 offset:160
    ds_read_b64_tr_b16 v[62:63], v142 offset:4768
    ds_read_b64_tr_b16 v[64:65], v142 offset:192
    s_add_u32 m0, s96, 34816
    v_mfma_f32_16x16x32_bf16 v[116:119], v[76:79], v[48:51], v[116:119]
    ds_read_b64_tr_b16 v[66:67], v142 offset:4800
    ds_read_b64_tr_b16 v[68:69], v142 offset:224
    ds_read_b64_tr_b16 v[70:71], v142 offset:4832
    buffer_load_dwordx4 v134, s[44:47], s99 offen lds
    v_mfma_f32_16x16x32_bf16 v[100:103], v[80:83], v[44:47], v[100:103]
    s_add_u32 m0, s96, 35840
    v_mfma_f32_16x16x32_bf16 v[120:123], v[80:83], v[48:51], v[120:123]
    buffer_load_dwordx4 v135, s[44:47], s99 offen lds
    v_mfma_f32_16x16x32_bf16 v[104:107], v[84:87], v[44:47], v[104:107]
    s_add_u32 m0, s97, 51200
    v_mfma_f32_16x16x32_bf16 v[124:127], v[84:87], v[48:51], v[124:127]
    buffer_load_dwordx4 v136, s[48:51], s100 offen lds
    v_mfma_f32_16x16x32_bf16 v[108:111], v[88:91], v[44:47], v[108:111]
    v_mfma_f32_16x16x32_bf16 v[128:131], v[88:91], v[48:51], v[128:131]
    s_waitcnt lgkmcnt(0)
    v_mfma_f32_16x16x32_bf16 v[92:95], v[52:55], v[36:39], v[92:95]
    ds_read_b128 v[44:47], v141 offset:0
    ds_read_b128 v[48:51], v141 offset:2048
    ds_read_b64_tr_b16 v[72:73], v142 offset:9216
    v_mfma_f32_16x16x32_bf16 v[112:115], v[52:55], v[40:43], v[112:115]
    ds_read_b64_tr_b16 v[74:75], v142 offset:13824
    ds_read_b64_tr_b16 v[76:77], v142 offset:9248
    ds_read_b64_tr_b16 v[78:79], v142 offset:13856
    v_mfma_f32_16x16x32_bf16 v[96:99], v[56:59], v[36:39], v[96:99]
    ds_read_b64_tr_b16 v[80:81], v142 offset:9376
    ds_read_b64_tr_b16 v[82:83], v142 offset:13984
    ds_read_b64_tr_b16 v[84:85], v142 offset:9408
    s_add_u32 m0, s97, 52224
    v_mfma_f32_16x16x32_bf16 v[116:119], v[56:59], v[40:43], v[116:119]
    ds_read_b64_tr_b16 v[86:87], v142 offset:14016
    ds_read_b64_tr_b16 v[88:89], v142 offset:9440
    ds_read_b64_tr_b16 v[90:91], v142 offset:14048
    buffer_load_dwordx4 v143, s[48:51], s100 offen lds
    v_mfma_f32_16x16x32_bf16 v[100:103], v[60:63], v[36:39], v[100:103]
    s_add_u32 m0, s98, 67584
    s_cmp_lt_u32 s8, 2
    s_cbranch_scc0 L_B_ex33
    buffer_load_dwordx4 v144, s[48:51], s100 offen lds
L_B_ex33:
    s_add_u32 s99, s99, 128
    s_add_u32 s100, s100, s101
    v_mfma_f32_16x16x32_bf16 v[120:123], v[60:63], v[40:43], v[120:123]
    v_mfma_f32_16x16x32_bf16 v[104:107], v[64:67], v[36:39], v[104:107]
    v_mfma_f32_16x16x32_bf16 v[124:127], v[64:67], v[40:43], v[124:127]
    v_mfma_f32_16x16x32_bf16 v[108:111], v[68:71], v[36:39], v[108:111]
    v_mfma_f32_16x16x32_bf16 v[128:131], v[68:71], v[40:43], v[128:131]
    s_waitcnt vmcnt(9)
    s_waitcnt lgkmcnt(0)
    s_barrier
    v_add_u32 v140, 104448, v137
    v_add_u32 v141, 104448, v138
    v_add_u32 v142, 104448, v139
    v_mfma_f32_16x16x32_bf16 v[92:95], v[72:75], v[44:47], v[92:95]
    ds_read_b128 v[36:39], v140 offset:0
    ds_read_b128 v[40:43], v140 offset:2048
    ds_read_b64_tr_b16 v[52:53], v142 offset:0
    v_mfma_f32_16x16x32_bf16 v[112:115], v[72:75], v[48:51], v[112:115]
    ds_read_b64_tr_b16 v[54:55], v142 offset:4608
    ds_read_b64_tr_b16 v[56:57], v142 offset:32
    ds_read_b64_tr_b16 v[58:59], v142 offset:4640
    v_mfma_f32_16x16x32_bf16 v[96:99], v[76:79], v[44:47], v[96:99]
    ds_read_b64_tr_b16 v[60:61], v142 offset:160
    ds_read_b64_tr_b16 v[62:63], v142 offset:4768
    ds_read_b64_tr_b16 v[64:65], v142 offset:192
    s_add_u32 m0, s96, 69632
    v_mfma_f32_16x16x32_bf16 v[116:119], v[76:79], v[48:51], v[116:119]
    ds_read_b64_tr_b16 v[66:67], v142 offset:4800
    ds_read_b64_tr_b16 v[68:69], v142 offset:224
    ds_read_b64_tr_b16 v[70:71], v142 offset:4832
    buffer_load_dwordx4 v134, s[44:47], s99 offen lds
    v_mfma_f32_16x16x32_bf16 v[100:103], v[80:83], v[44:47], v[100:103]
    s_add_u32 m0, s96, 70656
    v_mfma_f32_16x16x32_bf16 v[120:123], v[80:83], v[48:51], v[120:123]
    buffer_load_dwordx4 v135, s[44:47], s99 offen lds
    v_mfma_f32_16x16x32_bf16 v[104:107], v[84:87], v[44:47], v[104:107]
    s_add_u32 m0, s97, 86016
    v_mfma_f32_16x16x32_bf16 v[124:127], v[84:87], v[48:51], v[124:127]
    buffer_load_dwordx4 v136, s[48:51], s100 offen lds
    v_mfma_f32_16x16x32_bf16 v[108:111], v[88:91], v[44:47], v[108:111]
    v_mfma_f32_16x16x32_bf16 v[128:131], v[88:91], v[48:51], v[128:131]
    s_waitcnt lgkmcnt(0)
    v_mfma_f32_16x16x32_bf16 v[92:95], v[52:55], v[36:39], v[92:95]
    ds_read_b128 v[44:47], v141 offset:0
    ds_read_b128 v[48:51], v141 offset:2048
    ds_read_b64_tr_b16 v[72:73], v142 offset:9216
    v_mfma_f32_16x16x32_bf16 v[112:115], v[52:55], v[40:43], v[112:115]
    ds_read_b64_tr_b16 v[74:75], v142 offset:13824
    ds_read_b64_tr_b16 v[76:77], v142 offset:9248
    ds_read_b64_tr_b16 v[78:79], v142 offset:13856
    v_mfma_f32_16x16x32_bf16 v[96:99], v[56:59], v[36:39], v[96:99]
    ds_read_b64_tr_b16 v[80:81], v142 offset:9376
    ds_read_b64_tr_b16 v[82:83], v142 offset:13984
    ds_read_b64_tr_b16 v[84:85], v142 offset:9408
    s_add_u32 m0, s97, 87040
    v_mfma_f32_16x16x32_bf16 v[116:119], v[56:59], v[40:43], v[116:119]
    ds_read_b64_tr_b16 v[86:87], v142 offset:14016
    ds_read_b64_tr_b16 v[88:89], v142 offset:9440
    ds_read_b64_tr_b16 v[90:91], v142 offset:14048
    buffer_load_dwordx4 v143, s[48:51], s100 offen lds
    v_mfma_f32_16x16x32_bf16 v[100:103], v[60:63], v[36:39], v[100:103]
    s_add_u32 m0, s98, 102400
    s_cmp_lt_u32 s8, 2
    s_cbranch_scc0 L_B_ex34
    buffer_load_dwordx4 v144, s[48:51], s100 offen lds
L_B_ex34:
    s_add_u32 s99, s99, 128
    s_add_u32 s100, s100, s101
    v_mfma_f32_16x16x32_bf16 v[120:123], v[60:63], v[40:43], v[120:123]
    v_mfma_f32_16x16x32_bf16 v[104:107], v[64:67], v[36:39], v[104:107]
    v_mfma_f32_16x16x32_bf16 v[124:127], v[64:67], v[40:43], v[124:127]
    v_mfma_f32_16x16x32_bf16 v[108:111], v[68:71], v[36:39], v[108:111]
    v_mfma_f32_16x16x32_bf16 v[128:131], v[68:71], v[40:43], v[128:131]
    s_waitcnt vmcnt(8)
    s_waitcnt lgkmcnt(0)
    s_barrier
    v_add_u32 v140, 0, v137
    v_add_u32 v141, 0, v138
    v_add_u32 v142, 0, v139
    v_mfma_f32_16x16x32_bf16 v[92:95], v[72:75], v[44:47], v[92:95]
    ds_read_b128 v[36:39], v140 offset:0
    ds_read_b128 v[40:43], v140 offset:2048
    ds_read_b64_tr_b16 v[52:53], v142 offset:0
    v_mfma_f32_16x16x32_bf16 v[112:115], v[72:75], v[48:51], v[112:115]
    ds_read_b64_tr_b16 v[54:55], v142 offset:4608
    ds_read_b64_tr_b16 v[56:57], v142 offset:32
    ds_read_b64_tr_b16 v[58:59], v142 offset:4640
    v_mfma_f32_16x16x32_bf16 v[96:99], v[76:79], v[44:47], v[96:99]
    ds_read_b64_tr_b16 v[60:61], v142 offset:160
    ds_read_b64_tr_b16 v[62:63], v142 offset:4768
    ds_read_b64_tr_b16 v[64:65], v142 offset:192
    s_add_u32 m0, s96, 104448
    v_mfma_f32_16x16x32_bf16 v[116:119], v[76:79], v[48:51], v[116:119]
    ds_read_b64_tr_b16 v[66:67], v142 offset:4800
    ds_read_b64_tr_b16 v[68:69], v142 offset:224
    ds_read_b64_tr_b16 v[70:71], v142 offset:4832
    buffer_load_dwordx4 v134, s[44:47], s99 offen lds
    v_mfma_f32_16x16x32_bf16 v[100:103], v[80:83], v[44:47], v[100:103]
    s_add_u32 m0, s96, 105472
    v_mfma_f32_16x16x32_bf16 v[120:123], v[80:83], v[48:51], v[120:123]
    buffer_load_dwordx4 v135, s[44:47], s99 offen lds
    v_mfma_f32_16x16x32_bf16 v[104:107], v[84:87], v[44:47], v[104:107]
    s_add_u32 m0, s97, 120832
    v_mfma_f32_16x16x32_bf16 v[124:127], v[84:87], v[48:51], v[124:127]
    buffer_load_dwordx4 v136, s[48:51], s100 offen lds
    v_mfma_f32_16x16x32_bf16 v[108:111], v[88:91], v[44:47], v[108:111]
    v_mfma_f32_16x16x32_bf16 v[128:131], v[88:91], v[48:51], v[128:131]
    s_waitcnt lgkmcnt(0)
    v_mfma_f32_16x16x32_bf16 v[92:95], v[52:55], v[36:39], v[92:95]
    ds_read_b128 v[44:47], v141 offset:0
    ds_read_b128 v[48:51], v141 offset:2048
    ds_read_b64_tr_b16 v[72:73], v142 offset:9216
    v_mfma_f32_16x16x32_bf16 v[112:115], v[52:55], v[40:43], v[112:115]
    ds_read_b64_tr_b16 v[74:75], v142 offset:13824
    ds_read_b64_tr_b16 v[76:77], v142 offset:9248
    ds_read_b64_tr_b16 v[78:79], v142 offset:13856
    v_mfma_f32_16x16x32_bf16 v[96:99], v[56:59], v[36:39], v[96:99]
    ds_read_b64_tr_b16 v[80:81], v142 offset:9376
    ds_read_b64_tr_b16 v[82:83], v142 offset:13984
    ds_read_b64_tr_b16 v[84:85], v142 offset:9408
    s_add_u32 m0, s97, 121856
    v_mfma_f32_16x16x32_bf16 v[116:119], v[56:59], v[40:43], v[116:119]
    ds_read_b64_tr_b16 v[86:87], v142 offset:14016
    ds_read_b64_tr_b16 v[88:89], v142 offset:9440
    ds_read_b64_tr_b16 v[90:91], v142 offset:14048
    buffer_load_dwordx4 v143, s[48:51], s100 offen lds
    v_mfma_f32_16x16x32_bf16 v[100:103], v[60:63], v[36:39], v[100:103]
    s_add_u32 m0, s98, 137216
    s_cmp_lt_u32 s8, 2
    s_cbranch_scc0 L_B_ex35
    buffer_load_dwordx4 v144, s[48:51], s100 offen lds
L_B_ex35:
    s_add_u32 s99, s99, 128
    s_add_u32 s100, s100, s101
    v_mfma_f32_16x16x32_bf16 v[120:123], v[60:63], v[40:43], v[120:123]
    v_mfma_f32_16x16x32_bf16 v[104:107], v[64:67], v[36:39], v[104:107]
    v_mfma_f32_16x16x32_bf16 v[124:127], v[64:67], v[40:43], v[124:127]
    v_mfma_f32_16x16x32_bf16 v[108:111], v[68:71], v[36:39], v[108:111]
    v_mfma_f32_16x16x32_bf16 v[128:131], v[68:71], v[40:43], v[128:131]
    s_waitcnt vmcnt(8)
    s_waitcnt lgkmcnt(0)
    s_barrier
    v_lshlrev_b32 v236, 7, v1
    v_add_u32 v236, 0xf10000, v236
    s_cmp_lg_u32 s8, 0
    s_cbranch_scc1 L_pa_iBq0
    global_load_dword v232, v236, s[4:5] sc1
L_pa_iBq0:
    v_add_u32 v140, 34816, v137
    v_add_u32 v141, 34816, v138
    v_add_u32 v142, 34816, v139
    v_mfma_f32_16x16x32_bf16 v[92:95], v[72:75], v[44:47], v[92:95]
    ds_read_b128 v[36:39], v140 offset:0
    ds_read_b128 v[40:43], v140 offset:2048
    ds_read_b64_tr_b16 v[52:53], v142 offset:0
    v_mfma_f32_16x16x32_bf16 v[112:115], v[72:75], v[48:51], v[112:115]
    ds_read_b64_tr_b16 v[54:55], v142 offset:4608
    ds_read_b64_tr_b16 v[56:57], v142 offset:32
    ds_read_b64_tr_b16 v[58:59], v142 offset:4640
    v_mfma_f32_16x16x32_bf16 v[96:99], v[76:79], v[44:47], v[96:99]
    ds_read_b64_tr_b16 v[60:61], v142 offset:160
    ds_read_b64_tr_b16 v[62:63], v142 offset:4768
    ds_read_b64_tr_b16 v[64:65], v142 offset:192
    s_add_u32 m0, s96, 0
    v_mfma_f32_16x16x32_bf16 v[116:119], v[76:79], v[48:51], v[116:119]
    ds_read_b64_tr_b16 v[66:67], v142 offset:4800
    ds_read_b64_tr_b16 v[68:69], v142 offset:224
    ds_read_b64_tr_b16 v[70:71], v142 offset:4832
    buffer_load_dwordx4 v134, s[44:47], s99 offen lds
    v_mfma_f32_16x16x32_bf16 v[100:103], v[80:83], v[44:47], v[100:103]
    s_add_u32 m0, s96, 1024
    v_mfma_f32_16x16x32_bf16 v[120:123], v[80:83], v[48:51], v[120:123]
    buffer_load_dwordx4 v135, s[44:47], s99 offen lds
    v_mfma_f32_16x16x32_bf16 v[104:107], v[84:87], v[44:47], v[104:107]
    s_add_u32 m0, s97, 16384
    v_mfma_f32_16x16x32_bf16 v[124:127], v[84:87], v[48:51], v[124:127]
    buffer_load_dwordx4 v136, s[48:51], s100 offen lds
    v_mfma_f32_16x16x32_bf16 v[108:111], v[88:91], v[44:47], v[108:111]
    v_mfma_f32_16x16x32_bf16 v[128:131], v[88:91], v[48:51], v[128:131]
    s_waitcnt lgkmcnt(0)
    v_mfma_f32_16x16x32_bf16 v[92:95], v[52:55], v[36:39], v[92:95]
    ds_read_b128 v[44:47], v141 offset:0
    ds_read_b128 v[48:51], v141 offset:2048
    ds_read_b64_tr_b16 v[72:73], v142 offset:9216
    v_mfma_f32_16x16x32_bf16 v[112:115], v[52:55], v[40:43], v[112:115]
    ds_read_b64_tr_b16 v[74:75], v142 offset:13824
    ds_read_b64_tr_b16 v[76:77], v142 offset:9248
    ds_read_b64_tr_b16 v[78:79], v142 offset:13856
    v_mfma_f32_16x16x32_bf16 v[96:99], v[56:59], v[36:39], v[96:99]
    ds_read_b64_tr_b16 v[80:81], v142 offset:9376
    ds_read_b64_tr_b16 v[82:83], v142 offset:13984
    ds_read_b64_tr_b16 v[84:85], v142 offset:9408
    s_add_u32 m0, s97, 17408
    v_mfma_f32_16x16x32_bf16 v[116:119], v[56:59], v[40:43], v[116:119]
    ds_read_b64_tr_b16 v[86:87], v142 offset:14016
    ds_read_b64_tr_b16 v[88:89], v142 offset:9440
    ds_read_b64_tr_b16 v[90:91], v142 offset:14048
    buffer_load_dwordx4 v143, s[48:51], s100 offen lds
    v_mfma_f32_16x16x32_bf16 v[100:103], v[60:63], v[36:39], v[100:103]
    s_add_u32 m0, s98, 32768
    s_cmp_lt_u32 s8, 2
    s_cbranch_scc0 L_B_ex36
    buffer_load_dwordx4 v144, s[48:51], s100 offen lds
L_B_ex36:
    s_add_u32 s99, s99, 128
    s_add_u32 s100, s100, s101
    v_mfma_f32_16x16x32_bf16 v[120:123], v[60:63], v[40:43], v[120:123]
    v_mfma_f32_16x16x32_bf16 v[104:107], v[64:67], v[36:39], v[104:107]
    v_mfma_f32_16x16x32_bf16 v[124:127], v[64:67], v[40:43], v[124:127]
    v_mfma_f32_16x16x32_bf16 v[108:111], v[68:71], v[36:39], v[108:111]
    v_mfma_f32_16x16x32_bf16 v[128:131], v[68:71], v[40:43], v[128:131]
    s_waitcnt vmcnt(8)
    s_waitcnt lgkmcnt(0)
    s_barrier
    v_add_u32 v140, 69632, v137
    v_add_u32 v141, 69632, v138
    v_add_u32 v142, 69632, v139
    v_mfma_f32_16x16x32_bf16 v[92:95], v[72:75], v[44:47], v[92:95]
    ds_read_b128 v[36:39], v140 offset:0
    ds_read_b128 v[40:43], v140 offset:2048
    ds_read_b64_tr_b16 v[52:53], v142 offset:0
    v_mfma_f32_16x16x32_bf16 v[112:115], v[72:75], v[48:51], v[112:115]
    ds_read_b64_tr_b16 v[54:55], v142 offset:4608
    ds_read_b64_tr_b16 v[56:57], v142 offset:32
    ds_read_b64_tr_b16 v[58:59], v142 offset:4640
    v_mfma_f32_16x16x32_bf16 v[96:99], v[76:79], v[44:47], v[96:99]
    ds_read_b64_tr_b16 v[60:61], v142 offset:160
    ds_read_b64_tr_b16 v[62:63], v142 offset:4768
    ds_read_b64_tr_b16 v[64:65], v142 offset:192
    v_mfma_f32_16x16x32_bf16 v[116:119], v[76:79], v[48:51], v[116:119]
    ds_read_b64_tr_b16 v[66:67], v142 offset:4800
    ds_read_b64_tr_b16 v[68:69], v142 offset:224
    ds_read_b64_tr_b16 v[70:71], v142 offset:4832
    v_mfma_f32_16x16x32_bf16 v[100:103], v[80:83], v[44:47], v[100:103]
    v_mfma_f32_16x16x32_bf16 v[120:123], v[80:83], v[48:51], v[120:123]
    v_mfma_f32_16x16x32_bf16 v[104:107], v[84:87], v[44:47], v[104:107]
    v_mfma_f32_16x16x32_bf16 v[124:127], v[84:87], v[48:51], v[124:127]
    v_mfma_f32_16x16x32_bf16 v[108:111], v[88:91], v[44:47], v[108:111]
    v_mfma_f32_16x16x32_bf16 v[128:131], v[88:91], v[48:51], v[128:131]
    s_waitcnt lgkmcnt(0)
    v_mfma_f32_16x16x32_bf16 v[92:95], v[52:55], v[36:39], v[92:95]
    ds_read_b128 v[44:47], v141 offset:0
    ds_read_b128 v[48:51], v141 offset:2048
    ds_read_b64_tr_b16 v[72:73], v142 offset:9216
    v_mfma_f32_16x16x32_bf16 v[112:115], v[52:55], v[40:43], v[112:115]
    ds_read_b64_tr_b16 v[74:75], v142 offset:13824
    ds_read_b64_tr_b16 v[76:77], v142 offset:9248
    ds_read_b64_tr_b16 v[78:79], v142 offset:13856
    v_mfma_f32_16x16x32_bf16 v[96:99], v[56:59], v[36:39], v[96:99]
    ds_read_b64_tr_b16 v[80:81], v142 offset:9376
    ds_read_b64_tr_b16 v[82:83], v142 offset:13984
    ds_read_b64_tr_b16 v[84:85], v142 offset:9408
    v_mfma_f32_16x16x32_bf16 v[116:119], v[56:59], v[40:43], v[116:119]
    ds_read_b64_tr_b16 v[86:87], v142 offset:14016
    ds_read_b64_tr_b16 v[88:89], v142 offset:9440
    ds_read_b64_tr_b16 v[90:91], v142 offset:14048
    v_mfma_f32_16x16x32_bf16 v[100:103], v[60:63], v[36:39], v[100:103]
    v_mfma_f32_16x16x32_bf16 v[120:123], v[60:63], v[40:43], v[120:123]
    v_mfma_f32_16x16x32_bf16 v[104:107], v[64:67], v[36:39], v[104:107]
    v_mfma_f32_16x16x32_bf16 v[124:127], v[64:67], v[40:43], v[124:127]
    v_mfma_f32_16x16x32_bf16 v[108:111], v[68:71], v[36:39], v[108:111]
    v_mfma_f32_16x16x32_bf16 v[128:131], v[68:71], v[40:43], v[128:131]
    s_waitcnt vmcnt(4)
    s_waitcnt lgkmcnt(0)
    s_barrier
    v_add_u32 v140, 104448, v137
    v_add_u32 v141, 104448, v138
    v_add_u32 v142, 104448, v139
    v_mfma_f32_16x16x32_bf16 v[92:95], v[72:75], v[44:47], v[92:95]
    ds_read_b128 v[36:39], v140 offset:0
    ds_read_b128 v[40:43], v140 offset:2048
    ds_read_b64_tr_b16 v[52:53], v142 offset:0
    v_mfma_f32_16x16x32_bf16 v[112:115], v[72:75], v[48:51], v[112:115]
    ds_read_b64_tr_b16 v[54:55], v142 offset:4608
    ds_read_b64_tr_b16 v[56:57], v142 offset:32
    ds_read_b64_tr_b16 v[58:59], v142 offset:4640
    v_mfma_f32_16x16x32_bf16 v[96:99], v[76:79], v[44:47], v[96:99]
    ds_read_b64_tr_b16 v[60:61], v142 offset:160
    ds_read_b64_tr_b16 v[62:63], v142 offset:4768
    ds_read_b64_tr_b16 v[64:65], v142 offset:192
    v_mfma_f32_16x16x32_bf16 v[116:119], v[76:79], v[48:51], v[116:119]
    ds_read_b64_tr_b16 v[66:67], v142 offset:4800
    ds_read_b64_tr_b16 v[68:69], v142 offset:224
    ds_read_b64_tr_b16 v[70:71], v142 offset:4832
    v_mfma_f32_16x16x32_bf16 v[100:103], v[80:83], v[44:47], v[100:103]
    v_mfma_f32_16x16x32_bf16 v[120:123], v[80:83], v[48:51], v[120:123]
    v_mfma_f32_16x16x32_bf16 v[104:107], v[84:87], v[44:47], v[104:107]
    v_mfma_f32_16x16x32_bf16 v[124:127], v[84:87], v[48:51], v[124:127]
    v_mfma_f32_16x16x32_bf16 v[108:111], v[88:91], v[44:47], v[108:111]
    v_mfma_f32_16x16x32_bf16 v[128:131], v[88:91], v[48:51], v[128:131]
    s_waitcnt lgkmcnt(0)
    v_mfma_f32_16x16x32_bf16 v[92:95], v[52:55], v[36:39], v[92:95]
    ds_read_b128 v[44:47], v141 offset:0
    ds_read_b128 v[48:51], v141 offset:2048
    ds_read_b64_tr_b16 v[72:73], v142 offset:9216
    v_mfma_f32_16x16x32_bf16 v[112:115], v[52:55], v[40:43], v[112:115]
    ds_read_b64_tr_b16 v[74:75], v142 offset:13824
    ds_read_b64_tr_b16 v[76:77], v142 offset:9248
    ds_read_b64_tr_b16 v[78:79], v142 offset:13856
    v_mfma_f32_16x16x32_bf16 v[96:99], v[56:59], v[36:39], v[96:99]
    ds_read_b64_tr_b16 v[80:81], v142 offset:9376
    ds_read_b64_tr_b16 v[82:83], v142 offset:13984
    ds_read_b64_tr_b16 v[84:85], v142 offset:9408
    v_mfma_f32_16x16x32_bf16 v[116:119], v[56:59], v[40:43], v[116:119]
    ds_read_b64_tr_b16 v[86:87], v142 offset:14016
    ds_read_b64_tr_b16 v[88:89], v142 offset:9440
    ds_read_b64_tr_b16 v[90:91], v142 offset:14048
    v_mfma_f32_16x16x32_bf16 v[100:103], v[60:63], v[36:39], v[100:103]
    v_mfma_f32_16x16x32_bf16 v[120:123], v[60:63], v[40:43], v[120:123]
    v_mfma_f32_16x16x32_bf16 v[104:107], v[64:67], v[36:39], v[104:107]
    v_mfma_f32_16x16x32_bf16 v[124:127], v[64:67], v[40:43], v[124:127]
    v_mfma_f32_16x16x32_bf16 v[108:111], v[68:71], v[36:39], v[108:111]
    v_mfma_f32_16x16x32_bf16 v[128:131], v[68:71], v[40:43], v[128:131]
    s_waitcnt vmcnt(0)
    s_cmp_lg_u32 s8, 0
    s_cbranch_scc1 L_pa_cBq0
    s_mov_b32 s21, 0
L_pa_wBq0_spin:
    s_waitcnt vmcnt(0)
    v_cmp_eq_u32 vcc, s3, v232
    s_add_u32 s21, s21, 1
    s_cmp_eq_u64 vcc, -1
    s_cbranch_scc1 L_pa_wBq0_ok
    s_sleep 2
    global_load_dword v232, v236, s[4:5] sc1
    s_cmp_lt_u32 s21, 0x40000
    s_cbranch_scc1 L_pa_wBq0_spin
L_pa_wBq0_ok:
L_pa_cBq0:
    s_waitcnt lgkmcnt(0)
    s_barrier
    v_add_u32 v140, 0, v137
    v_add_u32 v141, 0, v138
    v_add_u32 v142, 0, v139
    v_mfma_f32_16x16x32_bf16 v[92:95], v[72:75], v[44:47], v[92:95]
    ds_read_b128 v[36:39], v140 offset:0
    ds_read_b128 v[40:43], v140 offset:2048
    ds_read_b64_tr_b16 v[52:53], v142 offset:0
    v_mfma_f32_16x16x32_bf16 v[112:115], v[72:75], v[48:51], v[112:115]
    ds_read_b64_tr_b16 v[54:55], v142 offset:4608
    ds_read_b64_tr_b16 v[56:57], v142 offset:32
    ds_read_b64_tr_b16 v[58:59], v142 offset:4640
    v_mfma_f32_16x16x32_bf16 v[96:99], v[76:79], v[44:47], v[96:99]
    ds_read_b64_tr_b16 v[60:61], v142 offset:160
    ds_read_b64_tr_b16 v[62:63], v142 offset:4768
    ds_read_b64_tr_b16 v[64:65], v142 offset:192
    s_mov_b32 s96, -1
    s_mov_b32 s98, -1
    s_cmp_eq_u32 s8, 3
    s_cselect_b32 s97, 0, -1
    s_cmp_eq_u32 s8, 7
    s_cselect_b32 s99, 0, -1
    v_lshlrev_b32 v237, 4, v1
    s_add_u32 m0, s29, 119808
    s_mov_b32 s52, s24
    buffer_load_dwordx4 v237, s[32:35], s52 offen sc1 lds
    v_mfma_f32_16x16x32_bf16 v[116:119], v[76:79], v[48:51], v[116:119]
    ds_read_b64_tr_b16 v[66:67], v142 offset:4800
    ds_read_b64_tr_b16 v[68:69], v142 offset:224
    ds_read_b64_tr_b16 v[70:71], v142 offset:4832
    s_add_u32 m0, s30, 119808
    s_mov_b32 s52, s25
    v_mfma_f32_16x16x32_bf16 v[100:103], v[80:83], v[44:47], v[100:103]
    buffer_load_dwordx4 v237, s[32:35], s52 offen sc1 lds
    v_mfma_f32_16x16x32_bf16 v[120:123], v[80:83], v[48:51], v[120:123]
    s_add_u32 m0, s31, 119808
    s_mov_b32 s52, s26
    s_mov_b64 exec, s[96:97]
    buffer_load_dwordx4 v237, s[32:35], s52 offen sc1 lds
    s_mov_b64 exec, -1
    v_mfma_f32_16x16x32_bf16 v[104:107], v[84:87], v[44:47], v[104:107]
    v_mfma_f32_16x16x32_bf16 v[124:127], v[84:87], v[48:51], v[124:127]
    v_mfma_f32_16x16x32_bf16 v[108:111], v[88:91], v[44:47], v[108:111]
    v_mfma_f32_16x16x32_bf16 v[128:131], v[88:91], v[48:51], v[128:131]
    s_waitcnt lgkmcnt(0)
    v_mfma_f32_16x16x32_bf16 v[92:95], v[52:55], v[36:39], v[92:95]
    ds_read_b128 v[44:47], v141 offset:0
    ds_read_b128 v[48:51], v141 offset:2048
    ds_read_b64_tr_b16 v[72:73], v142 offset:9216
    v_mfma_f32_16x16x32_bf16 v[112:115], v[52:55], v[40:43], v[112:115]
    ds_read_b64_tr_b16 v[74:75], v142 offset:13824
    ds_read_b64_tr_b16 v[76:77], v142 offset:9248
    ds_read_b64_tr_b16 v[78:79], v142 offset:13856
    v_mfma_f32_16x16x32_bf16 v[96:99], v[56:59], v[36:39], v[96:99]
    ds_read_b64_tr_b16 v[80:81], v142 offset:9376
    ds_read_b64_tr_b16 v[82:83], v142 offset:13984
    ds_read_b64_tr_b16 v[84:85], v142 offset:9408
    s_add_u32 m0, s36, 119808
    s_mov_b32 s52, s27
    v_mfma_f32_16x16x32_bf16 v[116:119], v[56:59], v[40:43], v[116:119]
    ds_read_b64_tr_b16 v[86:87], v142 offset:14016
    ds_read_b64_tr_b16 v[88:89], v142 offset:9440
    ds_read_b64_tr_b16 v[90:91], v142 offset:14048
    buffer_load_dwordx4 v237, s[32:35], s52 offen sc1 lds
    v_mfma_f32_16x16x32_bf16 v[100:103], v[60:63], v[36:39], v[100:103]
    s_add_u32 m0, s37, 119808
    s_mov_b32 s52, s28
    s_mov_b64 exec, s[98:99]
    buffer_load_dwordx4 v237, s[32:35], s52 offen sc1 lds
    s_mov_b64 exec, -1
    v_mfma_f32_16x16x32_bf16 v[120:123], v[60:63], v[40:43], v[120:123]
    v_and_b32 v236, 31, v1
    s_lshl_b32 s16, s8, 5
    v_add_u32 v236, s16, v236
    v_lshlrev_b32 v236, 7, v236
    v_add_u32 v236, 0xd10000, v236
    s_mov_b32 exec_hi, 0
    global_load_dword v224, v236, s[4:5] sc1
    s_mov_b64 exec, -1
    v_mfma_f32_16x16x32_bf16 v[104:107], v[64:67], v[36:39], v[104:107]
    s_lshl_b32 s16, s11, 7
    s_add_u32 s16, s16, 0x4a9000
    v_and_b32 v236, 31, v1
    v_lshlrev_b32 v236, 2, v236
    v_add_u32 v236, s16, v236
    global_load_dword v228, v236, s[4:5] sc1
    v_mfma_f32_16x16x32_bf16 v[124:127], v[64:67], v[40:43], v[124:127]
    v_mfma_f32_16x16x32_bf16 v[108:111], v[68:71], v[36:39], v[108:111]
    v_mfma_f32_16x16x32_bf16 v[128:131], v[68:71], v[40:43], v[128:131]
    s_waitcnt lgkmcnt(0)
    v_mfma_f32_16x16x32_bf16 v[92:95], v[72:75], v[44:47], v[92:95]
    v_mfma_f32_16x16x32_bf16 v[112:115], v[72:75], v[48:51], v[112:115]
    v_mfma_f32_16x16x32_bf16 v[96:99], v[76:79], v[44:47], v[96:99]
    v_mfma_f32_16x16x32_bf16 v[116:119], v[76:79], v[48:51], v[116:119]
    v_mfma_f32_16x16x32_bf16 v[100:103], v[80:83], v[44:47], v[100:103]
    v_mfma_f32_16x16x32_bf16 v[120:123], v[80:83], v[48:51], v[120:123]
    v_mfma_f32_16x16x32_bf16 v[104:107], v[84:87], v[44:47], v[104:107]
    v_mfma_f32_16x16x32_bf16 v[124:127], v[84:87], v[48:51], v[124:127]
    v_mfma_f32_16x16x32_bf16 v[108:111], v[88:91], v[44:47], v[108:111]
    v_mfma_f32_16x16x32_bf16 v[128:131], v[88:91], v[48:51], v[128:131]
    s_lshl_b32 s16, s14, 5
    v_add_u32 v20, s16, v2
    v_mul_u32_u24 v20, 296, v20
    v_lshl_add_u32 v20, v3, 3, v20
    v_add_u32 v20, 73728, v20
    s_barrier
    v_cvt_pk_bf16_f32 v92, v92, v93
    v_cvt_pk_bf16_f32 v93, v94, v95
    ds_write_b64 v20, v[92:93] offset:0
    v_cvt_pk_bf16_f32 v112, v112, v113
    v_cvt_pk_bf16_f32 v113, v114, v115
    ds_write_b64 v20, v[112:113] offset:4736
    v_cvt_pk_bf16_f32 v96, v96, v97
    v_cvt_pk_bf16_f32 v97, v98, v99
    ds_write_b64 v20, v[96:97] offset:32
    v_cvt_pk_bf16_f32 v116, v116, v117
    v_cvt_pk_bf16_f32 v117, v118, v119
    ds_write_b64 v20, v[116:117] offset:4768
    v_cvt_pk_bf16_f32 v100, v100, v101
    v_cvt_pk_bf16_f32 v101, v102, v103
    ds_write_b64 v20, v[100:101] offset:160
    v_cvt_pk_bf16_f32 v120, v120, v121
    v_cvt_pk_bf16_f32 v121, v122, v123
    ds_write_b64 v20, v[120:121] offset:4896
    v_cvt_pk_bf16_f32 v104, v104, v105
    v_cvt_pk_bf16_f32 v105, v106, v107
    ds_write_b64 v20, v[104:105] offset:192
    v_cvt_pk_bf16_f32 v124, v124, v125
    v_cvt_pk_bf16_f32 v125, v126, v127
    ds_write_b64 v20, v[124:125] offset:4928
    v_cvt_pk_bf16_f32 v108, v108, v109
    v_cvt_pk_bf16_f32 v109, v110, v111
    ds_write_b64 v20, v[108:109] offset:224
    v_cvt_pk_bf16_f32 v128, v128, v129
    v_cvt_pk_bf16_f32 v129, v130, v131
    ds_write_b64 v20, v[128:129] offset:4960
    s_mul_i32 s16, s8, 36
    s_add_u32 s16, s16, 73728
    v_and_b32 v21, 31, v1
    v_mul_u32_u24 v22, 296, v21
    v_add_u32 v22, s16, v22
    v_lshrrev_b32 v23, 5, v1
    v_lshl_add_u32 v24, v23, 4, v22
    v_mul_u32_u24 v25, 9472, v23
    v_add_u32 v25, v25, v22
    v_lshlrev_b32 v26, 4, v1
    v_mul_u32_u24 v27, 36864, v23
    v_lshl_add_u32 v27, v21, 2, v27
    s_lshl_b32 s16, s69, 7
    s_lshl_b32 s17, s70, 3
    s_add_u32 s16, s16, s17
    s_add_u32 s16, s16, s8
    s_mul_i32 s16, s16, 1152
    s_add_u32 s16, s16, 0x240000
    s_add_u32 s76, s4, s16
    s_addc_u32 s77, s5, 0
    s_waitcnt lgkmcnt(0)
    s_barrier
    v_add_u32 v28, 0, v24
    ds_read2_b32 v[36:37], v28 offset0:0 offset1:1
    ds_read2_b32 v[38:39], v28 offset0:2 offset1:3
    v_add_u32 v28, 9472, v24
    ds_read2_b32 v[40:41], v28 offset0:0 offset1:1
    ds_read2_b32 v[42:43], v28 offset0:2 offset1:3
    v_add_u32 v28, 18944, v24
    ds_read2_b32 v[44:45], v28 offset0:0 offset1:1
    ds_read2_b32 v[46:47], v28 offset0:2 offset1:3
    v_add_u32 v28, 28416, v24
    ds_read2_b32 v[48:49], v28 offset0:0 offset1:1
    ds_read2_b32 v[50:51], v28 offset0:2 offset1:3
    ds_read_b32 v52, v25 offset:32
    ds_read_b32 v53, v25 offset:18976
    s_waitcnt lgkmcnt(0)
    global_store_dwordx4 v26, v[36:39], s[76:77] sc1
    s_add_u32 s76, s76, 36864
    s_addc_u32 s77, s77, 0
    global_store_dwordx4 v26, v[40:43], s[76:77] sc1
    s_add_u32 s76, s76, 36864
    s_addc_u32 s77, s77, 0
    global_store_dwordx4 v26, v[44:47], s[76:77] sc1
    s_add_u32 s76, s76, 36864
    s_addc_u32 s77, s77, 0
    global_store_dwordx4 v26, v[48:51], s[76:77] sc1
    s_add_u32 s76, s76, 36864
    s_addc_u32 s77, s77, 0
    s_sub_u32 s76, s76, 147456
    s_subb_u32 s77, s77, 0
    global_store_dword v27, v52, s[76:77] offset:1024 sc1
    s_add_u32 s76, s76, 73728
    s_addc_u32 s77, s77, 0
    global_store_dword v27, v53, s[76:77] offset:1024 sc1
    s_branch L_B_qj
L_B_q1:
    s_barrier
    v_add_u32 v140, 0, v137
    v_add_u32 v141, 0, v138
    v_add_u32 v142, 0, v139
    ds_read_b128 v[36:39], v140 offset:0
    ds_read_b128 v[40:43], v140 offset:2048
    ds_read_b64_tr_b16 v[52:53], v142 offset:64
    ds_read_b64_tr_b16 v[54:55], v142 offset:4672
    ds_read_b64_tr_b16 v[56:57], v142 offset:96
    ds_read_b64_tr_b16 v[58:59], v142 offset:4704
    ds_read_b64_tr_b16 v[60:61], v142 offset:128
    ds_read_b64_tr_b16 v[62:63], v142 offset:4736
    ds_read_b64_tr_b16 v[64:65], v142 offset:256
    ds_read_b64_tr_b16 v[66:67], v142 offset:4864
    s_waitcnt lgkmcnt(0)
    v_mfma_f32_16x16x32_bf16 v[92:95], v[52:55], v[36:39], 0
    ds_read_b128 v[44:47], v141 offset:0
    ds_read_b128 v[48:51], v141 offset:2048
    ds_read_b64_tr_b16 v[72:73], v142 offset:9280
    v_mfma_f32_16x16x32_bf16 v[112:115], v[52:55], v[40:43], 0
    ds_read_b64_tr_b16 v[74:75], v142 offset:13888
    ds_read_b64_tr_b16 v[76:77], v142 offset:9312
    ds_read_b64_tr_b16 v[78:79], v142 offset:13920
    v_mfma_f32_16x16x32_bf16 v[96:99], v[56:59], v[36:39], 0
    ds_read_b64_tr_b16 v[80:81], v142 offset:9344
    ds_read_b64_tr_b16 v[82:83], v142 offset:13952
    ds_read_b64_tr_b16 v[84:85], v142 offset:9472
    s_add_u32 m0, s96, 69632
    v_mfma_f32_16x16x32_bf16 v[116:119], v[56:59], v[40:43], 0
    ds_read_b64_tr_b16 v[86:87], v142 offset:14080
    buffer_load_dwordx4 v134, s[44:47], s99 offen lds
    v_mfma_f32_16x16x32_bf16 v[100:103], v[60:63], v[36:39], 0
    s_add_u32 m0, s96, 70656
    v_mfma_f32_16x16x32_bf16 v[120:123], v[60:63], v[40:43], 0
    buffer_load_dwordx4 v135, s[44:47], s99 offen lds
    v_mfma_f32_16x16x32_bf16 v[104:107], v[64:67], v[36:39], 0
    s_add_u32 m0, s97, 86016
    v_mfma_f32_16x16x32_bf16 v[124:127], v[64:67], v[40:43], 0
    buffer_load_dwordx4 v136, s[48:51], s100 offen lds
    s_add_u32 m0, s97, 87040
    s_nop 0
    buffer_load_dwordx4 v143, s[48:51], s100 offen lds
    s_add_u32 m0, s98, 102400
    s_cmp_lt_u32 s8, 2
    s_cbranch_scc0 L_B_ex37
    buffer_load_dwordx4 v144, s[48:51], s100 offen lds
L_B_ex37:
    s_add_u32 s99, s99, 128
    s_add_u32 s100, s100, s101
    s_add_u32 m0, s96, 104448
    s_nop 0
    buffer_load_dwordx4 v134, s[44:47], s99 offen lds
    s_add_u32 m0, s96, 105472
    s_nop 0
    buffer_load_dwordx4 v135, s[44:47], s99 offen lds
    s_add_u32 m0, s97, 120832
    s_nop 0
    buffer_load_dwordx4 v136, s[48:51], s100 offen lds
    s_add_u32 m0, s97, 121856
    s_nop 0
    buffer_load_dwordx4 v143, s[48:51], s100 offen lds
    s_add_u32 m0, s98, 137216
    s_cmp_lt_u32 s8, 2
    s_cbranch_scc0 L_B_ex38
    buffer_load_dwordx4 v144, s[48:51], s100 offen lds
L_B_ex38:
    s_add_u32 s99, s99, 128
    s_add_u32 s100, s100, s101
    s_waitcnt vmcnt(9)
    s_waitcnt vmcnt(8)
    s_waitcnt lgkmcnt(0)
    s_barrier
    s_lshl_b32 s16, s23, 7
    s_add_u32 s16, s16, 0xf10000
    v_mov_b32 v16, s16
    v_mov_b32 v17, s3
    s_cmp_eq_u32 s8, 0
    s_cselect_b32 exec_lo, 1, 0
    s_mov_b32 exec_hi, 0
    global_store_dword v16, v17, s[4:5] sc1
    s_mov_b64 exec, -1
    v_add_u32 v140, 34816, v137
    v_add_u32 v141, 34816, v138
    v_add_u32 v142, 34816, v139
    v_mfma_f32_16x16x32_bf16 v[92:95], v[72:75], v[44:47], v[92:95]
    ds_read_b128 v[36:39], v140 offset:0
    ds_read_b128 v[40:43], v140 offset:2048
    ds_read_b64_tr_b16 v[52:53], v142 offset:64
    v_mfma_f32_16x16x32_bf16 v[112:115], v[72:75], v[48:51], v[112:115]
    ds_read_b64_tr_b16 v[54:55], v142 offset:4672
    ds_read_b64_tr_b16 v[56:57], v142 offset:96
    ds_read_b64_tr_b16 v[58:59], v142 offset:4704
    v_mfma_f32_16x16x32_bf16 v[96:99], v[76:79], v[44:47], v[96:99]
    ds_read_b64_tr_b16 v[60:61], v142 offset:128
    ds_read_b64_tr_b16 v[62:63], v142 offset:4736
    ds_read_b64_tr_b16 v[64:65], v142 offset:256
    s_add_u32 m0, s96, 0
    v_mfma_f32_16x16x32_bf16 v[116:119], v[76:79], v[48:51], v[116:119]
    ds_read_b64_tr_b16 v[66:67], v142 offset:4864
    buffer_load_dwordx4 v134, s[44:47], s99 offen lds
    v_mfma_f32_16x16x32_bf16 v[100:103], v[80:83], v[44:47], v[100:103]
    s_add_u32 m0, s96, 1024
    v_mfma_f32_16x16x32_bf16 v[120:123], v[80:83], v[48:51], v[120:123]
    buffer_load_dwordx4 v135, s[44:47], s99 offen lds
    v_mfma_f32_16x16x32_bf16 v[104:107], v[84:87], v[44:47], v[104:107]
    s_add_u32 m0, s97, 16384
    v_mfma_f32_16x16x32_bf16 v[124:127], v[84:87], v[48:51], v[124:127]
    buffer_load_dwordx4 v136, s[48:51], s100 offen lds
    s_waitcnt lgkmcnt(0)
    v_mfma_f32_16x16x32_bf16 v[92:95], v[52:55], v[36:39], v[92:95]
    ds_read_b128 v[44:47], v141 offset:0
    ds_read_b128 v[48:51], v141 offset:2048
    ds_read_b64_tr_b16 v[72:73], v142 offset:9280
    v_mfma_f32_16x16x32_bf16 v[112:115], v[52:55], v[40:43], v[112:115]
    ds_read_b64_tr_b16 v[74:75], v142 offset:13888
    ds_read_b64_tr_b16 v[76:77], v142 offset:9312
    ds_read_b64_tr_b16 v[78:79], v142 offset:13920
    v_mfma_f32_16x16x32_bf16 v[96:99], v[56:59], v[36:39], v[96:99]
    ds_read_b64_tr_b16 v[80:81], v142 offset:9344
    ds_read_b64_tr_b16 v[82:83], v142 offset:13952
    ds_read_b64_tr_b16 v[84:85], v142 offset:9472
    s_add_u32 m0, s97, 17408
    v_mfma_f32_16x16x32_bf16 v[116:119], v[56:59], v[40:43], v[116:119]
    ds_read_b64_tr_b16 v[86:87], v142 offset:14080
    buffer_load_dwordx4 v143, s[48:51], s100 offen lds
    v_mfma_f32_16x16x32_bf16 v[100:103], v[60:63], v[36:39], v[100:103]
    s_add_u32 m0, s98, 32768
    s_cmp_lt_u32 s8, 2
    s_cbranch_scc0 L_B_ex39
    buffer_load_dwordx4 v144, s[48:51], s100 offen lds
L_B_ex39:
    s_add_u32 s99, s99, 128
    s_add_u32 s100, s100, s101
    v_mfma_f32_16x16x32_bf16 v[120:123], v[60:63], v[40:43], v[120:123]
    v_mfma_f32_16x16x32_bf16 v[104:107], v[64:67], v[36:39], v[104:107]
    v_mfma_f32_16x16x32_bf16 v[124:127], v[64:67], v[40:43], v[124:127]
    s_waitcnt vmcnt(9)
    s_waitcnt lgkmcnt(0)
    s_barrier
    v_add_u32 v140, 69632, v137
    v_add_u32 v141, 69632, v138
    v_add_u32 v142, 69632, v139
    v_mfma_f32_16x16x32_bf16 v[92:95], v[72:75], v[44:47], v[92:95]
    ds_read_b128 v[36:39], v140 offset:0
    ds_read_b128 v[40:43], v140 offset:2048
    ds_read_b64_tr_b16 v[52:53], v142 offset:64
    v_mfma_f32_16x16x32_bf16 v[112:115], v[72:75], v[48:51], v[112:115]
    ds_read_b64_tr_b16 v[54:55], v142 offset:4672
    ds_read_b64_tr_b16 v[56:57], v142 offset:96
    ds_read_b64_tr_b16 v[58:59], v142 offset:4704
    v_mfma_f32_16x16x32_bf16 v[96:99], v[76:79], v[44:47], v[96:99]
    ds_read_b64_tr_b16 v[60:61], v142 offset:128
    ds_read_b64_tr_b16 v[62:63], v142 offset:4736
    ds_read_b64_tr_b16 v[64:65], v142 offset:256
    s_add_u32 m0, s96, 34816
    v_mfma_f32_16x16x32_bf16 v[116:119], v[76:79], v[48:51], v[116:119]
    ds_read_b64_tr_b16 v[66:67], v142 offset:4864
    buffer_load_dwordx4 v134, s[44:47], s99 offen lds
    v_mfma_f32_16x16x32_bf16 v[100:103], v[80:83], v[44:47], v[100:103]
    s_add_u32 m0, s96, 35840
    v_mfma_f32_16x16x32_bf16 v[120:123], v[80:83], v[48:51], v[120:123]
    buffer_load_dwordx4 v135, s[44:47], s99 offen lds
    v_mfma_f32_16x16x32_bf16 v[104:107], v[84:87], v[44:47], v[104:107]
    s_add_u32 m0, s97, 51200
    v_mfma_f32_16x16x32_bf16 v[124:127], v[84:87], v[48:51], v[124:127]
    buffer_load_dwordx4 v136, s[48:51], s100 offen lds
    s_waitcnt lgkmcnt(0)
    v_mfma_f32_16x16x32_bf16 v[92:95], v[52:55], v[36:39], v[92:95]
    ds_read_b128 v[44:47], v141 offset:0
    ds_read_b128 v[48:51], v141 offset:2048
    ds_read_b64_tr_b16 v[72:73], v142 offset:9280
    v_mfma_f32_16x16x32_bf16 v[112:115], v[52:55], v[40:43], v[112:115]
    ds_read_b64_tr_b16 v[74:75], v142 offset:13888
    ds_read_b64_tr_b16 v[76:77], v142 offset:9312
    ds_read_b64_tr_b16 v[78:79], v142 offset:13920
    v_mfma_f32_16x16x32_bf16 v[96:99], v[56:59], v[36:39], v[96:99]
    ds_read_b64_tr_b16 v[80:81], v142 offset:9344
    ds_read_b64_tr_b16 v[82:83], v142 offset:13952
    ds_read_b64_tr_b16 v[84:85], v142 offset:9472
    s_add_u32 m0, s97, 52224
    v_mfma_f32_16x16x32_bf16 v[116:119], v[56:59], v[40:43], v[116:119]
    ds_read_b64_tr_b16 v[86:87], v142 offset:14080
    buffer_load_dwordx4 v143, s[48:51], s100 offen lds
    v_mfma_f32_16x16x32_bf16 v[100:103], v[60:63], v[36:39], v[100:103]
    s_add_u32 m0, s98, 67584
    s_cmp_lt_u32 s8, 2
    s_cbranch_scc0 L_B_ex40
    buffer_load_dwordx4 v144, s[48:51], s100 offen lds
L_B_ex40:
    s_add_u32 s99, s99, 128
    s_add_u32 s100, s100, s101
    v_mfma_f32_16x16x32_bf16 v[120:123], v[60:63], v[40:43], v[120:123]
    v_mfma_f32_16x16x32_bf16 v[104:107], v[64:67], v[36:39], v[104:107]
    v_mfma_f32_16x16x32_bf16 v[124:127], v[64:67], v[40:43], v[124:127]
    s_waitcnt vmcnt(9)
    s_waitcnt lgkmcnt(0)
    s_barrier
    v_add_u32 v140, 104448, v137
    v_add_u32 v141, 104448, v138
    v_add_u32 v142, 104448, v139
    v_mfma_f32_16x16x32_bf16 v[92:95], v[72:75], v[44:47], v[92:95]
    ds_read_b128 v[36:39], v140 offset:0
    ds_read_b128 v[40:43], v140 offset:2048
    ds_read_b64_tr_b16 v[52:53], v142 offset:64
    v_mfma_f32_16x16x32_bf16 v[112:115], v[72:75], v[48:51], v[112:115]
    ds_read_b64_tr_b16 v[54:55], v142 offset:4672
    ds_read_b64_tr_b16 v[56:57], v142 offset:96
    ds_read_b64_tr_b16 v[58:59], v142 offset:4704
    v_mfma_f32_16x16x32_bf16 v[96:99], v[76:79], v[44:47], v[96:99]
    ds_read_b64_tr_b16 v[60:61], v142 offset:128
    ds_read_b64_tr_b16 v[62:63], v142 offset:4736
    ds_read_b64_tr_b16 v[64:65], v142 offset:256
    s_add_u32 m0, s96, 69632
    v_mfma_f32_16x16x32_bf16 v[116:119], v[76:79], v[48:51], v[116:119]
    ds_read_b64_tr_b16 v[66:67], v142 offset:4864
    buffer_load_dwordx4 v134, s[44:47], s99 offen lds
    v_mfma_f32_16x16x32_bf16 v[100:103], v[80:83], v[44:47], v[100:103]
    s_add_u32 m0, s96, 70656
    v_mfma_f32_16x16x32_bf16 v[120:123], v[80:83], v[48:51], v[120:123]
    buffer_load_dwordx4 v135, s[44:47], s99 offen lds
    v_mfma_f32_16x16x32_bf16 v[104:107], v[84:87], v[44:47], v[104:107]
    s_add_u32 m0, s97, 86016
    v_mfma_f32_16x16x32_bf16 v[124:127], v[84:87], v[48:51], v[124:127]
    buffer_load_dwordx4 v136, s[48:51], s100 offen lds
    s_waitcnt lgkmcnt(0)
    v_mfma_f32_16x16x32_bf16 v[92:95], v[52:55], v[36:39], v[92:95]
    ds_read_b128 v[44:47], v141 offset:0
    ds_read_b128 v[48:51], v141 offset:2048
    ds_read_b64_tr_b16 v[72:73], v142 offset:9280
    v_mfma_f32_16x16x32_bf16 v[112:115], v[52:55], v[40:43], v[112:115]
    ds_read_b64_tr_b16 v[74:75], v142 offset:13888
    ds_read_b64_tr_b16 v[76:77], v142 offset:9312
    ds_read_b64_tr_b16 v[78:79], v142 offset:13920
    v_mfma_f32_16x16x32_bf16 v[96:99], v[56:59], v[36:39], v[96:99]
    ds_read_b64_tr_b16 v[80:81], v142 offset:9344
    ds_read_b64_tr_b16 v[82:83], v142 offset:13952
    ds_read_b64_tr_b16 v[84:85], v142 offset:9472
    s_add_u32 m0, s97, 87040
    v_mfma_f32_16x16x32_bf16 v[116:119], v[56:59], v[40:43], v[116:119]
    ds_read_b64_tr_b16 v[86:87], v142 offset:14080
    buffer_load_dwordx4 v143, s[48:51], s100 offen lds
    v_mfma_f32_16x16x32_bf16 v[100:103], v[60:63], v[36:39], v[100:103]
    s_add_u32 m0, s98, 102400
    s_cmp_lt_u32 s8, 2
    s_cbranch_scc0 L_B_ex41
    buffer_load_dwordx4 v144, s[48:51], s100 offen lds
L_B_ex41:
    s_add_u32 s99, s99, 128
    s_add_u32 s100, s100, s101
    v_mfma_f32_16x16x32_bf16 v[120:123], v[60:63], v[40:43], v[120:123]
    v_mfma_f32_16x16x32_bf16 v[104:107], v[64:67], v[36:39], v[104:107]
    v_mfma_f32_16x16x32_bf16 v[124:127], v[64:67], v[40:43], v[124:127]
    s_waitcnt vmcnt(8)
    s_waitcnt lgkmcnt(0)
    s_barrier
    v_add_u32 v140, 0, v137
    v_add_u32 v141, 0, v138
    v_add_u32 v142, 0, v139
    v_mfma_f32_16x16x32_bf16 v[92:95], v[72:75], v[44:47], v[92:95]
    ds_read_b128 v[36:39], v140 offset:0
    ds_read_b128 v[40:43], v140 offset:2048
    ds_read_b64_tr_b16 v[52:53], v142 offset:64
    v_mfma_f32_16x16x32_bf16 v[112:115], v[72:75], v[48:51], v[112:115]
    ds_read_b64_tr_b16 v[54:55], v142 offset:4672
    ds_read_b64_tr_b16 v[56:57], v142 offset:96
    ds_read_b64_tr_b16 v[58:59], v142 offset:4704
    v_mfma_f32_16x16x32_bf16 v[96:99], v[76:79], v[44:47], v[96:99]
    ds_read_b64_tr_b16 v[60:61], v142 offset:128
    ds_read_b64_tr_b16 v[62:63], v142 offset:4736
    ds_read_b64_tr_b16 v[64:65], v142 offset:256
    s_add_u32 m0, s96, 104448
    v_mfma_f32_16x16x32_bf16 v[116:119], v[76:79], v[48:51], v[116:119]
    ds_read_b64_tr_b16 v[66:67], v142 offset:4864
    buffer_load_dwordx4 v134, s[44:47], s99 offen lds
    v_mfma_f32_16x16x32_bf16 v[100:103], v[80:83], v[44:47], v[100:103]
    s_add_u32 m0, s96, 105472
    v_mfma_f32_16x16x32_bf16 v[120:123], v[80:83], v[48:51], v[120:123]
    buffer_load_dwordx4 v135, s[44:47], s99 offen lds
    v_mfma_f32_16x16x32_bf16 v[104:107], v[84:87], v[44:47], v[104:107]
    s_add_u32 m0, s97, 120832
    v_mfma_f32_16x16x32_bf16 v[124:127], v[84:87], v[48:51], v[124:127]
    buffer_load_dwordx4 v136, s[48:51], s100 offen lds
    s_waitcnt lgkmcnt(0)
    v_mfma_f32_16x16x32_bf16 v[92:95], v[52:55], v[36:39], v[92:95]
    ds_read_b128 v[44:47], v141 offset:0
    ds_read_b128 v[48:51], v141 offset:2048
    ds_read_b64_tr_b16 v[72:73], v142 offset:9280
    v_mfma_f32_16x16x32_bf16 v[112:115], v[52:55], v[40:43], v[112:115]
    ds_read_b64_tr_b16 v[74:75], v142 offset:13888
    ds_read_b64_tr_b16 v[76:77], v142 offset:9312
    ds_read_b64_tr_b16 v[78:79], v142 offset:13920
    v_mfma_f32_16x16x32_bf16 v[96:99], v[56:59], v[36:39], v[96:99]
    ds_read_b64_tr_b16 v[80:81], v142 offset:9344
    ds_read_b64_tr_b16 v[82:83], v142 offset:13952
    ds_read_b64_tr_b16 v[84:85], v142 offset:9472
    s_add_u32 m0, s97, 121856
    v_mfma_f32_16x16x32_bf16 v[116:119], v[56:59], v[40:43], v[116:119]
    ds_read_b64_tr_b16 v[86:87], v142 offset:14080
    buffer_load_dwordx4 v143, s[48:51], s100 offen lds
    v_mfma_f32_16x16x32_bf16 v[100:103], v[60:63], v[36:39], v[100:103]
    s_add_u32 m0, s98, 137216
    s_cmp_lt_u32 s8, 2
    s_cbranch_scc0 L_B_ex42
    buffer_load_dwordx4 v144, s[48:51], s100 offen lds
L_B_ex42:
    s_add_u32 s99, s99, 128
    s_add_u32 s100, s100, s101
    v_mfma_f32_16x16x32_bf16 v[120:123], v[60:63], v[40:43], v[120:123]
    v_mfma_f32_16x16x32_bf16 v[104:107], v[64:67], v[36:39], v[104:107]
    v_mfma_f32_16x16x32_bf16 v[124:127], v[64:67], v[40:43], v[124:127]
    s_waitcnt vmcnt(8)
    s_waitcnt lgkmcnt(0)
    s_barrier
    v_lshlrev_b32 v236, 7, v1
    v_add_u32 v236, 0xf10000, v236
    s_cmp_lg_u32 s8, 0
    s_cbranch_scc1 L_pa_iBq1
    global_load_dword v232, v236, s[4:5] sc1
L_pa_iBq1:
    v_add_u32 v140, 34816, v137
    v_add_u32 v141, 34816, v138
    v_add_u32 v142, 34816, v139
    v_mfma_f32_16x16x32_bf16 v[92:95], v[72:75], v[44:47], v[92:95]
    ds_read_b128 v[36:39], v140 offset:0
    ds_read_b128 v[40:43], v140 offset:2048
    ds_read_b64_tr_b16 v[52:53], v142 offset:64
    v_mfma_f32_16x16x32_bf16 v[112:115], v[72:75], v[48:51], v[112:115]
    ds_read_b64_tr_b16 v[54:55], v142 offset:4672
    ds_read_b64_tr_b16 v[56:57], v142 offset:96
    ds_read_b64_tr_b16 v[58:59], v142 offset:4704
    v_mfma_f32_16x16x32_bf16 v[96:99], v[76:79], v[44:47], v[96:99]
    ds_read_b64_tr_b16 v[60:61], v142 offset:128
    ds_read_b64_tr_b16 v[62:63], v142 offset:4736
    ds_read_b64_tr_b16 v[64:65], v142 offset:256
    s_add_u32 m0, s96, 0
    v_mfma_f32_16x16x32_bf16 v[116:119], v[76:79], v[48:51], v[116:119]
    ds_read_b64_tr_b16 v[66:67], v142 offset:4864
    buffer_load_dwordx4 v134, s[44:47], s99 offen lds
    v_mfma_f32_16x16x32_bf16 v[100:103], v[80:83], v[44:47], v[100:103]
    s_add_u32 m0, s96, 1024
    v_mfma_f32_16x16x32_bf16 v[120:123], v[80:83], v[48:51], v[120:123]
    buffer_load_dwordx4 v135, s[44:47], s99 offen lds
    v_mfma_f32_16x16x32_bf16 v[104:107], v[84:87], v[44:47], v[104:107]
    s_add_u32 m0, s97, 16384
    v_mfma_f32_16x16x32_bf16 v[124:127], v[84:87], v[48:51], v[124:127]
    buffer_load_dwordx4 v136, s[48:51], s100 offen lds
    s_waitcnt lgkmcnt(0)
    v_mfma_f32_16x16x32_bf16 v[92:95], v[52:55], v[36:39], v[92:95]
    ds_read_b128 v[44:47], v141 offset:0
    ds_read_b128 v[48:51], v141 offset:2048
    ds_read_b64_tr_b16 v[72:73], v142 offset:9280
    v_mfma_f32_16x16x32_bf16 v[112:115], v[52:55], v[40:43], v[112:115]
    ds_read_b64_tr_b16 v[74:75], v142 offset:13888
    ds_read_b64_tr_b16 v[76:77], v142 offset:9312
    ds_read_b64_tr_b16 v[78:79], v142 offset:13920
    v_mfma_f32_16x16x32_bf16 v[96:99], v[56:59], v[36:39], v[96:99]
    ds_read_b64_tr_b16 v[80:81], v142 offset:9344
    ds_read_b64_tr_b16 v[82:83], v142 offset:13952
    ds_read_b64_tr_b16 v[84:85], v142 offset:9472
    s_add_u32 m0, s97, 17408
    v_mfma_f32_16x16x32_bf16 v[116:119], v[56:59], v[40:43], v[116:119]
    ds_read_b64_tr_b16 v[86:87], v142 offset:14080
    buffer_load_dwordx4 v143, s[48:51], s100 offen lds
    v_mfma_f32_16x16x32_bf16 v[100:103], v[60:63], v[36:39], v[100:103]
    s_add_u32 m0, s98, 32768
    s_cmp_lt_u32 s8, 2
    s_cbranch_scc0 L_B_ex43
    buffer_load_dwordx4 v144, s[48:51], s100 offen lds
L_B_ex43:
    s_add_u32 s99, s99, 128
    s_add_u32 s100, s100, s101
    v_mfma_f32_16x16x32_bf16 v[120:123], v[60:63], v[40:43], v[120:123]
    v_mfma_f32_16x16x32_bf16 v[104:107], v[64:67], v[36:39], v[104:107]
    v_mfma_f32_16x16x32_bf16 v[124:127], v[64:67], v[40:43], v[124:127]
    s_waitcnt vmcnt(8)
    s_waitcnt lgkmcnt(0)
    s_barrier
    v_add_u32 v140, 69632, v137
    v_add_u32 v141, 69632, v138
    v_add_u32 v142, 69632, v139
    v_mfma_f32_16x16x32_bf16 v[92:95], v[72:75], v[44:47], v[92:95]
    ds_read_b128 v[36:39], v140 offset:0
    ds_read_b128 v[40:43], v140 offset:2048
    ds_read_b64_tr_b16 v[52:53], v142 offset:64
    v_mfma_f32_16x16x32_bf16 v[112:115], v[72:75], v[48:51], v[112:115]
    ds_read_b64_tr_b16 v[54:55], v142 offset:4672
    ds_read_b64_tr_b16 v[56:57], v142 offset:96
    ds_read_b64_tr_b16 v[58:59], v142 offset:4704
    v_mfma_f32_16x16x32_bf16 v[96:99], v[76:79], v[44:47], v[96:99]
    ds_read_b64_tr_b16 v[60:61], v142 offset:128
    ds_read_b64_tr_b16 v[62:63], v142 offset:4736
    ds_read_b64_tr_b16 v[64:65], v142 offset:256
    v_mfma_f32_16x16x32_bf16 v[116:119], v[76:79], v[48:51], v[116:119]
    ds_read_b64_tr_b16 v[66:67], v142 offset:4864
    v_mfma_f32_16x16x32_bf16 v[100:103], v[80:83], v[44:47], v[100:103]
    v_mfma_f32_16x16x32_bf16 v[120:123], v[80:83], v[48:51], v[120:123]
    v_mfma_f32_16x16x32_bf16 v[104:107], v[84:87], v[44:47], v[104:107]
    v_mfma_f32_16x16x32_bf16 v[124:127], v[84:87], v[48:51], v[124:127]
    s_waitcnt lgkmcnt(0)
    v_mfma_f32_16x16x32_bf16 v[92:95], v[52:55], v[36:39], v[92:95]
    ds_read_b128 v[44:47], v141 offset:0
    ds_read_b128 v[48:51], v141 offset:2048
    ds_read_b64_tr_b16 v[72:73], v142 offset:9280
    v_mfma_f32_16x16x32_bf16 v[112:115], v[52:55], v[40:43], v[112:115]
    ds_read_b64_tr_b16 v[74:75], v142 offset:13888
    ds_read_b64_tr_b16 v[76:77], v142 offset:9312
    ds_read_b64_tr_b16 v[78:79], v142 offset:13920
    v_mfma_f32_16x16x32_bf16 v[96:99], v[56:59], v[36:39], v[96:99]
    ds_read_b64_tr_b16 v[80:81], v142 offset:9344
    ds_read_b64_tr_b16 v[82:83], v142 offset:13952
    ds_read_b64_tr_b16 v[84:85], v142 offset:9472
    v_mfma_f32_16x16x32_bf16 v[116:119], v[56:59], v[40:43], v[116:119]
    ds_read_b64_tr_b16 v[86:87], v142 offset:14080
    v_mfma_f32_16x16x32_bf16 v[100:103], v[60:63], v[36:39], v[100:103]
    v_mfma_f32_16x16x32_bf16 v[120:123], v[60:63], v[40:43], v[120:123]
    v_mfma_f32_16x16x32_bf16 v[104:107], v[64:67], v[36:39], v[104:107]
    v_mfma_f32_16x16x32_bf16 v[124:127], v[64:67], v[40:43], v[124:127]
    s_waitcnt vmcnt(4)
    s_waitcnt lgkmcnt(0)
    s_barrier
    v_add_u32 v140, 104448, v137
    v_add_u32 v141, 104448, v138
    v_add_u32 v142, 104448, v139
    v_mfma_f32_16x16x32_bf16 v[92:95], v[72:75], v[44:47], v[92:95]
    ds_read_b128 v[36:39], v140 offset:0
    ds_read_b128 v[40:43], v140 offset:2048
    ds_read_b64_tr_b16 v[52:53], v142 offset:64
    v_mfma_f32_16x16x32_bf16 v[112:115], v[72:75], v[48:51], v[112:115]
    ds_read_b64_tr_b16 v[54:55], v142 offset:4672
    ds_read_b64_tr_b16 v[56:57], v142 offset:96
    ds_read_b64_tr_b16 v[58:59], v142 offset:4704
    v_mfma_f32_16x16x32_bf16 v[96:99], v[76:79], v[44:47], v[96:99]
    ds_read_b64_tr_b16 v[60:61], v142 offset:128
    ds_read_b64_tr_b16 v[62:63], v142 offset:4736
    ds_read_b64_tr_b16 v[64:65], v142 offset:256
    v_mfma_f32_16x16x32_bf16 v[116:119], v[76:79], v[48:51], v[116:119]
    ds_read_b64_tr_b16 v[66:67], v142 offset:4864
    v_mfma_f32_16x16x32_bf16 v[100:103], v[80:83], v[44:47], v[100:103]
    v_mfma_f32_16x16x32_bf16 v[120:123], v[80:83], v[48:51], v[120:123]
    v_mfma_f32_16x16x32_bf16 v[104:107], v[84:87], v[44:47], v[104:107]
    v_mfma_f32_16x16x32_bf16 v[124:127], v[84:87], v[48:51], v[124:127]
    s_waitcnt lgkmcnt(0)
    v_mfma_f32_16x16x32_bf16 v[92:95], v[52:55], v[36:39], v[92:95]
    ds_read_b128 v[44:47], v141 offset:0
    ds_read_b128 v[48:51], v141 offset:2048
    ds_read_b64_tr_b16 v[72:73], v142 offset:9280
    v_mfma_f32_16x16x32_bf16 v[112:115], v[52:55], v[40:43], v[112:115]
    ds_read_b64_tr_b16 v[74:75], v142 offset:13888
    ds_read_b64_tr_b16 v[76:77], v142 offset:9312
    ds_read_b64_tr_b16 v[78:79], v142 offset:13920
    v_mfma_f32_16x16x32_bf16 v[96:99], v[56:59], v[36:39], v[96:99]
    ds_read_b64_tr_b16 v[80:81], v142 offset:9344
    ds_read_b64_tr_b16 v[82:83], v142 offset:13952
    ds_read_b64_tr_b16 v[84:85], v142 offset:9472
    v_mfma_f32_16x16x32_bf16 v[116:119], v[56:59], v[40:43], v[116:119]
    ds_read_b64_tr_b16 v[86:87], v142 offset:14080
    v_mfma_f32_16x16x32_bf16 v[100:103], v[60:63], v[36:39], v[100:103]
    v_mfma_f32_16x16x32_bf16 v[120:123], v[60:63], v[40:43], v[120:123]
    v_mfma_f32_16x16x32_bf16 v[104:107], v[64:67], v[36:39], v[104:107]
    v_mfma_f32_16x16x32_bf16 v[124:127], v[64:67], v[40:43], v[124:127]
    s_waitcnt vmcnt(0)
    s_cmp_lg_u32 s8, 0
    s_cbranch_scc1 L_pa_cBq1
    s_mov_b32 s21, 0
L_pa_wBq1_spin:
    s_waitcnt vmcnt(0)
    v_cmp_eq_u32 vcc, s3, v232
    s_add_u32 s21, s21, 1
    s_cmp_eq_u64 vcc, -1
    s_cbranch_scc1 L_pa_wBq1_ok
    s_sleep 2
    global_load_dword v232, v236, s[4:5] sc1
    s_cmp_lt_u32 s21, 0x40000
    s_cbranch_scc1 L_pa_wBq1_spin
L_pa_wBq1_ok:
L_pa_cBq1:
    s_waitcnt lgkmcnt(0)
    s_barrier
    v_add_u32 v140, 0, v137
    v_add_u32 v141, 0, v138
    v_add_u32 v142, 0, v139
    v_mfma_f32_16x16x32_bf16 v[92:95], v[72:75], v[44:47], v[92:95]
    ds_read_b128 v[36:39], v140 offset:0
    ds_read_b128 v[40:43], v140 offset:2048
    ds_read_b64_tr_b16 v[52:53], v142 offset:64
    v_mfma_f32_16x16x32_bf16 v[112:115], v[72:75], v[48:51], v[112:115]
    ds_read_b64_tr_b16 v[54:55], v142 offset:4672
    ds_read_b64_tr_b16 v[56:57], v142 offset:96
    ds_read_b64_tr_b16 v[58:59], v142 offset:4704
    v_mfma_f32_16x16x32_bf16 v[96:99], v[76:79], v[44:47], v[96:99]
    ds_read_b64_tr_b16 v[60:61], v142 offset:128
    ds_read_b64_tr_b16 v[62:63], v142 offset:4736
    ds_read_b64_tr_b16 v[64:65], v142 offset:256
    s_mov_b32 s96, -1
    s_mov_b32 s98, -1
    s_cmp_eq_u32 s8, 3
    s_cselect_b32 s97, 0, -1
    s_cmp_eq_u32 s8, 7
    s_cselect_b32 s99, 0, -1
    v_lshlrev_b32 v237, 4, v1
    s_add_u32 m0, s29, 119808
    s_mov_b32 s52, s24
    buffer_load_dwordx4 v237, s[32:35], s52 offen sc1 lds
    v_mfma_f32_16x16x32_bf16 v[116:119], v[76:79], v[48:51], v[116:119]
    ds_read_b64_tr_b16 v[66:67], v142 offset:4864
    s_add_u32 m0, s30, 119808
    s_mov_b32 s52, s25
    v_mfma_f32_16x16x32_bf16 v[100:103], v[80:83], v[44:47], v[100:103]
    buffer_load_dwordx4 v237, s[32:35], s52 offen sc1 lds
    v_mfma_f32_16x16x32_bf16 v[120:123], v[80:83], v[48:51], v[120:123]
    s_add_u32 m0, s31, 119808
    s_mov_b32 s52, s26
    s_mov_b64 exec, s[96:97]
    buffer_load_dwordx4 v237, s[32:35], s52 offen sc1 lds
    s_mov_b64 exec, -1
    v_mfma_f32_16x16x32_bf16 v[104:107], v[84:87], v[44:47], v[104:107]
    v_mfma_f32_16x16x32_bf16 v[124:127], v[84:87], v[48:51], v[124:127]
    s_waitcnt lgkmcnt(0)
    v_mfma_f32_16x16x32_bf16 v[92:95], v[52:55], v[36:39], v[92:95]
    ds_read_b128 v[44:47], v141 offset:0
    ds_read_b128 v[48:51], v141 offset:2048
    ds_read_b64_tr_b16 v[72:73], v142 offset:9280
    v_mfma_f32_16x16x32_bf16 v[112:115], v[52:55], v[40:43], v[112:115]
    ds_read_b64_tr_b16 v[74:75], v142 offset:13888
    ds_read_b64_tr_b16 v[76:77], v142 offset:9312
    ds_read_b64_tr_b16 v[78:79], v142 offset:13920
    v_mfma_f32_16x16x32_bf16 v[96:99], v[56:59], v[36:39], v[96:99]
    ds_read_b64_tr_b16 v[80:81], v142 offset:9344
    ds_read_b64_tr_b16 v[82:83], v142 offset:13952
    ds_read_b64_tr_b16 v[84:85], v142 offset:9472
    s_add_u32 m0, s36, 119808
    s_mov_b32 s52, s27
    v_mfma_f32_16x16x32_bf16 v[116:119], v[56:59], v[40:43], v[116:119]
    ds_read_b64_tr_b16 v[86:87], v142 offset:14080
    buffer_load_dwordx4 v237, s[32:35], s52 offen sc1 lds
    v_mfma_f32_16x16x32_bf16 v[100:103], v[60:63], v[36:39], v[100:103]
    s_add_u32 m0, s37, 119808
    s_mov_b32 s52, s28
    s_mov_b64 exec, s[98:99]
    buffer_load_dwordx4 v237, s[32:35], s52 offen sc1 lds
    s_mov_b64 exec, -1
    v_mfma_f32_16x16x32_bf16 v[120:123], v[60:63], v[40:43], v[120:123]
    v_and_b32 v236, 31, v1
    s_lshl_b32 s16, s8, 5
    v_add_u32 v236, s16, v236
    v_lshlrev_b32 v236, 7, v236
    v_add_u32 v236, 0xd10000, v236
    s_mov_b32 exec_hi, 0
    global_load_dword v224, v236, s[4:5] sc1
    s_mov_b64 exec, -1
    v_mfma_f32_16x16x32_bf16 v[104:107], v[64:67], v[36:39], v[104:107]
    s_lshl_b32 s16, s11, 7
    s_add_u32 s16, s16, 0x4a9000
    v_and_b32 v236, 31, v1
    v_lshlrev_b32 v236, 2, v236
    v_add_u32 v236, s16, v236
    global_load_dword v228, v236, s[4:5] sc1
    v_mfma_f32_16x16x32_bf16 v[124:127], v[64:67], v[40:43], v[124:127]
    s_waitcnt lgkmcnt(0)
    v_mfma_f32_16x16x32_bf16 v[92:95], v[72:75], v[44:47], v[92:95]
    v_mfma_f32_16x16x32_bf16 v[112:115], v[72:75], v[48:51], v[112:115]
    v_mfma_f32_16x16x32_bf16 v[96:99], v[76:79], v[44:47], v[96:99]
    v_mfma_f32_16x16x32_bf16 v[116:119], v[76:79], v[48:51], v[116:119]
    v_mfma_f32_16x16x32_bf16 v[100:103], v[80:83], v[44:47], v[100:103]
    v_mfma_f32_16x16x32_bf16 v[120:123], v[80:83], v[48:51], v[120:123]
    v_mfma_f32_16x16x32_bf16 v[104:107], v[84:87], v[44:47], v[104:107]
    v_mfma_f32_16x16x32_bf16 v[124:127], v[84:87], v[48:51], v[124:127]
    s_lshl_b32 s16, s14, 5
    v_add_u32 v20, s16, v2
    v_mul_u32_u24 v20, 296, v20
    v_lshl_add_u32 v20, v3, 3, v20
    v_add_u32 v20, 73728, v20
    s_barrier
    v_cvt_pk_bf16_f32 v92, v92, v93
    v_cvt_pk_bf16_f32 v93, v94, v95
    ds_write_b64 v20, v[92:93] offset:64
    v_cvt_pk_bf16_f32 v112, v112, v113
    v_cvt_pk_bf16_f32 v113, v114, v115
    ds_write_b64 v20, v[112:113] offset:4800
    v_cvt_pk_bf16_f32 v96, v96, v97
    v_cvt_pk_bf16_f32 v97, v98, v99
    ds_write_b64 v20, v[96:97] offset:96
    v_cvt_pk_bf16_f32 v116, v116, v117
    v_cvt_pk_bf16_f32 v117, v118, v119
    ds_write_b64 v20, v[116:117] offset:4832
    v_cvt_pk_bf16_f32 v100, v100, v101
    v_cvt_pk_bf16_f32 v101, v102, v103
    ds_write_b64 v20, v[100:101] offset:128
    v_cvt_pk_bf16_f32 v120, v120, v121
    v_cvt_pk_bf16_f32 v121, v122, v123
    ds_write_b64 v20, v[120:121] offset:4864
    v_cvt_pk_bf16_f32 v104, v104, v105
    v_cvt_pk_bf16_f32 v105, v106, v107
    ds_write_b64 v20, v[104:105] offset:256
    v_cvt_pk_bf16_f32 v124, v124, v125
    v_cvt_pk_bf16_f32 v125, v126, v127
    ds_write_b64 v20, v[124:125] offset:4992
    s_mul_i32 s16, s8, 36
    s_add_u32 s16, s16, 73728
    v_and_b32 v21, 31, v1
    v_mul_u32_u24 v22, 296, v21
    v_add_u32 v22, s16, v22
    v_lshrrev_b32 v23, 5, v1
    v_lshl_add_u32 v24, v23, 4, v22
    v_mul_u32_u24 v25, 9472, v23
    v_add_u32 v25, v25, v22
    v_lshlrev_b32 v26, 4, v1
    v_mul_u32_u24 v27, 36864, v23
    v_lshl_add_u32 v27, v21, 2, v27
    s_lshl_b32 s16, s69, 7
    s_lshl_b32 s17, s70, 3
    s_add_u32 s16, s16, s17
    s_add_u32 s16, s16, s8
    s_mul_i32 s16, s16, 1152
    s_add_u32 s16, s16, 0x240000
    s_add_u32 s76, s4, s16
    s_addc_u32 s77, s5, 0
    s_waitcnt lgkmcnt(0)
    s_barrier
    v_add_u32 v28, 0, v24
    ds_read2_b32 v[36:37], v28 offset0:0 offset1:1
    ds_read2_b32 v[38:39], v28 offset0:2 offset1:3
    v_add_u32 v28, 9472, v24
    ds_read2_b32 v[40:41], v28 offset0:0 offset1:1
    ds_read2_b32 v[42:43], v28 offset0:2 offset1:3
    v_add_u32 v28, 18944, v24
    ds_read2_b32 v[44:45], v28 offset0:0 offset1:1
    ds_read2_b32 v[46:47], v28 offset0:2 offset1:3
    v_add_u32 v28, 28416, v24
    ds_read2_b32 v[48:49], v28 offset0:0 offset1:1
    ds_read2_b32 v[50:51], v28 offset0:2 offset1:3
    ds_read_b32 v52, v25 offset:32
    ds_read_b32 v53, v25 offset:18976
    s_waitcnt lgkmcnt(0)
    global_store_dwordx4 v26, v[36:39], s[76:77] sc1
    s_add_u32 s76, s76, 36864
    s_addc_u32 s77, s77, 0
    global_store_dwordx4 v26, v[40:43], s[76:77] sc1
    s_add_u32 s76, s76, 36864
    s_addc_u32 s77, s77, 0
    global_store_dwordx4 v26, v[44:47], s[76:77] sc1
    s_add_u32 s76, s76, 36864
    s_addc_u32 s77, s77, 0
    global_store_dwordx4 v26, v[48:51], s[76:77] sc1
    s_add_u32 s76, s76, 36864
    s_addc_u32 s77, s77, 0
    s_sub_u32 s76, s76, 147456
    s_subb_u32 s77, s77, 0
    global_store_dword v27, v52, s[76:77] offset:1024 sc1
    s_add_u32 s76, s76, 73728
    s_addc_u32 s77, s77, 0
    global_store_dword v27, v53, s[76:77] offset:1024 sc1
L_B_qj:
    s_and_b32 s16, s11, 0xfc
    s_add_u32 s16, s16, s12
    s_lshl_b32 s16, s16, 3
    s_lshl_b32 s17, s14, 1
    s_add_u32 s16, s16, s17
    v_and_b32 v238, 1, v1
    v_add_u32 v238, s16, v238
    v_lshlrev_b32 v238, 7, v238
    v_add_u32 v238, 0xf40000, v238
    global_load_dword v239, v238, s[4:5] sc1
    s_waitcnt vmcnt(7)
L_B_done:
    v_mov_b32 v117, v228
    s_nop 1
    v_max_f32_dpp v224, v224, v224 row_ror:1 row_mask:0xf bank_mask:0xf
    s_nop 1
    v_max_f32_dpp v224, v224, v224 row_ror:2 row_mask:0xf bank_mask:0xf
    s_nop 1
    v_max_f32_dpp v224, v224, v224 row_ror:4 row_mask:0xf bank_mask:0xf
    s_nop 1
    v_max_f32_dpp v224, v224, v224 row_ror:8 row_mask:0xf bank_mask:0xf
    v_mov_b32 v225, v224
    s_nop 1
    v_permlane16_swap_b32 v224, v225
    s_nop 1
    v_max_f32 v224, v224, v225
    s_lshl_b32 s16, s8, 2
    s_add_u32 s16, s16, 160256
    v_mov_b32 v225, s16
    s_mov_b32 exec_lo, 1
    s_mov_b32 exec_hi, 0
    ds_write_b32 v225, v224
    s_mov_b64 exec, -1
    v_lshlrev_b32 v115, 3, v4
    v_add_u32 v115, 8192, v115
    v_mov_b32 v114, v6
    v_min_u32 v8, 18, v4
    v_subrev_u32 v9, 20, v4
    v_cmp_gt_u32 vcc, 8, v9
    v_mov_b32 v9, 0
    s_nop 0
    v_cndmask_b32 v8, v8, v9, vcc
    v_lshlrev_b32 v8, 4, v8
    v_mul_u32_u24 v9, 304, v5
    v_add_u32 v116, v8, v9
    v_add_u32 v116, 10240, v116
    s_mul_i32 s16, s13, 19968
    v_add_u32 v114, s16, v114
    v_add_u32 v115, s16, v115
    v_add_u32 v116, s16, v116
    v_add_u32 v108, 119808, v114
    v_add_u32 v111, 0, v114
    v_add_u32 v109, 119808, v115
    v_add_u32 v112, 0, v115
    v_add_u32 v110, 119808, v116
    v_add_u32 v113, 0, v116
    s_waitcnt lgkmcnt(0)
    s_barrier
    v_mov_b32 v8, 160256
    ds_read_b128 v[130:133], v8
    ds_read_b128 v[134:137], v8 offset:16
    s_waitcnt lgkmcnt(0)
    v_max3_f32 v130, v130, v131, v132
    v_max3_f32 v134, v134, v135, v136
    v_max_f32 v130, v130, v133
    v_max_f32 v134, v134, v137
    v_add_f32 v11, v130, v134
    ds_read_b128 v[80:83], v108
    ds_read_b64 v[88:89], v109
    ds_read_b128 v[84:87], v108 offset:1024
    ds_read_b64 v[90:91], v109 offset:256
    ds_read_b128 v[92:95], v110 offset:0
    ds_read_b128 v[100:103], v110 offset:608
    s_mov_b32 s21, 0
    s_waitcnt vmcnt(0)
L_lq_chk:
    v_cmp_eq_u32 vcc, s3, v239
    s_add_u32 s21, s21, 1
    s_cmp_eq_u64 vcc, -1
    s_cbranch_scc1 L_lq_ok
    s_sleep 1
    global_load_dword v239, v238, s[4:5] sc1
    s_waitcnt vmcnt(0)
    s_cmp_lt_u32 s21, 0x40000
    s_cbranch_scc1 L_lq_chk
L_lq_ok:
    s_lshl_b32 s16, s11, 5
    s_add_u32 s16, s16, s54
    s_mul_i32 s16, s16, 1152
    s_add_u32 s16, s16, 0x0
    s_add_u32 s78, s4, s16
    s_addc_u32 s79, s5, 0
    v_lshlrev_b32 v16, 2, v4
    global_load_dwordx4 v[244:247], v6, s[78:79] sc1
    global_load_dword v248, v16, s[78:79] offset:1024 sc1
    global_load_dwordx4 v[250:253], v6, s[78:79] offset:1152 sc1
    global_load_dword v254, v16, s[78:79] offset:2176 sc1
    s_waitcnt vmcnt(0)
    v_cmp_gt_u32 vcc, 32, v1
    v_mov_b32 v16, 0
    s_nop 0
    v_cndmask_b32 v248, v16, v248, vcc
    v_cndmask_b32 v254, v16, v254, vcc
    v_mov_b32 v240, 0
    v_dot2_f32_bf16 v240, v244, v244, v240
    v_dot2_f32_bf16 v240, v245, v245, v240
    v_dot2_f32_bf16 v240, v246, v246, v240
    v_dot2_f32_bf16 v240, v247, v247, v240
    v_dot2_f32_bf16 v240, v248, v248, v240
    v_mov_b32 v241, 0
    v_dot2_f32_bf16 v241, v250, v250, v241
    v_dot2_f32_bf16 v241, v251, v251, v241
    v_dot2_f32_bf16 v241, v252, v252, v241
    v_dot2_f32_bf16 v241, v253, v253, v241
    v_dot2_f32_bf16 v241, v254, v254, v241
    s_nop 2
    v_mov_b32 v16, v240
    v_mov_b32 v17, v241
    s_nop 1
    v_permlane32_swap_b32 v240, v16
    v_permlane32_swap_b32 v241, v17
    s_nop 1
    v_add_f32 v240, v240, v16
    v_add_f32 v241, v241, v17
    v_cmp_gt_u32 vcc, 32, v1
    v_mul_f32 v9, v240, v11
    v_mul_f32 v10, v241, v11
    v_sqrt_f32 v9, v9
    v_sqrt_f32 v10, v10
    s_nop 0
    v_mul_f32 v9, 0xbf810000, v9
    v_mul_f32 v10, 0xbf810000, v10
    v_cvt_pk_bf16_f32 v12, v9, v9
    v_lshlrev_b32 v12, 16, v12
    v_sub_f32 v12, v9, v12
    v_cvt_pk_bf16_f32 v12, v9, v12
    v_mov_b32 v13, 0
    v_cndmask_b32 v249, v13, v12, vcc
    v_cvt_pk_bf16_f32 v12, v10, v10
    v_lshlrev_b32 v12, 16, v12
    v_sub_f32 v12, v10, v12
    v_cvt_pk_bf16_f32 v12, v10, v12
    v_mov_b32 v13, 0
    v_cndmask_b32 v255, v13, v12, vcc
    s_waitcnt lgkmcnt(0)
    v_mfma_f32_32x32x16_bf16 v[48:63], v[80:83], v[244:247], 0
    v_mfma_f32_32x32x8_bf16 v[48:63], v[88:89], v[248:249], v[48:63]
    s_nop 15
.p2align 6
    v_exp_f32 v48, v48
    v_exp_f32 v49, v49
    v_exp_f32 v50, v50
    ds_read_b128 v[96:99], v110 offset:1216
    v_exp_f32 v51, v51
    v_exp_f32 v52, v52
    v_exp_f32 v53, v53
    v_exp_f32 v54, v54
    v_exp_f32 v55, v55
    v_mfma_f32_32x32x16_bf16 v[64:79], v[80:83], v[250:253], 0
    ds_read_b128 v[104:107], v110 offset:1824
    v_cvt_pk_bf16_f32 v48, v48, v49
    v_cvt_pk_bf16_f32 v49, v50, v51
    v_cvt_pk_bf16_f32 v50, v52, v53
    v_cvt_pk_bf16_f32 v51, v54, v55
    v_exp_f32 v56, v56
    v_exp_f32 v57, v57
    v_exp_f32 v58, v58
    v_mfma_f32_32x32x8_bf16 v[64:79], v[88:89], v[254:255], v[64:79]
    s_waitcnt lgkmcnt(2)
    v_exp_f32 v59, v59
    v_exp_f32 v60, v60
    v_exp_f32 v61, v61
    v_exp_f32 v62, v62
    v_exp_f32 v63, v63
    v_mfma_f32_32x32x16_bf16 v[16:31], v[92:95], v[48:51], 0
    s_add_u32 m0, s29, 0
    v_cvt_pk_bf16_f32 v52, v56, v57
    v_cvt_pk_bf16_f32 v53, v58, v59
    v_cvt_pk_bf16_f32 v54, v60, v61
    v_cvt_pk_bf16_f32 v55, v62, v63
    v_exp_f32 v64, v64
    v_exp_f32 v65, v65
    v_exp_f32 v66, v66
    v_mfma_f32_32x32x16_bf16 v[16:31], v[100:103], v[52:55], v[16:31]
    s_add_u32 s52, s24, 19968
    buffer_load_dwordx4 v6, s[32:35], s52 offen sc1 lds
    v_exp_f32 v67, v67
    v_exp_f32 v68, v68
    v_exp_f32 v69, v69
    v_exp_f32 v70, v70
    v_exp_f32 v71, v71
    v_mfma_f32_32x32x16_bf16 v[48:63], v[84:87], v[244:247], 0
    v_cvt_pk_bf16_f32 v64, v64, v65
    v_cvt_pk_bf16_f32 v65, v66, v67
    v_cvt_pk_bf16_f32 v66, v68, v69
    v_cvt_pk_bf16_f32 v67, v70, v71
    s_cmp_eq_u32 s13, 0
    s_cbranch_scc1 L_prio0
    s_setprio 1
L_prio0:
    v_exp_f32 v72, v72
    v_exp_f32 v73, v73
    v_exp_f32 v74, v74
    v_mfma_f32_32x32x8_bf16 v[48:63], v[90:91], v[248:249], v[48:63]
    ds_read_b128 v[80:83], v108 offset:2048
    v_exp_f32 v75, v75
    v_exp_f32 v76, v76
    v_exp_f32 v77, v77
    v_exp_f32 v78, v78
    v_exp_f32 v79, v79
    v_mfma_f32_32x32x16_bf16 v[32:47], v[92:95], v[64:67], 0
    ds_read_b64 v[88:89], v109 offset:512
    v_cvt_pk_bf16_f32 v68, v72, v73
    v_cvt_pk_bf16_f32 v69, v74, v75
    v_cvt_pk_bf16_f32 v70, v76, v77
    v_cvt_pk_bf16_f32 v71, v78, v79
    v_exp_f32 v48, v48
    v_exp_f32 v49, v49
    v_exp_f32 v50, v50
    v_mfma_f32_32x32x16_bf16 v[32:47], v[100:103], v[68:71], v[32:47]
    ds_read_b128 v[92:95], v110 offset:2432
    v_exp_f32 v51, v51
    v_exp_f32 v52, v52
    v_exp_f32 v53, v53
    v_exp_f32 v54, v54
    v_exp_f32 v55, v55
    v_mfma_f32_32x32x16_bf16 v[64:79], v[84:87], v[250:253], 0
    ds_read_b128 v[100:103], v110 offset:3040
    v_cvt_pk_bf16_f32 v48, v48, v49
    v_cvt_pk_bf16_f32 v49, v50, v51
    v_cvt_pk_bf16_f32 v50, v52, v53
    v_cvt_pk_bf16_f32 v51, v54, v55
    v_exp_f32 v56, v56
    v_exp_f32 v57, v57
    v_exp_f32 v58, v58
    v_mfma_f32_32x32x8_bf16 v[64:79], v[90:91], v[254:255], v[64:79]
    s_waitcnt lgkmcnt(2)
    v_exp_f32 v59, v59
    v_exp_f32 v60, v60
    v_exp_f32 v61, v61
    v_exp_f32 v62, v62
    v_exp_f32 v63, v63
    v_mfma_f32_32x32x16_bf16 v[16:31], v[96:99], v[48:51], v[16:31]
    s_add_u32 m0, s30, 0
    v_cvt_pk_bf16_f32 v52, v56, v57
    v_cvt_pk_bf16_f32 v53, v58, v59
    v_cvt_pk_bf16_f32 v54, v60, v61
    v_cvt_pk_bf16_f32 v55, v62, v63
    v_exp_f32 v64, v64
    v_exp_f32 v65, v65
    v_exp_f32 v66, v66
    v_mfma_f32_32x32x16_bf16 v[16:31], v[104:107], v[52:55], v[16:31]
    s_add_u32 s52, s25, 19968
    buffer_load_dwordx4 v6, s[32:35], s52 offen sc1 lds
    v_exp_f32 v67, v67
    v_exp_f32 v68, v68
    v_exp_f32 v69, v69
    v_exp_f32 v70, v70
    v_exp_f32 v71, v71
    v_mfma_f32_32x32x16_bf16 v[48:63], v[80:83], v[244:247], 0
    v_cvt_pk_bf16_f32 v64, v64, v65
    v_cvt_pk_bf16_f32 v65, v66, v67
    v_cvt_pk_bf16_f32 v66, v68, v69
    v_cvt_pk_bf16_f32 v67, v70, v71
    v_exp_f32 v72, v72
    v_exp_f32 v73, v73
    v_exp_f32 v74, v74
    v_mfma_f32_32x32x8_bf16 v[48:63], v[88:89], v[248:249], v[48:63]
    ds_read_b128 v[84:87], v108 offset:3072
    v_exp_f32 v75, v75
    v_exp_f32 v76, v76
    v_exp_f32 v77, v77
    v_exp_f32 v78, v78
    v_exp_f32 v79, v79
    v_mfma_f32_32x32x16_bf16 v[32:47], v[96:99], v[64:67], v[32:47]
    ds_read_b64 v[90:91], v109 offset:768
    v_cvt_pk_bf16_f32 v68, v72, v73
    v_cvt_pk_bf16_f32 v69, v74, v75
    v_cvt_pk_bf16_f32 v70, v76, v77
    v_cvt_pk_bf16_f32 v71, v78, v79
    v_exp_f32 v48, v48
    v_exp_f32 v49, v49
    v_exp_f32 v50, v50
    v_mfma_f32_32x32x16_bf16 v[32:47], v[104:107], v[68:71], v[32:47]
    ds_read_b128 v[96:99], v110 offset:3648
    v_exp_f32 v51, v51
    v_exp_f32 v52, v52
    v_exp_f32 v53, v53
    v_exp_f32 v54, v54
    v_exp_f32 v55, v55
    v_mfma_f32_32x32x16_bf16 v[64:79], v[80:83], v[250:253], 0
    ds_read_b128 v[104:107], v110 offset:4256
    v_cvt_pk_bf16_f32 v48, v48, v49
    v_cvt_pk_bf16_f32 v49, v50, v51
    v_cvt_pk_bf16_f32 v50, v52, v53
    v_cvt_pk_bf16_f32 v51, v54, v55
    v_exp_f32 v56, v56
    v_exp_f32 v57, v57
    v_exp_f32 v58, v58
    v_mfma_f32_32x32x8_bf16 v[64:79], v[88:89], v[254:255], v[64:79]
    s_waitcnt lgkmcnt(2)
    v_exp_f32 v59, v59
    v_exp_f32 v60, v60
    v_exp_f32 v61, v61
    v_exp_f32 v62, v62
    v_exp_f32 v63, v63
    v_mfma_f32_32x32x16_bf16 v[16:31], v[92:95], v[48:51], v[16:31]
    s_add_u32 m0, s31, 0
    v_cvt_pk_bf16_f32 v52, v56, v57
    v_cvt_pk_bf16_f32 v53, v58, v59
    v_cvt_pk_bf16_f32 v54, v60, v61
    v_cvt_pk_bf16_f32 v55, v62, v63
    v_exp_f32 v64, v64
    v_exp_f32 v65, v65
    v_exp_f32 v66, v66
    v_mfma_f32_32x32x16_bf16 v[16:31], v[100:103], v[52:55], v[16:31]
    s_add_u32 s52, s26, 19968
    s_mov_b64 exec, s[96:97]
    buffer_load_dwordx4 v6, s[32:35], s52 offen sc1 lds
    s_mov_b64 exec, -1
    v_exp_f32 v67, v67
    v_exp_f32 v68, v68
    v_exp_f32 v69, v69
    v_exp_f32 v70, v70
    v_exp_f32 v71, v71
    v_mfma_f32_32x32x16_bf16 v[48:63], v[84:87], v[244:247], 0
    v_cvt_pk_bf16_f32 v64, v64, v65
    v_cvt_pk_bf16_f32 v65, v66, v67
    v_cvt_pk_bf16_f32 v66, v68, v69
    v_cvt_pk_bf16_f32 v67, v70, v71
    s_cmp_eq_u32 s13, 0
    s_cbranch_scc1 L_prio2
    s_setprio 0
L_prio2:
    v_exp_f32 v72, v72
    v_exp_f32 v73, v73
    v_exp_f32 v74, v74
    v_mfma_f32_32x32x8_bf16 v[48:63], v[90:91], v[248:249], v[48:63]
    ds_read_b128 v[80:83], v108 offset:4096
    v_exp_f32 v75, v75
    v_exp_f32 v76, v76
    v_exp_f32 v77, v77
    v_exp_f32 v78, v78
    v_exp_f32 v79, v79
    v_mfma_f32_32x32x16_bf16 v[32:47], v[92:95], v[64:67], v[32:47]
    ds_read_b64 v[88:89], v109 offset:1024
    v_cvt_pk_bf16_f32 v68, v72, v73
    v_cvt_pk_bf16_f32 v69, v74, v75
    v_cvt_pk_bf16_f32 v70, v76, v77
    v_cvt_pk_bf16_f32 v71, v78, v79
    v_exp_f32 v48, v48
    v_exp_f32 v49, v49
    v_exp_f32 v50, v50
    v_mfma_f32_32x32x16_bf16 v[32:47], v[100:103], v[68:71], v[32:47]
    ds_read_b128 v[92:95], v110 offset:4864
    v_exp_f32 v51, v51
    v_exp_f32 v52, v52
    v_exp_f32 v53, v53
    v_exp_f32 v54, v54
    v_exp_f32 v55, v55
    v_mfma_f32_32x32x16_bf16 v[64:79], v[84:87], v[250:253], 0
    ds_read_b128 v[100:103], v110 offset:5472
    v_cvt_pk_bf16_f32 v48, v48, v49
    v_cvt_pk_bf16_f32 v49, v50, v51
    v_cvt_pk_bf16_f32 v50, v52, v53
    v_cvt_pk_bf16_f32 v51, v54, v55
    v_exp_f32 v56, v56
    v_exp_f32 v57, v57
    v_exp_f32 v58, v58
    v_mfma_f32_32x32x8_bf16 v[64:79], v[90:91], v[254:255], v[64:79]
    s_waitcnt lgkmcnt(2)
    v_exp_f32 v59, v59
    v_exp_f32 v60, v60
    v_exp_f32 v61, v61
    v_exp_f32 v62, v62
    v_exp_f32 v63, v63
    v_mfma_f32_32x32x16_bf16 v[16:31], v[96:99], v[48:51], v[16:31]
    s_add_u32 m0, s36, 0
    v_cvt_pk_bf16_f32 v52, v56, v57
    v_cvt_pk_bf16_f32 v53, v58, v59
    v_cvt_pk_bf16_f32 v54, v60, v61
    v_cvt_pk_bf16_f32 v55, v62, v63
    v_exp_f32 v64, v64
    v_exp_f32 v65, v65
    v_exp_f32 v66, v66
    v_mfma_f32_32x32x16_bf16 v[16:31], v[104:107], v[52:55], v[16:31]
    s_add_u32 s52, s27, 19968
    buffer_load_dwordx4 v6, s[32:35], s52 offen sc1 lds
    v_exp_f32 v67, v67
    v_exp_f32 v68, v68
    v_exp_f32 v69, v69
    v_exp_f32 v70, v70
    v_exp_f32 v71, v71
    v_mfma_f32_32x32x16_bf16 v[48:63], v[80:83], v[244:247], 0
    v_cvt_pk_bf16_f32 v64, v64, v65
    v_cvt_pk_bf16_f32 v65, v66, v67
    v_cvt_pk_bf16_f32 v66, v68, v69
    v_cvt_pk_bf16_f32 v67, v70, v71
    v_exp_f32 v72, v72
    v_exp_f32 v73, v73
    v_exp_f32 v74, v74
    v_mfma_f32_32x32x8_bf16 v[48:63], v[88:89], v[248:249], v[48:63]
    ds_read_b128 v[84:87], v108 offset:5120
    v_exp_f32 v75, v75
    v_exp_f32 v76, v76
    v_exp_f32 v77, v77
    v_exp_f32 v78, v78
    v_exp_f32 v79, v79
    v_mfma_f32_32x32x16_bf16 v[32:47], v[96:99], v[64:67], v[32:47]
    ds_read_b64 v[90:91], v109 offset:1280
    v_cvt_pk_bf16_f32 v68, v72, v73
    v_cvt_pk_bf16_f32 v69, v74, v75
    v_cvt_pk_bf16_f32 v70, v76, v77
    v_cvt_pk_bf16_f32 v71, v78, v79
    v_exp_f32 v48, v48
    v_exp_f32 v49, v49
    v_exp_f32 v50, v50
    v_mfma_f32_32x32x16_bf16 v[32:47], v[104:107], v[68:71], v[32:47]
    ds_read_b128 v[96:99], v110 offset:6080
    v_exp_f32 v51, v51
    v_exp_f32 v52, v52
    v_exp_f32 v53, v53
    v_exp_f32 v54, v54
    v_exp_f32 v55, v55
    v_mfma_f32_32x32x16_bf16 v[64:79], v[80:83], v[250:253], 0
    ds_read_b128 v[104:107], v110 offset:6688
    v_cvt_pk_bf16_f32 v48, v48, v49
    v_cvt_pk_bf16_f32 v49, v50, v51
    v_cvt_pk_bf16_f32 v50, v52, v53
    v_cvt_pk_bf16_f32 v51, v54, v55
    v_exp_f32 v56, v56
    v_exp_f32 v57, v57
    v_exp_f32 v58, v58
    v_mfma_f32_32x32x8_bf16 v[64:79], v[88:89], v[254:255], v[64:79]
    s_waitcnt lgkmcnt(2)
    v_exp_f32 v59, v59
    v_exp_f32 v60, v60
    v_exp_f32 v61, v61
    v_exp_f32 v62, v62
    v_exp_f32 v63, v63
    v_mfma_f32_32x32x16_bf16 v[16:31], v[92:95], v[48:51], v[16:31]
    s_add_u32 m0, s37, 0
    v_cvt_pk_bf16_f32 v52, v56, v57
    v_cvt_pk_bf16_f32 v53, v58, v59
    v_cvt_pk_bf16_f32 v54, v60, v61
    v_cvt_pk_bf16_f32 v55, v62, v63
    v_exp_f32 v64, v64
    v_exp_f32 v65, v65
    v_exp_f32 v66, v66
    v_mfma_f32_32x32x16_bf16 v[16:31], v[100:103], v[52:55], v[16:31]
    s_add_u32 s52, s28, 19968
    s_mov_b64 exec, s[98:99]
    buffer_load_dwordx4 v6, s[32:35], s52 offen sc1 lds
    s_mov_b64 exec, -1
    v_exp_f32 v67, v67
    v_exp_f32 v68, v68
    v_exp_f32 v69, v69
    v_exp_f32 v70, v70
    v_exp_f32 v71, v71
    v_mfma_f32_32x32x16_bf16 v[48:63], v[84:87], v[244:247], 0
    v_cvt_pk_bf16_f32 v64, v64, v65
    v_cvt_pk_bf16_f32 v65, v66, v67
    v_cvt_pk_bf16_f32 v66, v68, v69
    v_cvt_pk_bf16_f32 v67, v70, v71
    s_waitcnt vmcnt(5)
    s_barrier
    s_lshl_b32 s16, s2, 7
    s_add_u32 s16, s16, 0xf18000
    v_mov_b32 v8, s16
    v_mov_b32 v9, s3
    s_cmp_eq_u32 s8, 0
    s_cselect_b32 exec_lo, 1, 0
    s_mov_b32 exec_hi, 0
    global_store_dword v8, v9, s[4:5] sc1
    s_mov_b64 exec, -1
    s_cmp_lg_u32 s8, 0
    s_cbranch_scc1 L_h_kva
    s_lshr_b32 s16, s2, 3
    s_and_b32 s17, s2, 7
    s_mul_i32 s17, s17, 22
    v_add_u32 v8, s17, v1
    v_min_u32 v8, 170, v8
    v_mul_u32_u24 v9, 7282, v8
    v_lshrrev_b32 v9, 16, v9
    v_mul_u32_u24 v10, 9, v9
    v_sub_u32 v10, v8, v10
    s_and_b32 s18, s16, 3
    s_mul_i32 s18, s18, 18
    v_lshl_add_u32 v11, v10, 1, s18
    v_lshrrev_b32 v12, 4, v11
    v_and_b32 v11, 15, v11
    s_add_u32 s19, s18, 72
    v_add_u32 v13, s19, v9
    v_lshrrev_b32 v138, 4, v13
    v_and_b32 v13, 15, v13
    v_lshl_add_u32 v138, v12, 1, v138
    v_subrev_u32 v138, 3, v138
    v_add_u32 v139, 15, v12
    v_cmp_eq_u32 vcc, 18, v9
    v_mov_b32 v140, 0
    s_nop 0
    v_cndmask_b32 v138, v138, v139, vcc
    v_cndmask_b32 v13, v13, v140, vcc
    v_lshrrev_b32 v139, 2, v11
    v_lshl_add_u32 v139, v139, 4, v13
    v_lshlrev_b32 v139, 4, v139
    v_lshl_add_u32 v139, v138, 10, v139
    v_and_b32 v11, 3, v11
    v_lshl_add_u32 v243, v11, 2, v139
    v_lshrrev_b32 v138, 2, v10
    v_lshl_add_u32 v138, v138, 5, v9
    v_lshlrev_b32 v138, 4, v138
    v_and_b32 v139, 3, v10
    v_lshl_add_u32 v138, v139, 2, v138
    v_lshlrev_b32 v139, 2, v9
    v_add_u32 v139, 1024, v139
    v_cmp_eq_u32 vcc, 8, v10
    s_mul_i32 s19, s16, 1280
    s_nop 0
    v_cndmask_b32 v138, v138, v139, vcc
    v_add_u32 v242, s19, v138
    v_add_u32 v242, 0x730000, v242
    v_add_u32 v8, s17, v1
    v_cmp_gt_u32 vcc, 171, v8
    v_cmp_gt_u32 s[72:73], 22, v1
    s_and_b64 vcc, vcc, s[72:73]
    v_mov_b32 v138, -1
    s_nop 0
    v_cndmask_b32 v242, v138, v242, vcc
    s_lshr_b32 s16, s16, 2
    s_mul_i32 s16, s16, 20480
    s_add_u32 s16, s16, 0x4b0000
    s_add_u32 s62, s4, s16
    s_addc_u32 s63, s5, 0
L_h_kva:
    s_cmp_eq_u32 s13, 0
    s_cbranch_scc1 L_prio4
    s_setprio 1
L_prio4:
    v_exp_f32 v72, v72
    v_exp_f32 v73, v73
    v_exp_f32 v74, v74
    v_mfma_f32_32x32x8_bf16 v[48:63], v[90:91], v[248:249], v[48:63]
    ds_read_b128 v[80:83], v108 offset:6144
    v_exp_f32 v75, v75
    v_exp_f32 v76, v76
    v_exp_f32 v77, v77
    v_exp_f32 v78, v78
    v_exp_f32 v79, v79
    v_mfma_f32_32x32x16_bf16 v[32:47], v[92:95], v[64:67], v[32:47]
    ds_read_b64 v[88:89], v109 offset:1536
    v_cvt_pk_bf16_f32 v68, v72, v73
    v_cvt_pk_bf16_f32 v69, v74, v75
    v_cvt_pk_bf16_f32 v70, v76, v77
    v_cvt_pk_bf16_f32 v71, v78, v79
    v_exp_f32 v48, v48
    v_exp_f32 v49, v49
    v_exp_f32 v50, v50
    v_mfma_f32_32x32x16_bf16 v[32:47], v[100:103], v[68:71], v[32:47]
    ds_read_b128 v[92:95], v110 offset:7296
    v_exp_f32 v51, v51
    v_exp_f32 v52, v52
    v_exp_f32 v53, v53
    v_exp_f32 v54, v54
    v_exp_f32 v55, v55
    v_mfma_f32_32x32x16_bf16 v[64:79], v[84:87], v[250:253], 0
    ds_read_b128 v[100:103], v110 offset:7904
    v_cvt_pk_bf16_f32 v48, v48, v49
    v_cvt_pk_bf16_f32 v49, v50, v51
    v_cvt_pk_bf16_f32 v50, v52, v53
    v_cvt_pk_bf16_f32 v51, v54, v55
    v_exp_f32 v56, v56
    v_exp_f32 v57, v57
    v_exp_f32 v58, v58
    v_mfma_f32_32x32x8_bf16 v[64:79], v[90:91], v[254:255], v[64:79]
    s_waitcnt lgkmcnt(2)
    v_exp_f32 v59, v59
    v_exp_f32 v60, v60
    v_exp_f32 v61, v61
    v_exp_f32 v62, v62
    v_exp_f32 v63, v63
    v_mfma_f32_32x32x16_bf16 v[16:31], v[96:99], v[48:51], v[16:31]
    s_nop 0
    v_cvt_pk_bf16_f32 v52, v56, v57
    v_cvt_pk_bf16_f32 v53, v58, v59
    v_cvt_pk_bf16_f32 v54, v60, v61
    v_cvt_pk_bf16_f32 v55, v62, v63
    v_exp_f32 v64, v64
    v_exp_f32 v65, v65
    v_exp_f32 v66, v66
    v_mfma_f32_32x32x16_bf16 v[16:31], v[104:107], v[52:55], v[16:31]
    v_exp_f32 v67, v67
    v_exp_f32 v68, v68
    v_exp_f32 v69, v69
    v_exp_f32 v70, v70
    v_exp_f32 v71, v71
    v_mfma_f32_32x32x16_bf16 v[48:63], v[80:83], v[244:247], 0
    v_cvt_pk_bf16_f32 v64, v64, v65
    v_cvt_pk_bf16_f32 v65, v66, v67
    v_cvt_pk_bf16_f32 v66, v68, v69
    v_cvt_pk_bf16_f32 v67, v70, v71
    s_cmp_eq_u32 s13, 0
    s_cbranch_scc1 L_prio5
    s_setprio 0
L_prio5:
    v_exp_f32 v72, v72
    v_exp_f32 v73, v73
    v_exp_f32 v74, v74
    v_mfma_f32_32x32x8_bf16 v[48:63], v[88:89], v[248:249], v[48:63]
    ds_read_b128 v[84:87], v108 offset:7168
    v_exp_f32 v75, v75
    v_exp_f32 v76, v76
    v_exp_f32 v77, v77
    v_exp_f32 v78, v78
    v_exp_f32 v79, v79
    v_mfma_f32_32x32x16_bf16 v[32:47], v[96:99], v[64:67], v[32:47]
    ds_read_b64 v[90:91], v109 offset:1792
    v_cvt_pk_bf16_f32 v68, v72, v73
    v_cvt_pk_bf16_f32 v69, v74, v75
    v_cvt_pk_bf16_f32 v70, v76, v77
    v_cvt_pk_bf16_f32 v71, v78, v79
    v_exp_f32 v48, v48
    v_exp_f32 v49, v49
    v_exp_f32 v50, v50
    v_mfma_f32_32x32x16_bf16 v[32:47], v[104:107], v[68:71], v[32:47]
    ds_read_b128 v[96:99], v110 offset:8512
    v_exp_f32 v51, v51
    v_exp_f32 v52, v52
    v_exp_f32 v53, v53
    v_exp_f32 v54, v54
    v_exp_f32 v55, v55
    v_mfma_f32_32x32x16_bf16 v[64:79], v[80:83], v[250:253], 0
    ds_read_b128 v[104:107], v110 offset:9120
    v_cvt_pk_bf16_f32 v48, v48, v49
    v_cvt_pk_bf16_f32 v49, v50, v51
    v_cvt_pk_bf16_f32 v50, v52, v53
    v_cvt_pk_bf16_f32 v51, v54, v55
    v_exp_f32 v56, v56
    v_exp_f32 v57, v57
    v_exp_f32 v58, v58
    v_mfma_f32_32x32x8_bf16 v[64:79], v[88:89], v[254:255], v[64:79]
    s_waitcnt lgkmcnt(2)
    v_exp_f32 v59, v59
    v_exp_f32 v60, v60
    v_exp_f32 v61, v61
    v_exp_f32 v62, v62
    v_exp_f32 v63, v63
    v_mfma_f32_32x32x16_bf16 v[16:31], v[92:95], v[48:51], v[16:31]
    s_nop 0
    v_cvt_pk_bf16_f32 v52, v56, v57
    v_cvt_pk_bf16_f32 v53, v58, v59
    v_cvt_pk_bf16_f32 v54, v60, v61
    v_cvt_pk_bf16_f32 v55, v62, v63
    v_exp_f32 v64, v64
    v_exp_f32 v65, v65
    v_exp_f32 v66, v66
    v_mfma_f32_32x32x16_bf16 v[16:31], v[100:103], v[52:55], v[16:31]
    v_exp_f32 v67, v67
    v_exp_f32 v68, v68
    v_exp_f32 v69, v69
    v_exp_f32 v70, v70
    v_exp_f32 v71, v71
    v_mfma_f32_32x32x16_bf16 v[48:63], v[84:87], v[244:247], 0
    v_cvt_pk_bf16_f32 v64, v64, v65
    v_cvt_pk_bf16_f32 v65, v66, v67
    v_cvt_pk_bf16_f32 v66, v68, v69
    v_cvt_pk_bf16_f32 v67, v70, v71
    s_waitcnt vmcnt(1)
    s_barrier
    s_cmp_eq_u32 s13, 0
    s_cbranch_scc1 L_prio6
    s_setprio 1
L_prio6:
    v_exp_f32 v72, v72
    v_exp_f32 v73, v73
    v_exp_f32 v74, v74
    v_mfma_f32_32x32x8_bf16 v[48:63], v[90:91], v[248:249], v[48:63]
    ds_read_b128 v[80:83], v111 offset:0
    v_exp_f32 v75, v75
    v_exp_f32 v76, v76
    v_exp_f32 v77, v77
    v_exp_f32 v78, v78
    v_exp_f32 v79, v79
    v_mfma_f32_32x32x16_bf16 v[32:47], v[92:95], v[64:67], v[32:47]
    ds_read_b64 v[88:89], v112 offset:0
    v_cvt_pk_bf16_f32 v68, v72, v73
    v_cvt_pk_bf16_f32 v69, v74, v75
    v_cvt_pk_bf16_f32 v70, v76, v77
    v_cvt_pk_bf16_f32 v71, v78, v79
    v_exp_f32 v48, v48
    v_exp_f32 v49, v49
    v_exp_f32 v50, v50
    v_mfma_f32_32x32x16_bf16 v[32:47], v[100:103], v[68:71], v[32:47]
    ds_read_b128 v[92:95], v113 offset:0
    v_exp_f32 v51, v51
    v_exp_f32 v52, v52
    v_exp_f32 v53, v53
    v_exp_f32 v54, v54
    v_exp_f32 v55, v55
    v_mfma_f32_32x32x16_bf16 v[64:79], v[84:87], v[250:253], 0
    ds_read_b128 v[100:103], v113 offset:608
    v_cvt_pk_bf16_f32 v48, v48, v49
    v_cvt_pk_bf16_f32 v49, v50, v51
    v_cvt_pk_bf16_f32 v50, v52, v53
    v_cvt_pk_bf16_f32 v51, v54, v55
    v_exp_f32 v56, v56
    v_exp_f32 v57, v57
    v_exp_f32 v58, v58
    v_mfma_f32_32x32x8_bf16 v[64:79], v[90:91], v[254:255], v[64:79]
    s_waitcnt lgkmcnt(2)
    v_exp_f32 v59, v59
    v_exp_f32 v60, v60
    v_exp_f32 v61, v61
    v_exp_f32 v62, v62
    v_exp_f32 v63, v63
    v_mfma_f32_32x32x16_bf16 v[16:31], v[96:99], v[48:51], v[16:31]
    s_nop 0
    v_cvt_pk_bf16_f32 v52, v56, v57
    v_cvt_pk_bf16_f32 v53, v58, v59
    v_cvt_pk_bf16_f32 v54, v60, v61
    v_cvt_pk_bf16_f32 v55, v62, v63
    v_exp_f32 v64, v64
    v_exp_f32 v65, v65
    v_exp_f32 v66, v66
    v_mfma_f32_32x32x16_bf16 v[16:31], v[104:107], v[52:55], v[16:31]
    v_exp_f32 v67, v67
    v_exp_f32 v68, v68
    v_exp_f32 v69, v69
    v_exp_f32 v70, v70
    v_exp_f32 v71, v71
    v_mfma_f32_32x32x16_bf16 v[48:63], v[80:83], v[244:247], 0
    v_cvt_pk_bf16_f32 v64, v64, v65
    v_cvt_pk_bf16_f32 v65, v66, v67
    v_cvt_pk_bf16_f32 v66, v68, v69
    v_cvt_pk_bf16_f32 v67, v70, v71
    v_exp_f32 v72, v72
    v_exp_f32 v73, v73
    v_exp_f32 v74, v74
    v_mfma_f32_32x32x8_bf16 v[48:63], v[88:89], v[248:249], v[48:63]
    ds_read_b128 v[84:87], v111 offset:1024
    v_exp_f32 v75, v75
    v_exp_f32 v76, v76
    v_exp_f32 v77, v77
    v_exp_f32 v78, v78
    v_exp_f32 v79, v79
    v_mfma_f32_32x32x16_bf16 v[32:47], v[96:99], v[64:67], v[32:47]
    ds_read_b64 v[90:91], v112 offset:256
    v_cvt_pk_bf16_f32 v68, v72, v73
    v_cvt_pk_bf16_f32 v69, v74, v75
    v_cvt_pk_bf16_f32 v70, v76, v77
    v_cvt_pk_bf16_f32 v71, v78, v79
    v_mov_b32 v108, v111
    v_mov_b32 v109, v112
    v_mov_b32 v110, v113
    v_add_u32 v111, 39936, v114
    v_add_u32 v112, 39936, v115
    v_add_u32 v113, 39936, v116
    v_exp_f32 v48, v48
    v_exp_f32 v49, v49
    v_exp_f32 v50, v50
    v_mfma_f32_32x32x16_bf16 v[32:47], v[104:107], v[68:71], v[32:47]
    ds_read_b128 v[96:99], v110 offset:1216
    v_exp_f32 v51, v51
    v_exp_f32 v52, v52
    v_exp_f32 v53, v53
    v_exp_f32 v54, v54
    v_exp_f32 v55, v55
    v_mfma_f32_32x32x16_bf16 v[64:79], v[80:83], v[250:253], 0
    ds_read_b128 v[104:107], v110 offset:1824
    v_cvt_pk_bf16_f32 v48, v48, v49
    v_cvt_pk_bf16_f32 v49, v50, v51
    v_cvt_pk_bf16_f32 v50, v52, v53
    v_cvt_pk_bf16_f32 v51, v54, v55
    v_exp_f32 v56, v56
    v_exp_f32 v57, v57
    v_exp_f32 v58, v58
    v_mfma_f32_32x32x8_bf16 v[64:79], v[88:89], v[254:255], v[64:79]
    s_waitcnt lgkmcnt(2)
    v_exp_f32 v59, v59
    v_exp_f32 v60, v60
    v_exp_f32 v61, v61
    v_exp_f32 v62, v62
    v_exp_f32 v63, v63
    v_mfma_f32_32x32x16_bf16 v[16:31], v[92:95], v[48:51], v[16:31]
    s_add_u32 m0, s29, 39936
    v_cvt_pk_bf16_f32 v52, v56, v57
    v_cvt_pk_bf16_f32 v53, v58, v59
    v_cvt_pk_bf16_f32 v54, v60, v61
    v_cvt_pk_bf16_f32 v55, v62, v63
    v_exp_f32 v64, v64
    v_exp_f32 v65, v65
    v_exp_f32 v66, v66
    v_mfma_f32_32x32x16_bf16 v[16:31], v[100:103], v[52:55], v[16:31]
    s_add_u32 s52, s24, 39936
    buffer_load_dwordx4 v6, s[32:35], s52 offen sc1 lds
    v_exp_f32 v67, v67
    v_exp_f32 v68, v68
    v_exp_f32 v69, v69
    v_exp_f32 v70, v70
    v_exp_f32 v71, v71
    v_mfma_f32_32x32x16_bf16 v[48:63], v[84:87], v[244:247], 0
    v_cvt_pk_bf16_f32 v64, v64, v65
    v_cvt_pk_bf16_f32 v65, v66, v67
    v_cvt_pk_bf16_f32 v66, v68, v69
    v_cvt_pk_bf16_f32 v67, v70, v71
    v_exp_f32 v72, v72
    v_exp_f32 v73, v73
    v_exp_f32 v74, v74
    v_mfma_f32_32x32x8_bf16 v[48:63], v[90:91], v[248:249], v[48:63]
    ds_read_b128 v[80:83], v108 offset:2048
    v_exp_f32 v75, v75
    v_exp_f32 v76, v76
    v_exp_f32 v77, v77
    v_exp_f32 v78, v78
    v_exp_f32 v79, v79
    v_mfma_f32_32x32x16_bf16 v[32:47], v[92:95], v[64:67], v[32:47]
    ds_read_b64 v[88:89], v109 offset:512
    v_cvt_pk_bf16_f32 v68, v72, v73
    v_cvt_pk_bf16_f32 v69, v74, v75
    v_cvt_pk_bf16_f32 v70, v76, v77
    v_cvt_pk_bf16_f32 v71, v78, v79
    v_exp_f32 v48, v48
    v_exp_f32 v49, v49
    v_exp_f32 v50, v50
    v_mfma_f32_32x32x16_bf16 v[32:47], v[100:103], v[68:71], v[32:47]
    ds_read_b128 v[92:95], v110 offset:2432
    v_exp_f32 v51, v51
    v_exp_f32 v52, v52
    v_exp_f32 v53, v53
    v_exp_f32 v54, v54
    v_exp_f32 v55, v55
    v_mfma_f32_32x32x16_bf16 v[64:79], v[84:87], v[250:253], 0
    ds_read_b128 v[100:103], v110 offset:3040
    v_cvt_pk_bf16_f32 v48, v48, v49
    v_cvt_pk_bf16_f32 v49, v50, v51
    v_cvt_pk_bf16_f32 v50, v52, v53
    v_cvt_pk_bf16_f32 v51, v54, v55
    v_exp_f32 v56, v56
    v_exp_f32 v57, v57
    v_exp_f32 v58, v58
    v_mfma_f32_32x32x8_bf16 v[64:79], v[90:91], v[254:255], v[64:79]
    s_waitcnt lgkmcnt(2)
    v_exp_f32 v59, v59
    v_exp_f32 v60, v60
    v_exp_f32 v61, v61
    v_exp_f32 v62, v62
    v_exp_f32 v63, v63
    v_mfma_f32_32x32x16_bf16 v[16:31], v[96:99], v[48:51], v[16:31]
    s_add_u32 m0, s30, 39936
    v_cvt_pk_bf16_f32 v52, v56, v57
    v_cvt_pk_bf16_f32 v53, v58, v59
    v_cvt_pk_bf16_f32 v54, v60, v61
    v_cvt_pk_bf16_f32 v55, v62, v63
    v_exp_f32 v64, v64
    v_exp_f32 v65, v65
    v_exp_f32 v66, v66
    v_mfma_f32_32x32x16_bf16 v[16:31], v[104:107], v[52:55], v[16:31]
    s_add_u32 s52, s25, 39936
    buffer_load_dwordx4 v6, s[32:35], s52 offen sc1 lds
    v_exp_f32 v67, v67
    v_exp_f32 v68, v68
    v_exp_f32 v69, v69
    v_exp_f32 v70, v70
    v_exp_f32 v71, v71
    v_mfma_f32_32x32x16_bf16 v[48:63], v[80:83], v[244:247], 0
    v_cvt_pk_bf16_f32 v64, v64, v65
    v_cvt_pk_bf16_f32 v65, v66, v67
    v_cvt_pk_bf16_f32 v66, v68, v69
    v_cvt_pk_bf16_f32 v67, v70, v71
    v_exp_f32 v72, v72
    v_exp_f32 v73, v73
    v_exp_f32 v74, v74
    v_mfma_f32_32x32x8_bf16 v[48:63], v[88:89], v[248:249], v[48:63]
    ds_read_b128 v[84:87], v108 offset:3072
    v_exp_f32 v75, v75
    v_exp_f32 v76, v76
    v_exp_f32 v77, v77
    v_exp_f32 v78, v78
    v_exp_f32 v79, v79
    v_mfma_f32_32x32x16_bf16 v[32:47], v[96:99], v[64:67], v[32:47]
    ds_read_b64 v[90:91], v109 offset:768
    v_cvt_pk_bf16_f32 v68, v72, v73
    v_cvt_pk_bf16_f32 v69, v74, v75
    v_cvt_pk_bf16_f32 v70, v76, v77
    v_cvt_pk_bf16_f32 v71, v78, v79
    v_exp_f32 v48, v48
    v_exp_f32 v49, v49
    v_exp_f32 v50, v50
    v_mfma_f32_32x32x16_bf16 v[32:47], v[104:107], v[68:71], v[32:47]
    ds_read_b128 v[96:99], v110 offset:3648
    v_exp_f32 v51, v51
    v_exp_f32 v52, v52
    v_exp_f32 v53, v53
    v_exp_f32 v54, v54
    v_exp_f32 v55, v55
    v_mfma_f32_32x32x16_bf16 v[64:79], v[80:83], v[250:253], 0
    ds_read_b128 v[104:107], v110 offset:4256
    v_cvt_pk_bf16_f32 v48, v48, v49
    v_cvt_pk_bf16_f32 v49, v50, v51
    v_cvt_pk_bf16_f32 v50, v52, v53
    v_cvt_pk_bf16_f32 v51, v54, v55
    v_exp_f32 v56, v56
    v_exp_f32 v57, v57
    v_exp_f32 v58, v58
    v_mfma_f32_32x32x8_bf16 v[64:79], v[88:89], v[254:255], v[64:79]
    s_waitcnt lgkmcnt(2)
    v_exp_f32 v59, v59
    v_exp_f32 v60, v60
    v_exp_f32 v61, v61
    v_exp_f32 v62, v62
    v_exp_f32 v63, v63
    v_mfma_f32_32x32x16_bf16 v[16:31], v[92:95], v[48:51], v[16:31]
    s_add_u32 m0, s31, 39936
    v_cvt_pk_bf16_f32 v52, v56, v57
    v_cvt_pk_bf16_f32 v53, v58, v59
    v_cvt_pk_bf16_f32 v54, v60, v61
    v_cvt_pk_bf16_f32 v55, v62, v63
    v_exp_f32 v64, v64
    v_exp_f32 v65, v65
    v_exp_f32 v66, v66
    v_mfma_f32_32x32x16_bf16 v[16:31], v[100:103], v[52:55], v[16:31]
    s_add_u32 s52, s26, 39936
    s_mov_b64 exec, s[96:97]
    buffer_load_dwordx4 v6, s[32:35], s52 offen sc1 lds
    s_mov_b64 exec, -1
    v_exp_f32 v67, v67
    v_exp_f32 v68, v68
    v_exp_f32 v69, v69
    v_exp_f32 v70, v70
    v_exp_f32 v71, v71
    v_mfma_f32_32x32x16_bf16 v[48:63], v[84:87], v[244:247], 0
    v_cvt_pk_bf16_f32 v64, v64, v65
    v_cvt_pk_bf16_f32 v65, v66, v67
    v_cvt_pk_bf16_f32 v66, v68, v69
    v_cvt_pk_bf16_f32 v67, v70, v71
    s_cmp_lg_u32 s8, 0
    s_cbranch_scc1 L_h_fbi
    v_lshlrev_b32 v12, 7, v1
    v_add_u32 v12, 0xf18000, v12
    global_load_dword v8, v12, s[4:5] sc1
    v_add_u32 v12, 8192, v12
    global_load_dword v9, v12, s[4:5] sc1
    v_add_u32 v12, 8192, v12
    global_load_dword v10, v12, s[4:5] sc1
    v_add_u32 v12, 8192, v12
    global_load_dword v11, v12, s[4:5] sc1
L_h_fbi:
    v_exp_f32 v72, v72
    v_exp_f32 v73, v73
    v_exp_f32 v74, v74
    v_mfma_f32_32x32x8_bf16 v[48:63], v[90:91], v[248:249], v[48:63]
    ds_read_b128 v[80:83], v108 offset:4096
    v_exp_f32 v75, v75
    v_exp_f32 v76, v76
    v_exp_f32 v77, v77
    v_exp_f32 v78, v78
    v_exp_f32 v79, v79
    v_mfma_f32_32x32x16_bf16 v[32:47], v[92:95], v[64:67], v[32:47]
    ds_read_b64 v[88:89], v109 offset:1024
    v_cvt_pk_bf16_f32 v68, v72, v73
    v_cvt_pk_bf16_f32 v69, v74, v75
    v_cvt_pk_bf16_f32 v70, v76, v77
    v_cvt_pk_bf16_f32 v71, v78, v79
    v_exp_f32 v48, v48
    v_exp_f32 v49, v49
    v_exp_f32 v50, v50
    v_mfma_f32_32x32x16_bf16 v[32:47], v[100:103], v[68:71], v[32:47]
    ds_read_b128 v[92:95], v110 offset:4864
    v_exp_f32 v51, v51
    v_exp_f32 v52, v52
    v_exp_f32 v53, v53
    v_exp_f32 v54, v54
    v_exp_f32 v55, v55
    v_mfma_f32_32x32x16_bf16 v[64:79], v[84:87], v[250:253], 0
    ds_read_b128 v[100:103], v110 offset:5472
    v_cvt_pk_bf16_f32 v48, v48, v49
    v_cvt_pk_bf16_f32 v49, v50, v51
    v_cvt_pk_bf16_f32 v50, v52, v53
    v_cvt_pk_bf16_f32 v51, v54, v55
    v_exp_f32 v56, v56
    v_exp_f32 v57, v57
    v_exp_f32 v58, v58
    v_mfma_f32_32x32x8_bf16 v[64:79], v[90:91], v[254:255], v[64:79]
    s_waitcnt lgkmcnt(2)
    v_exp_f32 v59, v59
    v_exp_f32 v60, v60
    v_exp_f32 v61, v61
    v_exp_f32 v62, v62
    v_exp_f32 v63, v63
    v_mfma_f32_32x32x16_bf16 v[16:31], v[96:99], v[48:51], v[16:31]
    s_add_u32 m0, s36, 39936
    v_cvt_pk_bf16_f32 v52, v56, v57
    v_cvt_pk_bf16_f32 v53, v58, v59
    v_cvt_pk_bf16_f32 v54, v60, v61
    v_cvt_pk_bf16_f32 v55, v62, v63
    v_exp_f32 v64, v64
    v_exp_f32 v65, v65
    v_exp_f32 v66, v66
    v_mfma_f32_32x32x16_bf16 v[16:31], v[104:107], v[52:55], v[16:31]
    s_add_u32 s52, s27, 39936
    buffer_load_dwordx4 v6, s[32:35], s52 offen sc1 lds
    v_exp_f32 v67, v67
    v_exp_f32 v68, v68
    v_exp_f32 v69, v69
    v_exp_f32 v70, v70
    v_exp_f32 v71, v71
    v_mfma_f32_32x32x16_bf16 v[48:63], v[80:83], v[244:247], 0
    v_cvt_pk_bf16_f32 v64, v64, v65
    v_cvt_pk_bf16_f32 v65, v66, v67
    v_cvt_pk_bf16_f32 v66, v68, v69
    v_cvt_pk_bf16_f32 v67, v70, v71
    s_cmp_eq_u32 s13, 0
    s_cbranch_scc1 L_prio11
    s_setprio 0
L_prio11:
    v_exp_f32 v72, v72
    v_exp_f32 v73, v73
    v_exp_f32 v74, v74
    v_mfma_f32_32x32x8_bf16 v[48:63], v[88:89], v[248:249], v[48:63]
    ds_read_b128 v[84:87], v108 offset:5120
    v_exp_f32 v75, v75
    v_exp_f32 v76, v76
    v_exp_f32 v77, v77
    v_exp_f32 v78, v78
    v_exp_f32 v79, v79
    v_mfma_f32_32x32x16_bf16 v[32:47], v[96:99], v[64:67], v[32:47]
    ds_read_b64 v[90:91], v109 offset:1280
    v_cvt_pk_bf16_f32 v68, v72, v73
    v_cvt_pk_bf16_f32 v69, v74, v75
    v_cvt_pk_bf16_f32 v70, v76, v77
    v_cvt_pk_bf16_f32 v71, v78, v79
    v_exp_f32 v48, v48
    v_exp_f32 v49, v49
    v_exp_f32 v50, v50
    v_mfma_f32_32x32x16_bf16 v[32:47], v[104:107], v[68:71], v[32:47]
    ds_read_b128 v[96:99], v110 offset:6080
    v_exp_f32 v51, v51
    v_exp_f32 v52, v52
    v_exp_f32 v53, v53
    v_exp_f32 v54, v54
    v_exp_f32 v55, v55
    v_mfma_f32_32x32x16_bf16 v[64:79], v[80:83], v[250:253], 0
    ds_read_b128 v[104:107], v110 offset:6688
    v_cvt_pk_bf16_f32 v48, v48, v49
    v_cvt_pk_bf16_f32 v49, v50, v51
    v_cvt_pk_bf16_f32 v50, v52, v53
    v_cvt_pk_bf16_f32 v51, v54, v55
    v_exp_f32 v56, v56
    v_exp_f32 v57, v57
    v_exp_f32 v58, v58
    v_mfma_f32_32x32x8_bf16 v[64:79], v[88:89], v[254:255], v[64:79]
    s_waitcnt lgkmcnt(2)
    v_exp_f32 v59, v59
    v_exp_f32 v60, v60
    v_exp_f32 v61, v61
    v_exp_f32 v62, v62
    v_exp_f32 v63, v63
    v_mfma_f32_32x32x16_bf16 v[16:31], v[92:95], v[48:51], v[16:31]
    s_add_u32 m0, s37, 39936
    v_cvt_pk_bf16_f32 v52, v56, v57
    v_cvt_pk_bf16_f32 v53, v58, v59
    v_cvt_pk_bf16_f32 v54, v60, v61
    v_cvt_pk_bf16_f32 v55, v62, v63
    v_exp_f32 v64, v64
    v_exp_f32 v65, v65
    v_exp_f32 v66, v66
    v_mfma_f32_32x32x16_bf16 v[16:31], v[100:103], v[52:55], v[16:31]
    s_add_u32 s52, s28, 39936
    s_mov_b64 exec, s[98:99]
    buffer_load_dwordx4 v6, s[32:35], s52 offen sc1 lds
    s_mov_b64 exec, -1
    v_exp_f32 v67, v67
    v_exp_f32 v68, v68
    v_exp_f32 v69, v69
    v_exp_f32 v70, v70
    v_exp_f32 v71, v71
    v_mfma_f32_32x32x16_bf16 v[48:63], v[84:87], v[244:247], 0
    v_cvt_pk_bf16_f32 v64, v64, v65
    v_cvt_pk_bf16_f32 v65, v66, v67
    v_cvt_pk_bf16_f32 v66, v68, v69
    v_cvt_pk_bf16_f32 v67, v70, v71
    s_cmp_lg_u32 s8, 0
    s_cbranch_scc1 L_h_fbw
    s_mov_b32 s21, 0
    s_waitcnt vmcnt(2)
L_h_fbc_chk:
    v_cmp_eq_u32 vcc, s3, v8
    v_cmp_eq_u32 s[74:75], s3, v9
    s_and_b64 vcc, vcc, s[74:75]
    v_cmp_eq_u32 s[74:75], s3, v10
    s_and_b64 vcc, vcc, s[74:75]
    v_cmp_eq_u32 s[74:75], s3, v11
    s_and_b64 vcc, vcc, s[74:75]
    s_cmp_eq_u64 vcc, -1
    s_cbranch_scc1 L_h_fbc_ok
    s_sleep 16
    v_lshlrev_b32 v12, 7, v1
    v_add_u32 v12, 0xf18000, v12
    global_load_dword v8, v12, s[4:5] sc1
    v_add_u32 v12, 8192, v12
    global_load_dword v9, v12, s[4:5] sc1
    v_add_u32 v12, 8192, v12
    global_load_dword v10, v12, s[4:5] sc1
    v_add_u32 v12, 8192, v12
    global_load_dword v11, v12, s[4:5] sc1
    s_waitcnt vmcnt(0)
    s_add_u32 s21, s21, 1
    s_cmp_lt_u32 s21, 0x40000
    s_cbranch_scc1 L_h_fbc_chk
L_h_fbc_ok:
    global_load_dwordx2 v[158:159], v243, s[62:63] sc1
    s_add_u32 s62, s62, 163840
    s_addc_u32 s63, s63, 0
    global_load_dwordx2 v[160:161], v243, s[62:63] sc1
    s_add_u32 s62, s62, 163840
    s_addc_u32 s63, s63, 0
    global_load_dwordx2 v[162:163], v243, s[62:63] sc1
    s_add_u32 s62, s62, 163840
    s_addc_u32 s63, s63, 0
    global_load_dwordx2 v[164:165], v243, s[62:63] sc1
    s_add_u32 s62, s62, 163840
    s_addc_u32 s63, s63, 0
    global_load_dwordx2 v[166:167], v243, s[62:63] sc1
    s_add_u32 s62, s62, 163840
    s_addc_u32 s63, s63, 0
    global_load_dwordx2 v[168:169], v243, s[62:63] sc1
    s_add_u32 s62, s62, 163840
    s_addc_u32 s63, s63, 0
    global_load_dwordx2 v[170:171], v243, s[62:63] sc1
    s_add_u32 s62, s62, 163840
    s_addc_u32 s63, s63, 0
    global_load_dwordx2 v[172:173], v243, s[62:63] sc1
    s_add_u32 s62, s62, 163840
    s_addc_u32 s63, s63, 0
    global_load_dwordx2 v[174:175], v243, s[62:63] sc1
    s_add_u32 s62, s62, 163840
    s_addc_u32 s63, s63, 0
    global_load_dwordx2 v[176:177], v243, s[62:63] sc1
    s_add_u32 s62, s62, 163840
    s_addc_u32 s63, s63, 0
    global_load_dwordx2 v[178:179], v243, s[62:63] sc1
    s_add_u32 s62, s62, 163840
    s_addc_u32 s63, s63, 0
    global_load_dwordx2 v[180:181], v243, s[62:63] sc1
    s_add_u32 s62, s62, 163840
    s_addc_u32 s63, s63, 0
    global_load_dwordx2 v[182:183], v243, s[62:63] sc1
    s_add_u32 s62, s62, 163840
    s_addc_u32 s63, s63, 0
    global_load_dwordx2 v[184:185], v243, s[62:63] sc1
    s_add_u32 s62, s62, 163840
    s_addc_u32 s63, s63, 0
    global_load_dwordx2 v[186:187], v243, s[62:63] sc1
    s_add_u32 s62, s62, 163840
    s_addc_u32 s63, s63, 0
    global_load_dwordx2 v[188:189], v243, s[62:63] sc1
L_h_fbw:
    v_exp_f32 v72, v72
    v_exp_f32 v73, v73
    v_exp_f32 v74, v74
    v_mfma_f32_32x32x8_bf16 v[48:63], v[90:91], v[248:249], v[48:63]
    ds_read_b128 v[80:83], v108 offset:6144
    v_exp_f32 v75, v75
    v_exp_f32 v76, v76
    v_exp_f32 v77, v77
    v_exp_f32 v78, v78
    v_exp_f32 v79, v79
    v_mfma_f32_32x32x16_bf16 v[32:47], v[92:95], v[64:67], v[32:47]
    ds_read_b64 v[88:89], v109 offset:1536
    v_cvt_pk_bf16_f32 v68, v72, v73
    v_cvt_pk_bf16_f32 v69, v74, v75
    v_cvt_pk_bf16_f32 v70, v76, v77
    v_cvt_pk_bf16_f32 v71, v78, v79
    v_exp_f32 v48, v48
    v_exp_f32 v49, v49
    v_exp_f32 v50, v50
    v_mfma_f32_32x32x16_bf16 v[32:47], v[100:103], v[68:71], v[32:47]
    ds_read_b128 v[92:95], v110 offset:7296
    v_exp_f32 v51, v51
    v_exp_f32 v52, v52
    v_exp_f32 v53, v53
    v_exp_f32 v54, v54
    v_exp_f32 v55, v55
    v_mfma_f32_32x32x16_bf16 v[64:79], v[84:87], v[250:253], 0
    ds_read_b128 v[100:103], v110 offset:7904
    v_cvt_pk_bf16_f32 v48, v48, v49
    v_cvt_pk_bf16_f32 v49, v50, v51
    v_cvt_pk_bf16_f32 v50, v52, v53
    v_cvt_pk_bf16_f32 v51, v54, v55
    v_exp_f32 v56, v56
    v_exp_f32 v57, v57
    v_exp_f32 v58, v58
    v_mfma_f32_32x32x8_bf16 v[64:79], v[90:91], v[254:255], v[64:79]
    s_waitcnt lgkmcnt(2)
    v_exp_f32 v59, v59
    v_exp_f32 v60, v60
    v_exp_f32 v61, v61
    v_exp_f32 v62, v62
    v_exp_f32 v63, v63
    v_mfma_f32_32x32x16_bf16 v[16:31], v[96:99], v[48:51], v[16:31]
    s_nop 0
    v_cvt_pk_bf16_f32 v52, v56, v57
    v_cvt_pk_bf16_f32 v53, v58, v59
    v_cvt_pk_bf16_f32 v54, v60, v61
    v_cvt_pk_bf16_f32 v55, v62, v63
    v_exp_f32 v64, v64
    v_exp_f32 v65, v65
    v_exp_f32 v66, v66
    v_mfma_f32_32x32x16_bf16 v[16:31], v[104:107], v[52:55], v[16:31]
    v_exp_f32 v67, v67
    v_exp_f32 v68, v68
    v_exp_f32 v69, v69
    v_exp_f32 v70, v70
    v_exp_f32 v71, v71
    v_mfma_f32_32x32x16_bf16 v[48:63], v[80:83], v[244:247], 0
    v_cvt_pk_bf16_f32 v64, v64, v65
    v_cvt_pk_bf16_f32 v65, v66, v67
    v_cvt_pk_bf16_f32 v66, v68, v69
    v_cvt_pk_bf16_f32 v67, v70, v71
    v_exp_f32 v72, v72
    v_exp_f32 v73, v73
    v_exp_f32 v74, v74
    v_mfma_f32_32x32x8_bf16 v[48:63], v[88:89], v[248:249], v[48:63]
    ds_read_b128 v[84:87], v108 offset:7168
    v_exp_f32 v75, v75
    v_exp_f32 v76, v76
    v_exp_f32 v77, v77
    v_exp_f32 v78, v78
    v_exp_f32 v79, v79
    v_mfma_f32_32x32x16_bf16 v[32:47], v[96:99], v[64:67], v[32:47]
    ds_read_b64 v[90:91], v109 offset:1792
    v_cvt_pk_bf16_f32 v68, v72, v73
    v_cvt_pk_bf16_f32 v69, v74, v75
    v_cvt_pk_bf16_f32 v70, v76, v77
    v_cvt_pk_bf16_f32 v71, v78, v79
    v_exp_f32 v48, v48
    v_exp_f32 v49, v49
    v_exp_f32 v50, v50
    v_mfma_f32_32x32x16_bf16 v[32:47], v[104:107], v[68:71], v[32:47]
    ds_read_b128 v[96:99], v110 offset:8512
    v_exp_f32 v51, v51
    v_exp_f32 v52, v52
    v_exp_f32 v53, v53
    v_exp_f32 v54, v54
    v_exp_f32 v55, v55
    v_mfma_f32_32x32x16_bf16 v[64:79], v[80:83], v[250:253], 0
    ds_read_b128 v[104:107], v110 offset:9120
    v_cvt_pk_bf16_f32 v48, v48, v49
    v_cvt_pk_bf16_f32 v49, v50, v51
    v_cvt_pk_bf16_f32 v50, v52, v53
    v_cvt_pk_bf16_f32 v51, v54, v55
    v_exp_f32 v56, v56
    v_exp_f32 v57, v57
    v_exp_f32 v58, v58
    v_mfma_f32_32x32x8_bf16 v[64:79], v[88:89], v[254:255], v[64:79]
    s_waitcnt lgkmcnt(2)
    v_exp_f32 v59, v59
    v_exp_f32 v60, v60
    v_exp_f32 v61, v61
    v_exp_f32 v62, v62
    v_exp_f32 v63, v63
    v_mfma_f32_32x32x16_bf16 v[16:31], v[92:95], v[48:51], v[16:31]
    s_nop 0
    v_cvt_pk_bf16_f32 v52, v56, v57
    v_cvt_pk_bf16_f32 v53, v58, v59
    v_cvt_pk_bf16_f32 v54, v60, v61
    v_cvt_pk_bf16_f32 v55, v62, v63
    v_exp_f32 v64, v64
    v_exp_f32 v65, v65
    v_exp_f32 v66, v66
    v_mfma_f32_32x32x16_bf16 v[16:31], v[100:103], v[52:55], v[16:31]
    v_exp_f32 v67, v67
    v_exp_f32 v68, v68
    v_exp_f32 v69, v69
    v_exp_f32 v70, v70
    v_exp_f32 v71, v71
    v_mfma_f32_32x32x16_bf16 v[48:63], v[84:87], v[244:247], 0
    v_cvt_pk_bf16_f32 v64, v64, v65
    v_cvt_pk_bf16_f32 v65, v66, v67
    v_cvt_pk_bf16_f32 v66, v68, v69
    v_cvt_pk_bf16_f32 v67, v70, v71
    s_waitcnt vmcnt(0)
    s_barrier
    s_cmp_lg_u32 s8, 0
    s_cbranch_scc1 L_h_kvr
    v_add_f32 v158, v158, v160
    v_add_f32 v159, v159, v161
    v_add_f32 v158, v158, v162
    v_add_f32 v159, v159, v163
    v_add_f32 v158, v158, v164
    v_add_f32 v159, v159, v165
    v_add_f32 v158, v158, v166
    v_add_f32 v159, v159, v167
    v_add_f32 v158, v158, v168
    v_add_f32 v159, v159, v169
    v_add_f32 v158, v158, v170
    v_add_f32 v159, v159, v171
    v_add_f32 v158, v158, v172
    v_add_f32 v159, v159, v173
    v_add_f32 v158, v158, v174
    v_add_f32 v159, v159, v175
    v_add_f32 v158, v158, v176
    v_add_f32 v159, v159, v177
    v_add_f32 v158, v158, v178
    v_add_f32 v159, v159, v179
    v_add_f32 v158, v158, v180
    v_add_f32 v159, v159, v181
    v_add_f32 v158, v158, v182
    v_add_f32 v159, v159, v183
    v_add_f32 v158, v158, v184
    v_add_f32 v159, v159, v185
    v_add_f32 v158, v158, v186
    v_add_f32 v159, v159, v187
    v_add_f32 v158, v158, v188
    v_add_f32 v159, v159, v189
    v_cvt_pk_bf16_f32 v130, v158, v159
    v_cmp_ne_u32 vcc, -1, v242
    s_and_saveexec_b64 s[72:73], vcc
    global_store_dword v242, v130, s[4:5] sc1
    s_mov_b64 exec, s[72:73]
L_h_kvr:
    s_lshl_b32 s16, s11, 5
    s_add_u32 s16, s16, s55
    s_mul_i32 s16, s16, 1152
    s_add_u32 s16, s16, 0x240000
    s_add_u32 s52, s4, s16
    s_addc_u32 s53, s5, 0
    v_lshlrev_b32 v8, 2, v4
    global_load_dwordx4 v[134:137], v6, s[52:53] sc1
    global_load_dword v138, v8, s[52:53] offset:1024 sc1
    s_cmp_eq_u32 s13, 0
    s_cbranch_scc1 L_prio14
    s_setprio 1
L_prio14:
    v_exp_f32 v72, v72
    v_exp_f32 v73, v73
    v_exp_f32 v74, v74
    v_mfma_f32_32x32x8_bf16 v[48:63], v[90:91], v[248:249], v[48:63]
    ds_read_b128 v[80:83], v111 offset:0
    v_exp_f32 v75, v75
    v_exp_f32 v76, v76
    v_exp_f32 v77, v77
    v_exp_f32 v78, v78
    v_exp_f32 v79, v79
    v_mfma_f32_32x32x16_bf16 v[32:47], v[92:95], v[64:67], v[32:47]
    ds_read_b64 v[88:89], v112 offset:0
    v_cvt_pk_bf16_f32 v68, v72, v73
    v_cvt_pk_bf16_f32 v69, v74, v75
    v_cvt_pk_bf16_f32 v70, v76, v77
    v_cvt_pk_bf16_f32 v71, v78, v79
    v_exp_f32 v48, v48
    v_exp_f32 v49, v49
    v_exp_f32 v50, v50
    v_mfma_f32_32x32x16_bf16 v[32:47], v[100:103], v[68:71], v[32:47]
    ds_read_b128 v[92:95], v113 offset:0
    v_exp_f32 v51, v51
    v_exp_f32 v52, v52
    v_exp_f32 v53, v53
    v_exp_f32 v54, v54
    v_exp_f32 v55, v55
    v_mfma_f32_32x32x16_bf16 v[64:79], v[84:87], v[250:253], 0
    ds_read_b128 v[100:103], v113 offset:608
    v_cvt_pk_bf16_f32 v48, v48, v49
    v_cvt_pk_bf16_f32 v49, v50, v51
    v_cvt_pk_bf16_f32 v50, v52, v53
    v_cvt_pk_bf16_f32 v51, v54, v55
    v_exp_f32 v56, v56
    v_exp_f32 v57, v57
    v_exp_f32 v58, v58
    v_mfma_f32_32x32x8_bf16 v[64:79], v[90:91], v[254:255], v[64:79]
    s_waitcnt lgkmcnt(2)
    v_exp_f32 v59, v59
    v_exp_f32 v60, v60
    v_exp_f32 v61, v61
    v_exp_f32 v62, v62
    v_exp_f32 v63, v63
    v_mfma_f32_32x32x16_bf16 v[16:31], v[96:99], v[48:51], v[16:31]
    s_nop 0
    v_cvt_pk_bf16_f32 v52, v56, v57
    v_cvt_pk_bf16_f32 v53, v58, v59
    v_cvt_pk_bf16_f32 v54, v60, v61
    v_cvt_pk_bf16_f32 v55, v62, v63
    v_exp_f32 v64, v64
    v_exp_f32 v65, v65
    v_exp_f32 v66, v66
    v_mfma_f32_32x32x16_bf16 v[16:31], v[104:107], v[52:55], v[16:31]
    v_exp_f32 v67, v67
    v_exp_f32 v68, v68
    v_exp_f32 v69, v69
    v_exp_f32 v70, v70
    v_exp_f32 v71, v71
    v_mfma_f32_32x32x16_bf16 v[48:63], v[80:83], v[244:247], 0
    s_mul_i32 s16, s12, 9
    s_add_u32 s17, s16, s8
    s_mul_i32 s17, s17, 18432
    s_add_u32 s17, s17, 0x740000
    s_add_u32 s22, s4, s17
    s_addc_u32 s23, s5, 0
    s_add_u32 s16, s16, 8
    s_mul_i32 s16, s16, 18432
    s_lshl_b32 s17, s8, 10
    s_add_u32 s16, s16, s17
    s_add_u32 s16, s16, 0x740000
    s_add_u32 s38, s4, s16
    s_addc_u32 s39, s5, 0
    global_load_dwordx4 v[158:161], v6, s[22:23] offset:0 sc1
    global_load_dwordx4 v[162:165], v6, s[22:23] offset:1024 sc1
    v_cvt_pk_bf16_f32 v64, v64, v65
    v_cvt_pk_bf16_f32 v65, v66, v67
    v_cvt_pk_bf16_f32 v66, v68, v69
    v_cvt_pk_bf16_f32 v67, v70, v71
    v_exp_f32 v72, v72
    v_exp_f32 v73, v73
    v_exp_f32 v74, v74
    v_mfma_f32_32x32x8_bf16 v[48:63], v[88:89], v[248:249], v[48:63]
    ds_read_b128 v[84:87], v111 offset:1024
    v_exp_f32 v75, v75
    v_exp_f32 v76, v76
    v_exp_f32 v77, v77
    v_exp_f32 v78, v78
    v_exp_f32 v79, v79
    v_mfma_f32_32x32x16_bf16 v[32:47], v[96:99], v[64:67], v[32:47]
    ds_read_b64 v[90:91], v112 offset:256
    v_cvt_pk_bf16_f32 v68, v72, v73
    v_cvt_pk_bf16_f32 v69, v74, v75
    v_cvt_pk_bf16_f32 v70, v76, v77
    v_cvt_pk_bf16_f32 v71, v78, v79
    v_mov_b32 v108, v111
    v_mov_b32 v109, v112
    v_mov_b32 v110, v113
    v_add_u32 v111, 79872, v114
    v_add_u32 v112, 79872, v115
    v_add_u32 v113, 79872, v116
    v_exp_f32 v48, v48
    v_exp_f32 v49, v49
    v_exp_f32 v50, v50
    v_mfma_f32_32x32x16_bf16 v[32:47], v[104:107], v[68:71], v[32:47]
    ds_read_b128 v[96:99], v110 offset:1216
    v_exp_f32 v51, v51
    v_exp_f32 v52, v52
    v_exp_f32 v53, v53
    v_exp_f32 v54, v54
    v_exp_f32 v55, v55
    v_mfma_f32_32x32x16_bf16 v[64:79], v[80:83], v[250:253], 0
    ds_read_b128 v[104:107], v110 offset:1824
    v_cvt_pk_bf16_f32 v48, v48, v49
    v_cvt_pk_bf16_f32 v49, v50, v51
    v_cvt_pk_bf16_f32 v50, v52, v53
    v_cvt_pk_bf16_f32 v51, v54, v55
    v_exp_f32 v56, v56
    v_exp_f32 v57, v57
    v_exp_f32 v58, v58
    v_mfma_f32_32x32x8_bf16 v[64:79], v[88:89], v[254:255], v[64:79]
    s_waitcnt lgkmcnt(2)
    v_exp_f32 v59, v59
    v_exp_f32 v60, v60
    v_exp_f32 v61, v61
    v_exp_f32 v62, v62
    v_exp_f32 v63, v63
    v_mfma_f32_32x32x16_bf16 v[16:31], v[92:95], v[48:51], v[16:31]
    s_add_u32 m0, s29, 79872
    v_cvt_pk_bf16_f32 v52, v56, v57
    v_cvt_pk_bf16_f32 v53, v58, v59
    v_cvt_pk_bf16_f32 v54, v60, v61
    v_cvt_pk_bf16_f32 v55, v62, v63
    v_exp_f32 v64, v64
    v_exp_f32 v65, v65
    v_exp_f32 v66, v66
    v_mfma_f32_32x32x16_bf16 v[16:31], v[100:103], v[52:55], v[16:31]
    s_add_u32 s52, s24, 59904
    buffer_load_dwordx4 v6, s[32:35], s52 offen sc1 lds
    v_exp_f32 v67, v67
    v_exp_f32 v68, v68
    v_exp_f32 v69, v69
    v_exp_f32 v70, v70
    v_exp_f32 v71, v71
    v_mfma_f32_32x32x16_bf16 v[48:63], v[84:87], v[244:247], 0
    global_load_dwordx4 v[166:169], v6, s[22:23] offset:2048 sc1
    global_load_dwordx4 v[170:173], v6, s[22:23] offset:3072 sc1
    v_cvt_pk_bf16_f32 v64, v64, v65
    v_cvt_pk_bf16_f32 v65, v66, v67
    v_cvt_pk_bf16_f32 v66, v68, v69
    v_cvt_pk_bf16_f32 v67, v70, v71
    v_exp_f32 v72, v72
    v_exp_f32 v73, v73
    v_exp_f32 v74, v74
    v_mfma_f32_32x32x8_bf16 v[48:63], v[90:91], v[248:249], v[48:63]
    ds_read_b128 v[80:83], v108 offset:2048
    v_exp_f32 v75, v75
    v_exp_f32 v76, v76
    v_exp_f32 v77, v77
    v_exp_f32 v78, v78
    v_exp_f32 v79, v79
    v_mfma_f32_32x32x16_bf16 v[32:47], v[92:95], v[64:67], v[32:47]
    ds_read_b64 v[88:89], v109 offset:512
    v_cvt_pk_bf16_f32 v68, v72, v73
    v_cvt_pk_bf16_f32 v69, v74, v75
    v_cvt_pk_bf16_f32 v70, v76, v77
    v_cvt_pk_bf16_f32 v71, v78, v79
    v_exp_f32 v48, v48
    v_exp_f32 v49, v49
    v_exp_f32 v50, v50
    v_mfma_f32_32x32x16_bf16 v[32:47], v[100:103], v[68:71], v[32:47]
    ds_read_b128 v[92:95], v110 offset:2432
    v_exp_f32 v51, v51
    v_exp_f32 v52, v52
    v_exp_f32 v53, v53
    v_exp_f32 v54, v54
    v_exp_f32 v55, v55
    v_mfma_f32_32x32x16_bf16 v[64:79], v[84:87], v[250:253], 0
    ds_read_b128 v[100:103], v110 offset:3040
    v_cvt_pk_bf16_f32 v48, v48, v49
    v_cvt_pk_bf16_f32 v49, v50, v51
    v_cvt_pk_bf16_f32 v50, v52, v53
    v_cvt_pk_bf16_f32 v51, v54, v55
    v_exp_f32 v56, v56
    v_exp_f32 v57, v57
    v_exp_f32 v58, v58
    v_mfma_f32_32x32x8_bf16 v[64:79], v[90:91], v[254:255], v[64:79]
    s_waitcnt lgkmcnt(2)
    v_exp_f32 v59, v59
    v_exp_f32 v60, v60
    v_exp_f32 v61, v61
    v_exp_f32 v62, v62
    v_exp_f32 v63, v63
    v_mfma_f32_32x32x16_bf16 v[16:31], v[96:99], v[48:51], v[16:31]
    s_add_u32 m0, s30, 79872
    v_cvt_pk_bf16_f32 v52, v56, v57
    v_cvt_pk_bf16_f32 v53, v58, v59
    v_cvt_pk_bf16_f32 v54, v60, v61
    v_cvt_pk_bf16_f32 v55, v62, v63
    v_exp_f32 v64, v64
    v_exp_f32 v65, v65
    v_exp_f32 v66, v66
    v_mfma_f32_32x32x16_bf16 v[16:31], v[104:107], v[52:55], v[16:31]
    s_add_u32 s52, s25, 59904
    buffer_load_dwordx4 v6, s[32:35], s52 offen sc1 lds
    v_exp_f32 v67, v67
    v_exp_f32 v68, v68
    v_exp_f32 v69, v69
    v_exp_f32 v70, v70
    v_exp_f32 v71, v71
    v_mfma_f32_32x32x16_bf16 v[48:63], v[80:83], v[244:247], 0
    s_add_u32 s22, s22, 4096
    s_addc_u32 s23, s23, 0
    global_load_dwordx4 v[174:177], v6, s[22:23] offset:0 sc1
    global_load_dwordx4 v[178:181], v6, s[22:23] offset:1024 sc1
    v_cvt_pk_bf16_f32 v64, v64, v65
    v_cvt_pk_bf16_f32 v65, v66, v67
    v_cvt_pk_bf16_f32 v66, v68, v69
    v_cvt_pk_bf16_f32 v67, v70, v71
    v_exp_f32 v72, v72
    v_exp_f32 v73, v73
    v_exp_f32 v74, v74
    v_mfma_f32_32x32x8_bf16 v[48:63], v[88:89], v[248:249], v[48:63]
    ds_read_b128 v[84:87], v108 offset:3072
    v_exp_f32 v75, v75
    v_exp_f32 v76, v76
    v_exp_f32 v77, v77
    v_exp_f32 v78, v78
    v_exp_f32 v79, v79
    v_mfma_f32_32x32x16_bf16 v[32:47], v[96:99], v[64:67], v[32:47]
    ds_read_b64 v[90:91], v109 offset:768
    v_cvt_pk_bf16_f32 v68, v72, v73
    v_cvt_pk_bf16_f32 v69, v74, v75
    v_cvt_pk_bf16_f32 v70, v76, v77
    v_cvt_pk_bf16_f32 v71, v78, v79
    v_exp_f32 v48, v48
    v_exp_f32 v49, v49
    v_exp_f32 v50, v50
    v_mfma_f32_32x32x16_bf16 v[32:47], v[104:107], v[68:71], v[32:47]
    ds_read_b128 v[96:99], v110 offset:3648
    v_exp_f32 v51, v51
    v_exp_f32 v52, v52
    v_exp_f32 v53, v53
    v_exp_f32 v54, v54
    v_exp_f32 v55, v55
    v_mfma_f32_32x32x16_bf16 v[64:79], v[80:83], v[250:253], 0
    ds_read_b128 v[104:107], v110 offset:4256
    v_cvt_pk_bf16_f32 v48, v48, v49
    v_cvt_pk_bf16_f32 v49, v50, v51
    v_cvt_pk_bf16_f32 v50, v52, v53
    v_cvt_pk_bf16_f32 v51, v54, v55
    v_exp_f32 v56, v56
    v_exp_f32 v57, v57
    v_exp_f32 v58, v58
    v_mfma_f32_32x32x8_bf16 v[64:79], v[88:89], v[254:255], v[64:79]
    s_waitcnt lgkmcnt(2)
    v_exp_f32 v59, v59
    v_exp_f32 v60, v60
    v_exp_f32 v61, v61
    v_exp_f32 v62, v62
    v_exp_f32 v63, v63
    v_mfma_f32_32x32x16_bf16 v[16:31], v[92:95], v[48:51], v[16:31]
    s_add_u32 m0, s31, 79872
    v_cvt_pk_bf16_f32 v52, v56, v57
    v_cvt_pk_bf16_f32 v53, v58, v59
    v_cvt_pk_bf16_f32 v54, v60, v61
    v_cvt_pk_bf16_f32 v55, v62, v63
    v_exp_f32 v64, v64
    v_exp_f32 v65, v65
    v_exp_f32 v66, v66
    v_mfma_f32_32x32x16_bf16 v[16:31], v[100:103], v[52:55], v[16:31]
    s_add_u32 s52, s26, 59904
    s_mov_b64 exec, s[96:97]
    buffer_load_dwordx4 v6, s[32:35], s52 offen sc1 lds
    s_mov_b64 exec, -1
    v_exp_f32 v67, v67
    v_exp_f32 v68, v68
    v_exp_f32 v69, v69
    v_exp_f32 v70, v70
    v_exp_f32 v71, v71
    v_mfma_f32_32x32x16_bf16 v[48:63], v[84:87], v[244:247], 0
    global_load_dwordx4 v[182:185], v6, s[22:23] offset:2048 sc1
    global_load_dwordx4 v[186:189], v6, s[22:23] offset:3072 sc1
    v_cvt_pk_bf16_f32 v64, v64, v65
    v_cvt_pk_bf16_f32 v65, v66, v67
    v_cvt_pk_bf16_f32 v66, v68, v69
    v_cvt_pk_bf16_f32 v67, v70, v71
    s_cmp_lg_u32 s8, 0
    s_cbranch_scc1 L_h_fkw
    s_waitcnt vmcnt(13)
L_h_fkw:
    s_lshl_b32 s16, s2, 7
    s_add_u32 s16, s16, 0xf20000
    v_mov_b32 v8, s16
    v_mov_b32 v9, s3
    s_cmp_eq_u32 s8, 0
    s_cselect_b32 exec_lo, 1, 0
    s_mov_b32 exec_hi, 0
    global_store_dword v8, v9, s[4:5] sc1
    s_mov_b64 exec, -1
    v_exp_f32 v72, v72
    v_exp_f32 v73, v73
    v_exp_f32 v74, v74
    v_mfma_f32_32x32x8_bf16 v[48:63], v[90:91], v[248:249], v[48:63]
    ds_read_b128 v[80:83], v108 offset:4096
    v_exp_f32 v75, v75
    v_exp_f32 v76, v76
    v_exp_f32 v77, v77
    v_exp_f32 v78, v78
    v_exp_f32 v79, v79
    v_mfma_f32_32x32x16_bf16 v[32:47], v[92:95], v[64:67], v[32:47]
    ds_read_b64 v[88:89], v109 offset:1024
    v_cvt_pk_bf16_f32 v68, v72, v73
    v_cvt_pk_bf16_f32 v69, v74, v75
    v_cvt_pk_bf16_f32 v70, v76, v77
    v_cvt_pk_bf16_f32 v71, v78, v79
    v_exp_f32 v48, v48
    v_exp_f32 v49, v49
    v_exp_f32 v50, v50
    v_mfma_f32_32x32x16_bf16 v[32:47], v[100:103], v[68:71], v[32:47]
    ds_read_b128 v[92:95], v110 offset:4864
    v_exp_f32 v51, v51
    v_exp_f32 v52, v52
    v_exp_f32 v53, v53
    v_exp_f32 v54, v54
    v_exp_f32 v55, v55
    v_mfma_f32_32x32x16_bf16 v[64:79], v[84:87], v[250:253], 0
    ds_read_b128 v[100:103], v110 offset:5472
    v_cvt_pk_bf16_f32 v48, v48, v49
    v_cvt_pk_bf16_f32 v49, v50, v51
    v_cvt_pk_bf16_f32 v50, v52, v53
    v_cvt_pk_bf16_f32 v51, v54, v55
    v_exp_f32 v56, v56
    v_exp_f32 v57, v57
    v_exp_f32 v58, v58
    v_mfma_f32_32x32x8_bf16 v[64:79], v[90:91], v[254:255], v[64:79]
    s_waitcnt lgkmcnt(2)
    v_exp_f32 v59, v59
    v_exp_f32 v60, v60
    v_exp_f32 v61, v61
    v_exp_f32 v62, v62
    v_exp_f32 v63, v63
    v_mfma_f32_32x32x16_bf16 v[16:31], v[96:99], v[48:51], v[16:31]
    s_add_u32 m0, s36, 79872
    v_cvt_pk_bf16_f32 v52, v56, v57
    v_cvt_pk_bf16_f32 v53, v58, v59
    v_cvt_pk_bf16_f32 v54, v60, v61
    v_cvt_pk_bf16_f32 v55, v62, v63
    v_exp_f32 v64, v64
    v_exp_f32 v65, v65
    v_exp_f32 v66, v66
    v_mfma_f32_32x32x16_bf16 v[16:31], v[104:107], v[52:55], v[16:31]
    s_add_u32 s52, s27, 59904
    buffer_load_dwordx4 v6, s[32:35], s52 offen sc1 lds
    v_exp_f32 v67, v67
    v_exp_f32 v68, v68
    v_exp_f32 v69, v69
    v_exp_f32 v70, v70
    v_exp_f32 v71, v71
    v_mfma_f32_32x32x16_bf16 v[48:63], v[80:83], v[244:247], 0
    s_add_u32 s22, s22, 4096
    s_addc_u32 s23, s23, 0
    global_load_dwordx4 v[190:193], v6, s[22:23] offset:0 sc1
    global_load_dwordx4 v[194:197], v6, s[22:23] offset:1024 sc1
    v_cvt_pk_bf16_f32 v64, v64, v65
    v_cvt_pk_bf16_f32 v65, v66, v67
    v_cvt_pk_bf16_f32 v66, v68, v69
    v_cvt_pk_bf16_f32 v67, v70, v71
    s_cmp_eq_u32 s13, 0
    s_cbranch_scc1 L_prio19
    s_setprio 0
L_prio19:
    v_exp_f32 v72, v72
    v_exp_f32 v73, v73
    v_exp_f32 v74, v74
    v_mfma_f32_32x32x8_bf16 v[48:63], v[88:89], v[248:249], v[48:63]
    ds_read_b128 v[84:87], v108 offset:5120
    v_exp_f32 v75, v75
    v_exp_f32 v76, v76
    v_exp_f32 v77, v77
    v_exp_f32 v78, v78
    v_exp_f32 v79, v79
    v_mfma_f32_32x32x16_bf16 v[32:47], v[96:99], v[64:67], v[32:47]
    ds_read_b64 v[90:91], v109 offset:1280
    v_cvt_pk_bf16_f32 v68, v72, v73
    v_cvt_pk_bf16_f32 v69, v74, v75
    v_cvt_pk_bf16_f32 v70, v76, v77
    v_cvt_pk_bf16_f32 v71, v78, v79
    v_exp_f32 v48, v48
    v_exp_f32 v49, v49
    v_exp_f32 v50, v50
    v_mfma_f32_32x32x16_bf16 v[32:47], v[104:107], v[68:71], v[32:47]
    ds_read_b128 v[96:99], v110 offset:6080
    v_exp_f32 v51, v51
    v_exp_f32 v52, v52
    v_exp_f32 v53, v53
    v_exp_f32 v54, v54
    v_exp_f32 v55, v55
    v_mfma_f32_32x32x16_bf16 v[64:79], v[80:83], v[250:253], 0
    ds_read_b128 v[104:107], v110 offset:6688
    v_cvt_pk_bf16_f32 v48, v48, v49
    v_cvt_pk_bf16_f32 v49, v50, v51
    v_cvt_pk_bf16_f32 v50, v52, v53
    v_cvt_pk_bf16_f32 v51, v54, v55
    v_exp_f32 v56, v56
    v_exp_f32 v57, v57
    v_exp_f32 v58, v58
    v_mfma_f32_32x32x8_bf16 v[64:79], v[88:89], v[254:255], v[64:79]
    s_waitcnt lgkmcnt(2)
    v_exp_f32 v59, v59
    v_exp_f32 v60, v60
    v_exp_f32 v61, v61
    v_exp_f32 v62, v62
    v_exp_f32 v63, v63
    v_mfma_f32_32x32x16_bf16 v[16:31], v[92:95], v[48:51], v[16:31]
    s_add_u32 m0, s37, 79872
    v_cvt_pk_bf16_f32 v52, v56, v57
    v_cvt_pk_bf16_f32 v53, v58, v59
    v_cvt_pk_bf16_f32 v54, v60, v61
    v_cvt_pk_bf16_f32 v55, v62, v63
    v_exp_f32 v64, v64
    v_exp_f32 v65, v65
    v_exp_f32 v66, v66
    v_mfma_f32_32x32x16_bf16 v[16:31], v[100:103], v[52:55], v[16:31]
    s_add_u32 s52, s28, 59904
    s_mov_b64 exec, s[98:99]
    buffer_load_dwordx4 v6, s[32:35], s52 offen sc1 lds
    s_mov_b64 exec, -1
    v_exp_f32 v67, v67
    v_exp_f32 v68, v68
    v_exp_f32 v69, v69
    v_exp_f32 v70, v70
    v_exp_f32 v71, v71
    v_mfma_f32_32x32x16_bf16 v[48:63], v[84:87], v[244:247], 0
    global_load_dwordx4 v[198:201], v6, s[22:23] offset:2048 sc1
    global_load_dwordx4 v[202:205], v6, s[22:23] offset:3072 sc1
    v_cvt_pk_bf16_f32 v64, v64, v65
    v_cvt_pk_bf16_f32 v65, v66, v67
    v_cvt_pk_bf16_f32 v66, v68, v69
    v_cvt_pk_bf16_f32 v67, v70, v71
    s_lshl_b32 s16, s10, 3
    s_add_u32 s16, s16, s8
    s_mul_i32 s16, s16, 21
    v_add_u32 v8, s16, v1
    v_min_u32 v8, 5183, v8
    v_lshlrev_b32 v8, 7, v8
    v_add_u32 v8, 0x7e2000, v8
    s_mov_b32 exec_lo, 0x1fffff
    s_mov_b32 exec_hi, 0
    global_load_dword v243, v8, s[4:5] sc1
    s_mov_b64 exec, -1
    v_exp_f32 v72, v72
    v_exp_f32 v73, v73
    v_exp_f32 v74, v74
    v_mfma_f32_32x32x8_bf16 v[48:63], v[90:91], v[248:249], v[48:63]
    ds_read_b128 v[80:83], v108 offset:6144
    v_exp_f32 v75, v75
    v_exp_f32 v76, v76
    v_exp_f32 v77, v77
    v_exp_f32 v78, v78
    v_exp_f32 v79, v79
    v_mfma_f32_32x32x16_bf16 v[32:47], v[92:95], v[64:67], v[32:47]
    ds_read_b64 v[88:89], v109 offset:1536
    v_cvt_pk_bf16_f32 v68, v72, v73
    v_cvt_pk_bf16_f32 v69, v74, v75
    v_cvt_pk_bf16_f32 v70, v76, v77
    v_cvt_pk_bf16_f32 v71, v78, v79
    v_exp_f32 v48, v48
    v_exp_f32 v49, v49
    v_exp_f32 v50, v50
    v_mfma_f32_32x32x16_bf16 v[32:47], v[100:103], v[68:71], v[32:47]
    ds_read_b128 v[92:95], v110 offset:7296
    v_exp_f32 v51, v51
    v_exp_f32 v52, v52
    v_exp_f32 v53, v53
    v_exp_f32 v54, v54
    v_exp_f32 v55, v55
    v_mfma_f32_32x32x16_bf16 v[64:79], v[84:87], v[250:253], 0
    ds_read_b128 v[100:103], v110 offset:7904
    v_cvt_pk_bf16_f32 v48, v48, v49
    v_cvt_pk_bf16_f32 v49, v50, v51
    v_cvt_pk_bf16_f32 v50, v52, v53
    v_cvt_pk_bf16_f32 v51, v54, v55
    v_exp_f32 v56, v56
    v_exp_f32 v57, v57
    v_exp_f32 v58, v58
    v_mfma_f32_32x32x8_bf16 v[64:79], v[90:91], v[254:255], v[64:79]
    s_waitcnt lgkmcnt(2)
    v_exp_f32 v59, v59
    v_exp_f32 v60, v60
    v_exp_f32 v61, v61
    v_exp_f32 v62, v62
    v_exp_f32 v63, v63
    v_mfma_f32_32x32x16_bf16 v[16:31], v[96:99], v[48:51], v[16:31]
    s_nop 0
    v_cvt_pk_bf16_f32 v52, v56, v57
    v_cvt_pk_bf16_f32 v53, v58, v59
    v_cvt_pk_bf16_f32 v54, v60, v61
    v_cvt_pk_bf16_f32 v55, v62, v63
    v_exp_f32 v64, v64
    v_exp_f32 v65, v65
    v_exp_f32 v66, v66
    v_mfma_f32_32x32x16_bf16 v[16:31], v[104:107], v[52:55], v[16:31]
    v_exp_f32 v67, v67
    v_exp_f32 v68, v68
    v_exp_f32 v69, v69
    v_exp_f32 v70, v70
    v_exp_f32 v71, v71
    v_mfma_f32_32x32x16_bf16 v[48:63], v[80:83], v[244:247], 0
    s_add_u32 s22, s22, 4096
    s_addc_u32 s23, s23, 0
    global_load_dwordx4 v[206:209], v6, s[22:23] offset:0 sc1
    v_cvt_pk_bf16_f32 v64, v64, v65
    v_cvt_pk_bf16_f32 v65, v66, v67
    v_cvt_pk_bf16_f32 v66, v68, v69
    v_cvt_pk_bf16_f32 v67, v70, v71
    v_exp_f32 v72, v72
    v_exp_f32 v73, v73
    v_exp_f32 v74, v74
    v_mfma_f32_32x32x8_bf16 v[48:63], v[88:89], v[248:249], v[48:63]
    ds_read_b128 v[84:87], v108 offset:7168
    v_exp_f32 v75, v75
    v_exp_f32 v76, v76
    v_exp_f32 v77, v77
    v_exp_f32 v78, v78
    v_exp_f32 v79, v79
    v_mfma_f32_32x32x16_bf16 v[32:47], v[96:99], v[64:67], v[32:47]
    ds_read_b64 v[90:91], v109 offset:1792
    v_cvt_pk_bf16_f32 v68, v72, v73
    v_cvt_pk_bf16_f32 v69, v74, v75
    v_cvt_pk_bf16_f32 v70, v76, v77
    v_cvt_pk_bf16_f32 v71, v78, v79
    v_exp_f32 v48, v48
    v_exp_f32 v49, v49
    v_exp_f32 v50, v50
    v_mfma_f32_32x32x16_bf16 v[32:47], v[104:107], v[68:71], v[32:47]
    ds_read_b128 v[96:99], v110 offset:8512
    v_exp_f32 v51, v51
    v_exp_f32 v52, v52
    v_exp_f32 v53, v53
    v_exp_f32 v54, v54
    v_exp_f32 v55, v55
    v_mfma_f32_32x32x16_bf16 v[64:79], v[80:83], v[250:253], 0
    ds_read_b128 v[104:107], v110 offset:9120
    v_cvt_pk_bf16_f32 v48, v48, v49
    v_cvt_pk_bf16_f32 v49, v50, v51
    v_cvt_pk_bf16_f32 v50, v52, v53
    v_cvt_pk_bf16_f32 v51, v54, v55
    v_exp_f32 v56, v56
    v_exp_f32 v57, v57
    v_exp_f32 v58, v58
    v_mfma_f32_32x32x8_bf16 v[64:79], v[88:89], v[254:255], v[64:79]
    s_waitcnt lgkmcnt(2)
    v_exp_f32 v59, v59
    v_exp_f32 v60, v60
    v_exp_f32 v61, v61
    v_exp_f32 v62, v62
    v_exp_f32 v63, v63
    v_mfma_f32_32x32x16_bf16 v[16:31], v[92:95], v[48:51], v[16:31]
    s_nop 0
    v_cvt_pk_bf16_f32 v52, v56, v57
    v_cvt_pk_bf16_f32 v53, v58, v59
    v_cvt_pk_bf16_f32 v54, v60, v61
    v_cvt_pk_bf16_f32 v55, v62, v63
    v_exp_f32 v64, v64
    v_exp_f32 v65, v65
    v_exp_f32 v66, v66
    v_mfma_f32_32x32x16_bf16 v[16:31], v[100:103], v[52:55], v[16:31]
    v_exp_f32 v67, v67
    v_exp_f32 v68, v68
    v_exp_f32 v69, v69
    v_exp_f32 v70, v70
    v_exp_f32 v71, v71
    v_mfma_f32_32x32x16_bf16 v[48:63], v[84:87], v[244:247], 0
    global_load_dwordx4 v[210:213], v6, s[22:23] offset:1024 sc1
    v_cvt_pk_bf16_f32 v64, v64, v65
    v_cvt_pk_bf16_f32 v65, v66, v67
    v_cvt_pk_bf16_f32 v66, v68, v69
    v_cvt_pk_bf16_f32 v67, v70, v71
    s_waitcnt vmcnt(5)
    s_barrier
    v_lshlrev_b32 v139, 16, v134
    v_and_b32 v140, 0xffff0000, v134
    v_mul_f32 v141, 0x3fb8aa3b, v139
    v_exp_f32_e64 v141, v141 clamp
    v_max_f32 v139, 0, v139
    v_add_f32 v139, 0x358637bd, v139
    v_add_f32 v139, v139, v141
    v_mul_f32 v141, 0x3fb8aa3b, v140
    v_exp_f32_e64 v141, v141 clamp
    v_max_f32 v140, 0, v140
    v_add_f32 v140, 0x358637bd, v140
    v_add_f32 v140, v140, v141
    v_cvt_pk_bf16_f32 v118, v139, v140
    v_lshlrev_b32 v139, 16, v135
    v_and_b32 v140, 0xffff0000, v135
    v_mul_f32 v141, 0x3fb8aa3b, v139
    v_exp_f32_e64 v141, v141 clamp
    v_max_f32 v139, 0, v139
    v_add_f32 v139, 0x358637bd, v139
    v_add_f32 v139, v139, v141
    v_mul_f32 v141, 0x3fb8aa3b, v140
    v_exp_f32_e64 v141, v141 clamp
    v_max_f32 v140, 0, v140
    v_add_f32 v140, 0x358637bd, v140
    v_add_f32 v140, v140, v141
    v_cvt_pk_bf16_f32 v119, v139, v140
    v_lshlrev_b32 v139, 16, v136
    v_and_b32 v140, 0xffff0000, v136
    v_mul_f32 v141, 0x3fb8aa3b, v139
    v_exp_f32_e64 v141, v141 clamp
    v_max_f32 v139, 0, v139
    v_add_f32 v139, 0x358637bd, v139
    v_add_f32 v139, v139, v141
    v_mul_f32 v141, 0x3fb8aa3b, v140
    v_exp_f32_e64 v141, v141 clamp
    v_max_f32 v140, 0, v140
    v_add_f32 v140, 0x358637bd, v140
    v_add_f32 v140, v140, v141
    v_cvt_pk_bf16_f32 v120, v139, v140
    v_lshlrev_b32 v139, 16, v137
    v_and_b32 v140, 0xffff0000, v137
    v_mul_f32 v141, 0x3fb8aa3b, v139
    v_exp_f32_e64 v141, v141 clamp
    v_max_f32 v139, 0, v139
    v_add_f32 v139, 0x358637bd, v139
    v_add_f32 v139, v139, v141
    v_mul_f32 v141, 0x3fb8aa3b, v140
    v_exp_f32_e64 v141, v141 clamp
    v_max_f32 v140, 0, v140
    v_add_f32 v140, 0x358637bd, v140
    v_add_f32 v140, v140, v141
    v_cvt_pk_bf16_f32 v121, v139, v140
    v_lshlrev_b32 v139, 16, v138
    v_and_b32 v140, 0xffff0000, v138
    v_mul_f32 v141, 0x3fb8aa3b, v139
    v_exp_f32_e64 v141, v141 clamp
    v_max_f32 v139, 0, v139
    v_add_f32 v139, 0x358637bd, v139
    v_add_f32 v139, v139, v141
    v_mul_f32 v141, 0x3fb8aa3b, v140
    v_exp_f32_e64 v141, v141 clamp
    v_max_f32 v140, 0, v140
    v_add_f32 v140, 0x358637bd, v140
    v_add_f32 v140, v140, v141
    v_cvt_pk_bf16_f32 v122, v139, v140
    v_cmp_gt_u32 vcc, 32, v1
    v_mov_b32 v139, 0
    v_mov_b32 v123, 0
    v_cndmask_b32 v122, v139, v122, vcc
    s_cmp_eq_u32 s13, 0
    s_cbranch_scc1 L_prio22
    s_setprio 1
L_prio22:
    v_exp_f32 v72, v72
    v_exp_f32 v73, v73
    v_exp_f32 v74, v74
    v_mfma_f32_32x32x8_bf16 v[48:63], v[90:91], v[248:249], v[48:63]
    ds_read_b128 v[80:83], v111 offset:0
    v_exp_f32 v75, v75
    v_exp_f32 v76, v76
    v_exp_f32 v77, v77
    v_exp_f32 v78, v78
    v_exp_f32 v79, v79
    v_mfma_f32_32x32x16_bf16 v[32:47], v[92:95], v[64:67], v[32:47]
    ds_read_b64 v[88:89], v112 offset:0
    v_cvt_pk_bf16_f32 v68, v72, v73
    v_cvt_pk_bf16_f32 v69, v74, v75
    v_cvt_pk_bf16_f32 v70, v76, v77
    v_cvt_pk_bf16_f32 v71, v78, v79
    v_exp_f32 v48, v48
    v_exp_f32 v49, v49
    v_exp_f32 v50, v50
    v_mfma_f32_32x32x16_bf16 v[32:47], v[100:103], v[68:71], v[32:47]
    ds_read_b128 v[92:95], v113 offset:0
    v_exp_f32 v51, v51
    v_exp_f32 v52, v52
    v_exp_f32 v53, v53
    v_exp_f32 v54, v54
    v_exp_f32 v55, v55
    v_mfma_f32_32x32x16_bf16 v[64:79], v[84:87], v[250:253], 0
    ds_read_b128 v[100:103], v113 offset:608
    v_cvt_pk_bf16_f32 v48, v48, v49
    v_cvt_pk_bf16_f32 v49, v50, v51
    v_cvt_pk_bf16_f32 v50, v52, v53
    v_cvt_pk_bf16_f32 v51, v54, v55
    v_exp_f32 v56, v56
    v_exp_f32 v57, v57
    v_exp_f32 v58, v58
    v_mfma_f32_32x32x8_bf16 v[64:79], v[90:91], v[254:255], v[64:79]
    s_waitcnt lgkmcnt(2)
    v_exp_f32 v59, v59
    v_exp_f32 v60, v60
    v_exp_f32 v61, v61
    v_exp_f32 v62, v62
    v_exp_f32 v63, v63
    v_mfma_f32_32x32x16_bf16 v[16:31], v[96:99], v[48:51], v[16:31]
    s_nop 0
    v_cvt_pk_bf16_f32 v52, v56, v57
    v_cvt_pk_bf16_f32 v53, v58, v59
    v_cvt_pk_bf16_f32 v54, v60, v61
    v_cvt_pk_bf16_f32 v55, v62, v63
    v_exp_f32 v64, v64
    v_exp_f32 v65, v65
    v_exp_f32 v66, v66
    v_mfma_f32_32x32x16_bf16 v[16:31], v[104:107], v[52:55], v[16:31]
    v_exp_f32 v67, v67
    v_exp_f32 v68, v68
    v_exp_f32 v69, v69
    v_exp_f32 v70, v70
    v_exp_f32 v71, v71
    v_mfma_f32_32x32x16_bf16 v[48:63], v[80:83], v[244:247], 0
    global_load_dwordx4 v[214:217], v6, s[22:23] offset:2048 sc1
    v_cvt_pk_bf16_f32 v64, v64, v65
    v_cvt_pk_bf16_f32 v65, v66, v67
    v_cvt_pk_bf16_f32 v66, v68, v69
    v_cvt_pk_bf16_f32 v67, v70, v71
    v_exp_f32 v72, v72
    v_exp_f32 v73, v73
    v_exp_f32 v74, v74
    v_mfma_f32_32x32x8_bf16 v[48:63], v[88:89], v[248:249], v[48:63]
    ds_read_b128 v[84:87], v111 offset:1024
    v_exp_f32 v75, v75
    v_exp_f32 v76, v76
    v_exp_f32 v77, v77
    v_exp_f32 v78, v78
    v_exp_f32 v79, v79
    v_mfma_f32_32x32x16_bf16 v[32:47], v[96:99], v[64:67], v[32:47]
    ds_read_b64 v[90:91], v112 offset:256
    v_cvt_pk_bf16_f32 v68, v72, v73
    v_cvt_pk_bf16_f32 v69, v74, v75
    v_cvt_pk_bf16_f32 v70, v76, v77
    v_cvt_pk_bf16_f32 v71, v78, v79
    v_mov_b32 v108, v111
    v_mov_b32 v109, v112
    v_mov_b32 v110, v113
    v_add_u32 v111, 79872, v114
    v_add_u32 v112, 79872, v115
    v_add_u32 v113, 79872, v116
    v_exp_f32 v48, v48
    v_exp_f32 v49, v49
    v_exp_f32 v50, v50
    v_mfma_f32_32x32x16_bf16 v[32:47], v[104:107], v[68:71], v[32:47]
    ds_read_b128 v[96:99], v110 offset:1216
    v_exp_f32 v51, v51
    v_exp_f32 v52, v52
    v_exp_f32 v53, v53
    v_exp_f32 v54, v54
    v_exp_f32 v55, v55
    v_mfma_f32_32x32x16_bf16 v[64:79], v[80:83], v[250:253], 0
    ds_read_b128 v[104:107], v110 offset:1824
    v_cvt_pk_bf16_f32 v48, v48, v49
    v_cvt_pk_bf16_f32 v49, v50, v51
    v_cvt_pk_bf16_f32 v50, v52, v53
    v_cvt_pk_bf16_f32 v51, v54, v55
    v_exp_f32 v56, v56
    v_exp_f32 v57, v57
    v_exp_f32 v58, v58
    v_mfma_f32_32x32x8_bf16 v[64:79], v[88:89], v[254:255], v[64:79]
    s_waitcnt lgkmcnt(2)
    v_exp_f32 v59, v59
    v_exp_f32 v60, v60
    v_exp_f32 v61, v61
    v_exp_f32 v62, v62
    v_exp_f32 v63, v63
    v_mfma_f32_32x32x16_bf16 v[16:31], v[92:95], v[48:51], v[16:31]
    s_nop 0
    v_cvt_pk_bf16_f32 v52, v56, v57
    v_cvt_pk_bf16_f32 v53, v58, v59
    v_cvt_pk_bf16_f32 v54, v60, v61
    v_cvt_pk_bf16_f32 v55, v62, v63
    v_exp_f32 v64, v64
    v_exp_f32 v65, v65
    v_exp_f32 v66, v66
    v_mfma_f32_32x32x16_bf16 v[16:31], v[100:103], v[52:55], v[16:31]
    v_exp_f32 v67, v67
    v_exp_f32 v68, v68
    v_exp_f32 v69, v69
    v_exp_f32 v70, v70
    v_exp_f32 v71, v71
    v_mfma_f32_32x32x16_bf16 v[48:63], v[84:87], v[244:247], 0
    global_load_dwordx4 v[218:221], v6, s[22:23] offset:3072 sc1
    v_cvt_pk_bf16_f32 v64, v64, v65
    v_cvt_pk_bf16_f32 v65, v66, v67
    v_cvt_pk_bf16_f32 v66, v68, v69
    v_cvt_pk_bf16_f32 v67, v70, v71
    s_cmp_lg_u32 s8, 0
    s_cbranch_scc1 L_h_fki
    v_lshlrev_b32 v12, 7, v1
    v_add_u32 v12, 0xf20000, v12
    global_load_dword v8, v12, s[4:5] sc1
    v_add_u32 v12, 8192, v12
    global_load_dword v9, v12, s[4:5] sc1
    v_add_u32 v12, 8192, v12
    global_load_dword v10, v12, s[4:5] sc1
    v_add_u32 v12, 8192, v12
    global_load_dword v11, v12, s[4:5] sc1
L_h_fki:
    s_cmp_eq_u32 s13, 0
    s_cbranch_scc1 L_prio24
    s_setprio 0
L_prio24:
    v_exp_f32 v72, v72
    v_exp_f32 v73, v73
    v_exp_f32 v74, v74
    v_mfma_f32_32x32x8_bf16 v[48:63], v[90:91], v[248:249], v[48:63]
    ds_read_b128 v[80:83], v108 offset:2048
    v_exp_f32 v75, v75
    v_exp_f32 v76, v76
    v_exp_f32 v77, v77
    v_exp_f32 v78, v78
    v_exp_f32 v79, v79
    v_mfma_f32_32x32x16_bf16 v[32:47], v[92:95], v[64:67], v[32:47]
    ds_read_b64 v[88:89], v109 offset:512
    v_cvt_pk_bf16_f32 v68, v72, v73
    v_cvt_pk_bf16_f32 v69, v74, v75
    v_cvt_pk_bf16_f32 v70, v76, v77
    v_cvt_pk_bf16_f32 v71, v78, v79
    v_exp_f32 v48, v48
    v_exp_f32 v49, v49
    v_exp_f32 v50, v50
    v_mfma_f32_32x32x16_bf16 v[32:47], v[100:103], v[68:71], v[32:47]
    ds_read_b128 v[92:95], v110 offset:2432
    v_exp_f32 v51, v51
    v_exp_f32 v52, v52
    v_exp_f32 v53, v53
    v_exp_f32 v54, v54
    v_exp_f32 v55, v55
    v_mfma_f32_32x32x16_bf16 v[64:79], v[84:87], v[250:253], 0
    ds_read_b128 v[100:103], v110 offset:3040
    v_cvt_pk_bf16_f32 v48, v48, v49
    v_cvt_pk_bf16_f32 v49, v50, v51
    v_cvt_pk_bf16_f32 v50, v52, v53
    v_cvt_pk_bf16_f32 v51, v54, v55
    v_exp_f32 v56, v56
    v_exp_f32 v57, v57
    v_exp_f32 v58, v58
    v_mfma_f32_32x32x8_bf16 v[64:79], v[90:91], v[254:255], v[64:79]
    s_waitcnt lgkmcnt(2)
    v_exp_f32 v59, v59
    v_exp_f32 v60, v60
    v_exp_f32 v61, v61
    v_exp_f32 v62, v62
    v_exp_f32 v63, v63
    v_mfma_f32_32x32x16_bf16 v[16:31], v[96:99], v[48:51], v[16:31]
    s_nop 0
    v_cvt_pk_bf16_f32 v52, v56, v57
    v_cvt_pk_bf16_f32 v53, v58, v59
    v_cvt_pk_bf16_f32 v54, v60, v61
    v_cvt_pk_bf16_f32 v55, v62, v63
    v_exp_f32 v64, v64
    v_exp_f32 v65, v65
    v_exp_f32 v66, v66
    v_mfma_f32_32x32x16_bf16 v[16:31], v[104:107], v[52:55], v[16:31]
    v_exp_f32 v67, v67
    v_exp_f32 v68, v68
    v_exp_f32 v69, v69
    v_exp_f32 v70, v70
    v_exp_f32 v71, v71
    v_mfma_f32_32x32x16_bf16 v[48:63], v[80:83], v[244:247], 0
    s_add_u32 s22, s22, 4096
    s_addc_u32 s23, s23, 0
    global_load_dwordx4 v[222:225], v6, s[22:23] offset:0 sc1
    v_cvt_pk_bf16_f32 v64, v64, v65
    v_cvt_pk_bf16_f32 v65, v66, v67
    v_cvt_pk_bf16_f32 v66, v68, v69
    v_cvt_pk_bf16_f32 v67, v70, v71
    v_exp_f32 v72, v72
    v_exp_f32 v73, v73
    v_exp_f32 v74, v74
    v_mfma_f32_32x32x8_bf16 v[48:63], v[88:89], v[248:249], v[48:63]
    ds_read_b128 v[84:87], v108 offset:3072
    v_exp_f32 v75, v75
    v_exp_f32 v76, v76
    v_exp_f32 v77, v77
    v_exp_f32 v78, v78
    v_exp_f32 v79, v79
    v_mfma_f32_32x32x16_bf16 v[32:47], v[96:99], v[64:67], v[32:47]
    ds_read_b64 v[90:91], v109 offset:768
    v_cvt_pk_bf16_f32 v68, v72, v73
    v_cvt_pk_bf16_f32 v69, v74, v75
    v_cvt_pk_bf16_f32 v70, v76, v77
    v_cvt_pk_bf16_f32 v71, v78, v79
    v_exp_f32 v48, v48
    v_exp_f32 v49, v49
    v_exp_f32 v50, v50
    v_mfma_f32_32x32x16_bf16 v[32:47], v[104:107], v[68:71], v[32:47]
    ds_read_b128 v[96:99], v110 offset:3648
    v_exp_f32 v51, v51
    v_exp_f32 v52, v52
    v_exp_f32 v53, v53
    v_exp_f32 v54, v54
    v_exp_f32 v55, v55
    v_mfma_f32_32x32x16_bf16 v[64:79], v[80:83], v[250:253], 0
    ds_read_b128 v[104:107], v110 offset:4256
    v_cvt_pk_bf16_f32 v48, v48, v49
    v_cvt_pk_bf16_f32 v49, v50, v51
    v_cvt_pk_bf16_f32 v50, v52, v53
    v_cvt_pk_bf16_f32 v51, v54, v55
    v_exp_f32 v56, v56
    v_exp_f32 v57, v57
    v_exp_f32 v58, v58
    v_mfma_f32_32x32x8_bf16 v[64:79], v[88:89], v[254:255], v[64:79]
    s_waitcnt lgkmcnt(2)
    v_exp_f32 v59, v59
    v_exp_f32 v60, v60
    v_exp_f32 v61, v61
    v_exp_f32 v62, v62
    v_exp_f32 v63, v63
    v_mfma_f32_32x32x16_bf16 v[16:31], v[92:95], v[48:51], v[16:31]
    s_nop 0
    v_cvt_pk_bf16_f32 v52, v56, v57
    v_cvt_pk_bf16_f32 v53, v58, v59
    v_cvt_pk_bf16_f32 v54, v60, v61
    v_cvt_pk_bf16_f32 v55, v62, v63
    v_exp_f32 v64, v64
    v_exp_f32 v65, v65
    v_exp_f32 v66, v66
    v_mfma_f32_32x32x16_bf16 v[16:31], v[100:103], v[52:55], v[16:31]
    v_exp_f32 v67, v67
    v_exp_f32 v68, v68
    v_exp_f32 v69, v69
    v_exp_f32 v70, v70
    v_exp_f32 v71, v71
    v_mfma_f32_32x32x16_bf16 v[48:63], v[84:87], v[244:247], 0
    global_load_dwordx4 v[226:229], v6, s[22:23] offset:1024 sc1
    v_cvt_pk_bf16_f32 v64, v64, v65
    v_cvt_pk_bf16_f32 v65, v66, v67
    v_cvt_pk_bf16_f32 v66, v68, v69
    v_cvt_pk_bf16_f32 v67, v70, v71
    s_cmp_lg_u32 s8, 0
    s_cbranch_scc1 L_h_fkc_w
    s_mov_b32 s21, 0
    s_waitcnt vmcnt(2)
L_h_fkc_chk:
    v_cmp_eq_u32 vcc, s3, v8
    v_cmp_eq_u32 s[74:75], s3, v9
    s_and_b64 vcc, vcc, s[74:75]
    v_cmp_eq_u32 s[74:75], s3, v10
    s_and_b64 vcc, vcc, s[74:75]
    v_cmp_eq_u32 s[74:75], s3, v11
    s_and_b64 vcc, vcc, s[74:75]
    s_cmp_eq_u64 vcc, -1
    s_cbranch_scc1 L_h_fkc_ok
    s_sleep 16
    v_lshlrev_b32 v12, 7, v1
    v_add_u32 v12, 0xf20000, v12
    global_load_dword v8, v12, s[4:5] sc1
    v_add_u32 v12, 8192, v12
    global_load_dword v9, v12, s[4:5] sc1
    v_add_u32 v12, 8192, v12
    global_load_dword v10, v12, s[4:5] sc1
    v_add_u32 v12, 8192, v12
    global_load_dword v11, v12, s[4:5] sc1
    s_waitcnt vmcnt(0)
    s_add_u32 s21, s21, 1
    s_cmp_lt_u32 s21, 0x40000
    s_cbranch_scc1 L_h_fkc_chk
L_h_fkc_ok:
L_h_fkc_w:
    s_barrier
    s_mul_i32 s17, s55, 1280
    s_add_u32 s17, s17, 0x730000
    v_add_u32 v8, s17, v6
    v_lshlrev_b32 v9, 2, v4
    v_add_u32 v9, s17, v9
    global_load_dwordx4 v[124:127], v8, s[4:5] sc1
    global_load_dword v128, v9, s[4:5] offset:1024 sc1
    s_cmp_eq_u32 s13, 0
    s_cbranch_scc1 L_prio26
    s_setprio 1
L_prio26:
    v_exp_f32 v72, v72
    v_exp_f32 v73, v73
    v_exp_f32 v74, v74
    v_mfma_f32_32x32x8_bf16 v[48:63], v[90:91], v[248:249], v[48:63]
    ds_read_b128 v[80:83], v108 offset:4096
    v_exp_f32 v75, v75
    v_exp_f32 v76, v76
    v_exp_f32 v77, v77
    v_exp_f32 v78, v78
    v_exp_f32 v79, v79
    v_mfma_f32_32x32x16_bf16 v[32:47], v[92:95], v[64:67], v[32:47]
    ds_read_b64 v[88:89], v109 offset:1024
    v_cvt_pk_bf16_f32 v68, v72, v73
    v_cvt_pk_bf16_f32 v69, v74, v75
    v_cvt_pk_bf16_f32 v70, v76, v77
    v_cvt_pk_bf16_f32 v71, v78, v79
    v_exp_f32 v48, v48
    v_exp_f32 v49, v49
    v_exp_f32 v50, v50
    v_mfma_f32_32x32x16_bf16 v[32:47], v[100:103], v[68:71], v[32:47]
    ds_read_b128 v[92:95], v110 offset:4864
    v_exp_f32 v51, v51
    v_exp_f32 v52, v52
    v_exp_f32 v53, v53
    v_exp_f32 v54, v54
    v_exp_f32 v55, v55
    v_mfma_f32_32x32x16_bf16 v[64:79], v[84:87], v[250:253], 0
    ds_read_b128 v[100:103], v110 offset:5472
    v_cvt_pk_bf16_f32 v48, v48, v49
    v_cvt_pk_bf16_f32 v49, v50, v51
    v_cvt_pk_bf16_f32 v50, v52, v53
    v_cvt_pk_bf16_f32 v51, v54, v55
    v_exp_f32 v56, v56
    v_exp_f32 v57, v57
    v_exp_f32 v58, v58
    v_mfma_f32_32x32x8_bf16 v[64:79], v[90:91], v[254:255], v[64:79]
    s_waitcnt lgkmcnt(2)
    v_exp_f32 v59, v59
    v_exp_f32 v60, v60
    v_exp_f32 v61, v61
    v_exp_f32 v62, v62
    v_exp_f32 v63, v63
    v_mfma_f32_32x32x16_bf16 v[16:31], v[96:99], v[48:51], v[16:31]
    s_mul_i32 s16, s12, 9
    s_add_u32 s16, s16, s8
    s_mul_i32 s16, s16, 18432
    s_add_u32 s16, s16, 0x7e2000
    s_add_u32 s28, s4, s16
    s_addc_u32 s29, s5, 0
    s_mul_i32 s52, s8, 9216
    s_mov_b32 m0, s52
    s_nop 0
    global_load_lds_dwordx4 v6, s[28:29] offset:0 sc1
    v_cvt_pk_bf16_f32 v52, v56, v57
    v_cvt_pk_bf16_f32 v53, v58, v59
    v_cvt_pk_bf16_f32 v54, v60, v61
    v_cvt_pk_bf16_f32 v55, v62, v63
    v_exp_f32 v64, v64
    v_exp_f32 v65, v65
    v_exp_f32 v66, v66
    v_mfma_f32_32x32x16_bf16 v[16:31], v[104:107], v[52:55], v[16:31]
    s_mov_b32 m0, s52
    s_nop 0
    global_load_lds_dwordx4 v6, s[28:29] offset:1024 sc1
    v_exp_f32 v67, v67
    v_exp_f32 v68, v68
    v_exp_f32 v69, v69
    v_exp_f32 v70, v70
    v_exp_f32 v71, v71
    v_mfma_f32_32x32x16_bf16 v[48:63], v[80:83], v[244:247], 0
    global_load_dwordx4 v[230:233], v6, s[38:39] sc1
    v_cvt_pk_bf16_f32 v64, v64, v65
    v_cvt_pk_bf16_f32 v65, v66, v67
    v_cvt_pk_bf16_f32 v66, v68, v69
    v_cvt_pk_bf16_f32 v67, v70, v71
    v_exp_f32 v72, v72
    v_exp_f32 v73, v73
    v_exp_f32 v74, v74
    v_mfma_f32_32x32x8_bf16 v[48:63], v[88:89], v[248:249], v[48:63]
    ds_read_b128 v[84:87], v108 offset:5120
    v_exp_f32 v75, v75
    v_exp_f32 v76, v76
    v_exp_f32 v77, v77
    v_exp_f32 v78, v78
    v_exp_f32 v79, v79
    v_mfma_f32_32x32x16_bf16 v[32:47], v[96:99], v[64:67], v[32:47]
    ds_read_b64 v[90:91], v109 offset:1280
    v_cvt_pk_bf16_f32 v68, v72, v73
    v_cvt_pk_bf16_f32 v69, v74, v75
    v_cvt_pk_bf16_f32 v70, v76, v77
    v_cvt_pk_bf16_f32 v71, v78, v79
    v_exp_f32 v48, v48
    v_exp_f32 v49, v49
    v_exp_f32 v50, v50
    v_mfma_f32_32x32x16_bf16 v[32:47], v[104:107], v[68:71], v[32:47]
    ds_read_b128 v[96:99], v110 offset:6080
    v_exp_f32 v51, v51
    v_exp_f32 v52, v52
    v_exp_f32 v53, v53
    v_exp_f32 v54, v54
    v_exp_f32 v55, v55
    v_mfma_f32_32x32x16_bf16 v[64:79], v[80:83], v[250:253], 0
    ds_read_b128 v[104:107], v110 offset:6688
    v_cvt_pk_bf16_f32 v48, v48, v49
    v_cvt_pk_bf16_f32 v49, v50, v51
    v_cvt_pk_bf16_f32 v50, v52, v53
    v_cvt_pk_bf16_f32 v51, v54, v55
    v_exp_f32 v56, v56
    v_exp_f32 v57, v57
    v_exp_f32 v58, v58
    v_mfma_f32_32x32x8_bf16 v[64:79], v[88:89], v[254:255], v[64:79]
    s_waitcnt lgkmcnt(2)
    v_exp_f32 v59, v59
    v_exp_f32 v60, v60
    v_exp_f32 v61, v61
    v_exp_f32 v62, v62
    v_exp_f32 v63, v63
    v_mfma_f32_32x32x16_bf16 v[16:31], v[92:95], v[48:51], v[16:31]
    s_mov_b32 m0, s52
    s_nop 0
    global_load_lds_dwordx4 v6, s[28:29] offset:2048 sc1
    v_cvt_pk_bf16_f32 v52, v56, v57
    v_cvt_pk_bf16_f32 v53, v58, v59
    v_cvt_pk_bf16_f32 v54, v60, v61
    v_cvt_pk_bf16_f32 v55, v62, v63
    v_exp_f32 v64, v64
    v_exp_f32 v65, v65
    v_exp_f32 v66, v66
    v_mfma_f32_32x32x16_bf16 v[16:31], v[100:103], v[52:55], v[16:31]
    s_mov_b32 m0, s52
    s_nop 0
    global_load_lds_dwordx4 v6, s[28:29] offset:3072 sc1
    v_exp_f32 v67, v67
    v_exp_f32 v68, v68
    v_exp_f32 v69, v69
    v_exp_f32 v70, v70
    v_exp_f32 v71, v71
    v_mfma_f32_32x32x16_bf16 v[48:63], v[84:87], v[244:247], 0
    s_add_u32 s38, s38, 8192
    s_addc_u32 s39, s39, 0
    global_load_dwordx4 v[234:237], v6, s[38:39] sc1
    v_cvt_pk_bf16_f32 v64, v64, v65
    v_cvt_pk_bf16_f32 v65, v66, v67
    v_cvt_pk_bf16_f32 v66, v68, v69
    v_cvt_pk_bf16_f32 v67, v70, v71
    v_exp_f32 v72, v72
    v_exp_f32 v73, v73
    v_exp_f32 v74, v74
    v_mfma_f32_32x32x8_bf16 v[48:63], v[90:91], v[248:249], v[48:63]
    ds_read_b128 v[80:83], v108 offset:6144
    v_exp_f32 v75, v75
    v_exp_f32 v76, v76
    v_exp_f32 v77, v77
    v_exp_f32 v78, v78
    v_exp_f32 v79, v79
    v_mfma_f32_32x32x16_bf16 v[32:47], v[92:95], v[64:67], v[32:47]
    ds_read_b64 v[88:89], v109 offset:1536
    v_cvt_pk_bf16_f32 v68, v72, v73
    v_cvt_pk_bf16_f32 v69, v74, v75
    v_cvt_pk_bf16_f32 v70, v76, v77
    v_cvt_pk_bf16_f32 v71, v78, v79
    v_exp_f32 v48, v48
    v_exp_f32 v49, v49
    v_exp_f32 v50, v50
    v_mfma_f32_32x32x16_bf16 v[32:47], v[100:103], v[68:71], v[32:47]
    ds_read_b128 v[92:95], v110 offset:7296
    v_exp_f32 v51, v51
    v_exp_f32 v52, v52
    v_exp_f32 v53, v53
    v_exp_f32 v54, v54
    v_exp_f32 v55, v55
    v_mfma_f32_32x32x16_bf16 v[64:79], v[84:87], v[250:253], 0
    ds_read_b128 v[100:103], v110 offset:7904
    v_cvt_pk_bf16_f32 v48, v48, v49
    v_cvt_pk_bf16_f32 v49, v50, v51
    v_cvt_pk_bf16_f32 v50, v52, v53
    v_cvt_pk_bf16_f32 v51, v54, v55
    v_exp_f32 v56, v56
    v_exp_f32 v57, v57
    v_exp_f32 v58, v58
    v_mfma_f32_32x32x8_bf16 v[64:79], v[90:91], v[254:255], v[64:79]
    s_waitcnt lgkmcnt(2)
    v_exp_f32 v59, v59
    v_exp_f32 v60, v60
    v_exp_f32 v61, v61
    v_exp_f32 v62, v62
    v_exp_f32 v63, v63
    v_mfma_f32_32x32x16_bf16 v[16:31], v[96:99], v[48:51], v[16:31]
    s_add_u32 s28, s28, 4096
    s_addc_u32 s29, s29, 0
    s_add_u32 s52, s52, 4096
    s_mov_b32 m0, s52
    s_nop 0
    global_load_lds_dwordx4 v6, s[28:29] offset:0 sc1
    v_cvt_pk_bf16_f32 v52, v56, v57
    v_cvt_pk_bf16_f32 v53, v58, v59
    v_cvt_pk_bf16_f32 v54, v60, v61
    v_cvt_pk_bf16_f32 v55, v62, v63
    v_exp_f32 v64, v64
    v_exp_f32 v65, v65
    v_exp_f32 v66, v66
    v_mfma_f32_32x32x16_bf16 v[16:31], v[104:107], v[52:55], v[16:31]
    s_mov_b32 m0, s52
    s_nop 0
    global_load_lds_dwordx4 v6, s[28:29] offset:1024 sc1
    v_exp_f32 v67, v67
    v_exp_f32 v68, v68
    v_exp_f32 v69, v69
    v_exp_f32 v70, v70
    v_exp_f32 v71, v71
    v_mfma_f32_32x32x16_bf16 v[48:63], v[80:83], v[244:247], 0
    s_add_u32 s38, s38, 8192
    s_addc_u32 s39, s39, 0
    v_mov_b32 v238, 0
    v_mov_b32 v239, 0
    v_mov_b32 v240, 0
    v_mov_b32 v241, 0
    s_cmp_ge_u32 s8, 2
    s_cbranch_scc1 L_w9_0
    global_load_dwordx4 v[238:241], v6, s[38:39] sc1
L_w9_0:
    v_cvt_pk_bf16_f32 v64, v64, v65
    v_cvt_pk_bf16_f32 v65, v66, v67
    v_cvt_pk_bf16_f32 v66, v68, v69
    v_cvt_pk_bf16_f32 v67, v70, v71
    v_exp_f32 v72, v72
    v_exp_f32 v73, v73
    v_exp_f32 v74, v74
    v_mfma_f32_32x32x8_bf16 v[48:63], v[88:89], v[248:249], v[48:63]
    ds_read_b128 v[84:87], v108 offset:7168
    v_exp_f32 v75, v75
    v_exp_f32 v76, v76
    v_exp_f32 v77, v77
    v_exp_f32 v78, v78
    v_exp_f32 v79, v79
    v_mfma_f32_32x32x16_bf16 v[32:47], v[96:99], v[64:67], v[32:47]
    ds_read_b64 v[90:91], v109 offset:1792
    v_cvt_pk_bf16_f32 v68, v72, v73
    v_cvt_pk_bf16_f32 v69, v74, v75
    v_cvt_pk_bf16_f32 v70, v76, v77
    v_cvt_pk_bf16_f32 v71, v78, v79
    v_exp_f32 v48, v48
    v_exp_f32 v49, v49
    v_exp_f32 v50, v50
    v_mfma_f32_32x32x16_bf16 v[32:47], v[104:107], v[68:71], v[32:47]
    ds_read_b128 v[96:99], v110 offset:8512
    v_exp_f32 v51, v51
    v_exp_f32 v52, v52
    v_exp_f32 v53, v53
    v_exp_f32 v54, v54
    v_exp_f32 v55, v55
    v_mfma_f32_32x32x16_bf16 v[64:79], v[80:83], v[250:253], 0
    ds_read_b128 v[104:107], v110 offset:9120
    v_cvt_pk_bf16_f32 v48, v48, v49
    v_cvt_pk_bf16_f32 v49, v50, v51
    v_cvt_pk_bf16_f32 v50, v52, v53
    v_cvt_pk_bf16_f32 v51, v54, v55
    v_exp_f32 v56, v56
    v_exp_f32 v57, v57
    v_exp_f32 v58, v58
    v_mfma_f32_32x32x8_bf16 v[64:79], v[88:89], v[254:255], v[64:79]
    s_waitcnt lgkmcnt(2)
    v_exp_f32 v59, v59
    v_exp_f32 v60, v60
    v_exp_f32 v61, v61
    v_exp_f32 v62, v62
    v_exp_f32 v63, v63
    v_mfma_f32_32x32x16_bf16 v[16:31], v[92:95], v[48:51], v[16:31]
    s_mov_b32 m0, s52
    s_nop 0
    global_load_lds_dwordx4 v6, s[28:29] offset:2048 sc1
    v_cvt_pk_bf16_f32 v52, v56, v57
    v_cvt_pk_bf16_f32 v53, v58, v59
    v_cvt_pk_bf16_f32 v54, v60, v61
    v_cvt_pk_bf16_f32 v55, v62, v63
    v_exp_f32 v64, v64
    v_exp_f32 v65, v65
    v_exp_f32 v66, v66
    v_mfma_f32_32x32x16_bf16 v[16:31], v[100:103], v[52:55], v[16:31]
    s_mov_b32 m0, s52
    s_nop 0
    global_load_lds_dwordx4 v6, s[28:29] offset:3072 sc1
    v_exp_f32 v67, v67
    v_exp_f32 v68, v68
    v_exp_f32 v69, v69
    v_exp_f32 v70, v70
    v_exp_f32 v71, v71
    v_mfma_f32_32x32x16_bf16 v[48:63], v[84:87], v[244:247], 0
    v_cvt_pk_bf16_f32 v64, v64, v65
    v_cvt_pk_bf16_f32 v65, v66, v67
    v_cvt_pk_bf16_f32 v66, v68, v69
    v_cvt_pk_bf16_f32 v67, v70, v71
    s_waitcnt vmcnt(10)
    v_cmp_gt_u32 vcc, 32, v1
    v_mov_b32 v141, 0
    v_mov_b32 v129, 0
    v_cndmask_b32 v128, v141, v128, vcc
    s_nop 1
    v_mfma_f32_32x32x16_bf16 v[142:157], v[124:127], v[118:121], 0
    v_mfma_f32_32x32x8_bf16 v[142:157], v[128:129], v[122:123], v[142:157]
    s_add_u32 s76, s56, 18432
    s_addc_u32 s77, s57, 0
    s_add_u32 s78, s58, 18432
    s_addc_u32 s79, s59, 0
    s_nop 15
    v_mov_b32 v10, v152
    v_mov_b32 v11, v152
    s_nop 1
    v_permlane32_swap_b32 v10, v11
    s_nop 1
    v_add_f32 v10, 0x358637bd, v10
    v_rcp_f32 v10, v10
    v_sub_f32 v11, 1.0, v117
    s_nop 0
    v_mul_f32 v10, v10, v11
    v_mul_f32 v142, v142, v10
    v_mul_f32 v143, v143, v10
    v_mul_f32 v144, v144, v10
    v_mul_f32 v145, v145, v10
    v_mul_f32 v146, v146, v10
    v_mul_f32 v147, v147, v10
    v_mul_f32 v148, v148, v10
    v_mul_f32 v149, v149, v10
    v_mul_f32 v150, v150, v10
    v_mul_f32 v151, v151, v10
    v_cvt_pk_bf16_f32 v130, v142, v143
    v_cvt_pk_bf16_f32 v131, v144, v145
    v_cvt_pk_bf16_f32 v132, v146, v147
    v_cvt_pk_bf16_f32 v133, v148, v149
    v_cvt_pk_bf16_f32 v134, v150, v151
    v_lshl_add_u32 v136, v5, 8, v7
    global_store_dwordx4 v136, v[130:133], s[76:77] sc1
    s_mov_b64 exec, s[64:65]
    global_store_dword v7, v134, s[78:79] sc1
    s_mov_b64 exec, -1
    s_cmp_eq_u32 s13, 0
    s_cbranch_scc1 L_prio30
    s_setprio 0
L_prio30:
    v_exp_f32 v72, v72
    v_exp_f32 v73, v73
    v_exp_f32 v74, v74
    v_mfma_f32_32x32x8_bf16 v[48:63], v[90:91], v[248:249], v[48:63]
    ds_read_b128 v[80:83], v111 offset:0
    v_exp_f32 v75, v75
    v_exp_f32 v76, v76
    v_exp_f32 v77, v77
    v_exp_f32 v78, v78
    v_exp_f32 v79, v79
    v_mfma_f32_32x32x16_bf16 v[32:47], v[92:95], v[64:67], v[32:47]
    ds_read_b64 v[88:89], v112 offset:0
    v_cvt_pk_bf16_f32 v68, v72, v73
    v_cvt_pk_bf16_f32 v69, v74, v75
    v_cvt_pk_bf16_f32 v70, v76, v77
    v_cvt_pk_bf16_f32 v71, v78, v79
    v_exp_f32 v48, v48
    v_exp_f32 v49, v49
    v_exp_f32 v50, v50
    v_mfma_f32_32x32x16_bf16 v[32:47], v[100:103], v[68:71], v[32:47]
    ds_read_b128 v[92:95], v113 offset:0
    v_exp_f32 v51, v51
    v_exp_f32 v52, v52
    v_exp_f32 v53, v53
    v_exp_f32 v54, v54
    v_exp_f32 v55, v55
    v_mfma_f32_32x32x16_bf16 v[64:79], v[84:87], v[250:253], 0
    ds_read_b128 v[100:103], v113 offset:608
    v_cvt_pk_bf16_f32 v48, v48, v49
    v_cvt_pk_bf16_f32 v49, v50, v51
    v_cvt_pk_bf16_f32 v50, v52, v53
    v_cvt_pk_bf16_f32 v51, v54, v55
    v_exp_f32 v56, v56
    v_exp_f32 v57, v57
    v_exp_f32 v58, v58
    v_mfma_f32_32x32x8_bf16 v[64:79], v[90:91], v[254:255], v[64:79]
    s_waitcnt lgkmcnt(2)
    v_exp_f32 v59, v59
    v_exp_f32 v60, v60
    v_exp_f32 v61, v61
    v_exp_f32 v62, v62
    v_exp_f32 v63, v63
    v_mfma_f32_32x32x16_bf16 v[16:31], v[96:99], v[48:51], v[16:31]
    s_add_u32 s28, s28, 4096
    s_addc_u32 s29, s29, 0
    s_add_u32 s52, s52, 4096
    s_mov_b32 m0, s52
    s_nop 0
    global_load_lds_dwordx4 v6, s[28:29] offset:0 sc1
    v_cvt_pk_bf16_f32 v52, v56, v57
    v_cvt_pk_bf16_f32 v53, v58, v59
    v_cvt_pk_bf16_f32 v54, v60, v61
    v_cvt_pk_bf16_f32 v55, v62, v63
    v_exp_f32 v64, v64
    v_exp_f32 v65, v65
    v_exp_f32 v66, v66
    v_mfma_f32_32x32x16_bf16 v[16:31], v[104:107], v[52:55], v[16:31]
    v_exp_f32 v67, v67
    v_exp_f32 v68, v68
    v_exp_f32 v69, v69
    v_exp_f32 v70, v70
    v_exp_f32 v71, v71
    v_mfma_f32_32x32x16_bf16 v[48:63], v[80:83], v[244:247], 0
    v_cvt_pk_bf16_f32 v64, v64, v65
    v_cvt_pk_bf16_f32 v65, v66, v67
    v_cvt_pk_bf16_f32 v66, v68, v69
    v_cvt_pk_bf16_f32 v67, v70, v71
    v_exp_f32 v72, v72
    v_exp_f32 v73, v73
    v_exp_f32 v74, v74
    v_mfma_f32_32x32x8_bf16 v[48:63], v[88:89], v[248:249], v[48:63]
    ds_read_b128 v[84:87], v111 offset:1024
    v_exp_f32 v75, v75
    v_exp_f32 v76, v76
    v_exp_f32 v77, v77
    v_exp_f32 v78, v78
    v_exp_f32 v79, v79
    v_mfma_f32_32x32x16_bf16 v[32:47], v[96:99], v[64:67], v[32:47]
    ds_read_b64 v[90:91], v112 offset:256
    v_cvt_pk_bf16_f32 v68, v72, v73
    v_cvt_pk_bf16_f32 v69, v74, v75
    v_cvt_pk_bf16_f32 v70, v76, v77
    v_cvt_pk_bf16_f32 v71, v78, v79
    s_nop 1
    v_mfma_f32_32x32x16_bf16 v[32:47], v[104:107], v[68:71], v[32:47]
    s_waitcnt lgkmcnt(0)
    s_mul_i32 s16, s12, 9
    s_add_u32 s17, s16, s8
    s_mul_i32 s17, s17, 18432
    s_add_u32 s17, s17, 0x7e2000
    s_add_u32 s22, s4, s17
    s_addc_u32 s23, s5, 0
    s_add_u32 s16, s16, 8
    s_mul_i32 s16, s16, 18432
    s_lshl_b32 s17, s8, 10
    s_add_u32 s16, s16, s17
    s_add_u32 s16, s16, 0x7e2000
    s_add_u32 s38, s4, s16
    s_addc_u32 s39, s5, 0
    s_add_u32 s22, s22, 4096
    s_addc_u32 s23, s23, 0
    s_add_u32 s22, s22, 4096
    s_addc_u32 s23, s23, 0
    global_load_dwordx4 v[84:87], v6, s[22:23] offset:1024 sc1
    global_load_dwordx4 v[88:91], v6, s[22:23] offset:2048 sc1
    global_load_dwordx4 v[92:95], v6, s[22:23] offset:3072 sc1
    s_add_u32 s22, s22, 4096
    s_addc_u32 s23, s23, 0
    global_load_dwordx4 v[96:99], v6, s[22:23] offset:0 sc1
    global_load_dwordx4 v[100:103], v6, s[22:23] offset:1024 sc1
    global_load_dwordx4 v[104:107], v6, s[22:23] offset:2048 sc1
    s_mul_i32 s16, s14, 3072
    s_add_u32 s16, s16, 119808
    s_mul_i32 s17, s13, 19968
    s_add_u32 s18, s16, s17
    s_sub_u32 s17, 19968, s17
    s_add_u32 s19, s16, s17
    v_add_u32 v8, s18, v6
    v_add_u32 v9, s19, v6
    s_cmp_eq_u32 s13, 0
    s_cbranch_scc1 L_at_x0
    s_nop 7
    ds_write_b128 v8, v[16:19] offset:0
    ds_write_b128 v8, v[20:23] offset:1024
    ds_write_b128 v8, v[24:27] offset:2048
    s_nop 7
    v_mov_b32 v16, v32
    v_mov_b32 v17, v33
    v_mov_b32 v18, v34
    v_mov_b32 v19, v35
    v_mov_b32 v20, v36
    v_mov_b32 v21, v37
    v_mov_b32 v22, v38
    v_mov_b32 v23, v39
    v_mov_b32 v24, v40
    v_mov_b32 v25, v41
    v_mov_b32 v26, v42
    v_mov_b32 v244, v250
    v_mov_b32 v245, v251
    v_mov_b32 v246, v252
    v_mov_b32 v247, v253
    v_mov_b32 v248, v254
    s_branch L_at_x1
L_at_x0:
    s_nop 15
    ds_write_b128 v8, v[32:35] offset:0
    ds_write_b128 v8, v[36:39] offset:1024
    ds_write_b128 v8, v[40:43] offset:2048
L_at_x1:
    s_waitcnt vmcnt(6)
    s_waitcnt lgkmcnt(0)
    s_barrier
    s_lshl_b32 s16, s2, 7
    s_add_u32 s16, s16, 0xf28000
    v_mov_b32 v12, s16
    v_mov_b32 v13, s3
    s_cmp_eq_u32 s8, 0
    s_cselect_b32 exec_lo, 1, 0
    s_mov_b32 exec_hi, 0
    global_store_dword v12, v13, s[4:5] sc1
    s_mov_b64 exec, -1
    ds_read_b128 v[32:35], v9 offset:0
    ds_read_b128 v[36:39], v9 offset:1024
    ds_read_b128 v[40:43], v9 offset:2048
    s_waitcnt lgkmcnt(0)
    v_add_f32 v16, v16, v32
    v_add_f32 v17, v17, v33
    v_add_f32 v18, v18, v34
    v_add_f32 v19, v19, v35
    v_add_f32 v20, v20, v36
    v_add_f32 v21, v21, v37
    v_add_f32 v22, v22, v38
    v_add_f32 v23, v23, v39
    v_add_f32 v24, v24, v40
    v_add_f32 v25, v25, v41
    v_add_f32 v26, v26, v42
    v_mov_b32 v10, v26
    v_mov_b32 v11, v26
    s_nop 1
    v_permlane32_swap_b32 v10, v11
    s_nop 1
    v_mov_b32 v11, 0x1f800000
    v_cmp_nge_f32 vcc, v10, v11
    s_cbranch_vccnz L_at_fallback
L_at_epi:
    v_rcp_f32 v10, v10
    s_nop 0
    v_mul_f32 v10, v10, v117
    v_mul_f32 v16, v16, v10
    v_mul_f32 v17, v17, v10
    v_mul_f32 v18, v18, v10
    v_mul_f32 v19, v19, v10
    v_mul_f32 v20, v20, v10
    v_mul_f32 v21, v21, v10
    v_mul_f32 v22, v22, v10
    v_mul_f32 v23, v23, v10
    v_mul_f32 v24, v24, v10
    v_mul_f32 v25, v25, v10
    v_cvt_pk_bf16_f32 v130, v16, v17
    v_cvt_pk_bf16_f32 v131, v18, v19
    v_cvt_pk_bf16_f32 v132, v20, v21
    v_cvt_pk_bf16_f32 v133, v22, v23
    v_cvt_pk_bf16_f32 v134, v24, v25
    v_lshl_add_u32 v136, v5, 8, v7
    global_store_dwordx4 v136, v[130:133], s[56:57] sc1
    s_mov_b64 exec, s[64:65]
    global_store_dword v7, v134, s[58:59] sc1
    s_mov_b64 exec, -1
    s_and_b32 s16, s10, 0x1c
    s_lshl_b32 s16, s16, 3
    s_add_u32 s16, s16, s9
    v_and_b32 v14, 3, v1
    v_lshlrev_b32 v14, 3, v14
    v_add_u32 v14, s16, v14
    v_lshlrev_b32 v14, 7, v14
    v_add_u32 v14, 0xf28000, v14
    s_cmp_lg_u32 s8, 1
    s_cbranch_scc1 L_tl_ob_i
    global_load_dword v15, v14, s[4:5] sc1
L_tl_ob_i:
    s_mul_i32 s16, s11, 73728
    s_add_u32 s16, s16, 0x890000
    s_add_u32 s17, s4, s16
    s_addc_u32 s18, s5, 0
    s_mov_b32 s32, s17
    s_and_b32 s33, s18, 0xffff
    s_mov_b32 s34, 73728
    s_mov_b32 s35, 0x20000
    s_load_dwordx2 s[76:77], s[0:1], 72
    s_mul_i32 s16, s8, 9216
    v_add_u32 v8, s16, v6
    ds_read_b128 v[48:51], v8 offset:0
    ds_read_b128 v[52:55], v8 offset:1024
    ds_read_b128 v[56:59], v8 offset:2048
    ds_read_b128 v[60:63], v8 offset:3072
    ds_read_b128 v[64:67], v8 offset:4096
    ds_read_b128 v[68:71], v8 offset:5120
    ds_read_b128 v[72:75], v8 offset:6144
    ds_read_b128 v[76:79], v8 offset:7168
    ds_read_b128 v[80:83], v8 offset:8192
    s_waitcnt vmcnt(0) lgkmcnt(0)
    s_cmp_lg_u32 s8, 1
    s_cbranch_scc1 L_tl_ob_w
    s_mov_b32 s21, 0
L_tl_ob_spin:
    s_waitcnt vmcnt(0)
    v_cmp_eq_u32 vcc, s3, v15
    s_add_u32 s21, s21, 1
    s_cmp_eq_u64 vcc, -1
    s_cbranch_scc1 L_tl_ob_ok
    s_sleep 2
    global_load_dword v15, v14, s[4:5] sc1
    s_cmp_lt_u32 s21, 0x40000
    s_cbranch_scc1 L_tl_ob_spin
L_tl_ob_ok:
L_tl_ob_w:
    s_barrier
    s_lshl_b32 s16, s2, 7
    s_add_u32 s16, s16, 0xf30000
    v_mov_b32 v8, s16
    v_mov_b32 v9, s3
    s_cmp_eq_u32 s8, 0
    s_cselect_b32 exec_lo, 1, 0
    s_mov_b32 exec_hi, 0
    global_store_dword v8, v9, s[4:5] sc1
    s_mov_b64 exec, -1
    s_and_b32 s16, s8, 1
    s_mul_i32 s16, s16, 36864
    s_lshr_b32 s17, s8, 1
    s_lshl_b32 s17, s17, 10
    s_add_u32 s16, s16, s17
    s_add_u32 s16, s16, 18432
    s_add_u32 s20, s16, 0
    s_mov_b32 m0, s20
    s_nop 0
    buffer_load_dwordx4 v6, s[32:35], s20 offen sc1 lds
    s_add_u32 s20, s16, 4096
    s_mov_b32 m0, s20
    s_nop 0
    buffer_load_dwordx4 v6, s[32:35], s20 offen sc1 lds
    s_add_u32 s20, s16, 8192
    s_mov_b32 m0, s20
    s_nop 0
    buffer_load_dwordx4 v6, s[32:35], s20 offen sc1 lds
    s_add_u32 s20, s16, 12288
    s_mov_b32 m0, s20
    s_nop 0
    buffer_load_dwordx4 v6, s[32:35], s20 offen sc1 lds
    s_add_u32 s20, s16, 16384
    s_cmp_lt_u32 s8, 4
    s_cbranch_scc0 L_act_skip1
    s_mov_b32 m0, s20
    s_nop 0
    buffer_load_dwordx4 v6, s[32:35], s20 offen sc1 lds
L_act_skip1:
    s_mul_i32 s16, s12, 9
    s_add_u32 s17, s16, s8
    s_mul_i32 s17, s17, 18432
    s_add_u32 s17, s17, 0x7e2000
    s_add_u32 s22, s4, s17
    s_addc_u32 s23, s5, 0
    s_add_u32 s16, s16, 8
    s_mul_i32 s16, s16, 18432
    s_lshl_b32 s17, s8, 10
    s_add_u32 s16, s16, s17
    s_add_u32 s16, s16, 0x7e2000
    s_add_u32 s38, s4, s16
    s_addc_u32 s39, s5, 0
    s_add_u32 s22, s22, 4096
    s_addc_u32 s23, s23, 0
    s_add_u32 s22, s22, 4096
    s_addc_u32 s23, s23, 0
    s_add_u32 s22, s22, 4096
    s_addc_u32 s23, s23, 0
    global_load_dwordx4 v[16:19], v6, s[22:23] offset:3072 sc1
    s_add_u32 s22, s22, 4096
    s_addc_u32 s23, s23, 0
    global_load_dwordx4 v[20:23], v6, s[22:23] offset:0 sc1
    global_load_dwordx4 v[24:27], v6, s[22:23] offset:1024 sc1
    global_load_dwordx4 v[28:31], v6, s[38:39] sc1
    s_add_u32 s38, s38, 8192
    s_addc_u32 s39, s39, 0
    global_load_dwordx4 v[32:35], v6, s[38:39] sc1
    s_add_u32 s38, s38, 8192
    s_addc_u32 s39, s39, 0
    v_mov_b32 v36, 0
    v_mov_b32 v37, 0
    v_mov_b32 v38, 0
    v_mov_b32 v39, 0
    s_cmp_ge_u32 s8, 2
    s_cbranch_scc1 L_w9_1
    global_load_dwordx4 v[36:39], v6, s[38:39] sc1
L_w9_1:
    s_cmp_eq_u32 s8, 1
    s_cbranch_scc0 L_tl_wl
    s_setprio 3
    s_and_b32 s16, s10, 0x1c
    s_lshl_b32 s16, s16, 3
    s_add_u32 s16, s16, s9
    v_and_b32 v14, 3, v1
    v_lshlrev_b32 v14, 3, v14
    v_add_u32 v14, s16, v14
    v_lshlrev_b32 v14, 7, v14
    v_add_u32 v14, 0xf30000, v14
    global_load_dword v15, v14, s[4:5] sc1
    s_mov_b32 s21, 0
L_tl_oa_spin:
    s_waitcnt vmcnt(0)
    v_cmp_eq_u32 vcc, s3, v15
    s_add_u32 s21, s21, 1
    s_cmp_eq_u64 vcc, -1
    s_cbranch_scc1 L_tl_oa_ok
    s_sleep 2
    global_load_dword v15, v14, s[4:5] sc1
    s_cmp_lt_u32 s21, 0x40000
    s_cbranch_scc1 L_tl_oa_spin
L_tl_oa_ok:
    s_setprio 0
L_tl_wl:
    s_barrier
    s_and_b32 s16, s8, 1
    s_mul_i32 s16, s16, 36864
    s_lshr_b32 s17, s8, 1
    s_lshl_b32 s17, s17, 10
    s_add_u32 s16, s16, s17
    s_add_u32 s16, s16, 0
    s_add_u32 s20, s16, 0
    s_mov_b32 m0, s20
    s_nop 0
    buffer_load_dwordx4 v6, s[32:35], s20 offen sc1 lds
    s_add_u32 s20, s16, 4096
    s_mov_b32 m0, s20
    s_nop 0
    buffer_load_dwordx4 v6, s[32:35], s20 offen sc1 lds
    s_add_u32 s20, s16, 8192
    s_mov_b32 m0, s20
    s_nop 0
    buffer_load_dwordx4 v6, s[32:35], s20 offen sc1 lds
    s_add_u32 s20, s16, 12288
    s_mov_b32 m0, s20
    s_nop 0
    buffer_load_dwordx4 v6, s[32:35], s20 offen sc1 lds
    s_add_u32 s20, s16, 16384
    s_cmp_lt_u32 s8, 4
    s_cbranch_scc0 L_act_skip0
    s_mov_b32 m0, s20
    s_nop 0
    buffer_load_dwordx4 v6, s[32:35], s20 offen sc1 lds
L_act_skip0:
    v_and_b32 v8, 15, v1
    v_mul_u32_u24 v8, 1152, v8
    v_lshrrev_b32 v9, 4, v1
    v_lshl_add_u32 v8, v9, 3, v8
    v_add_u32 v9, 36864, v6
    s_lshl_b32 s16, s8, 10
    v_add_u32 v10, s16, v6
    s_add_u32 s17, s8, 16
    s_min_u32 s17, s17, 17
    s_lshl_b32 s17, s17, 10
    v_add_u32 v11, s17, v6
    s_waitcnt vmcnt(4) lgkmcnt(0)
    s_barrier
    ds_read_b128 v[108:111], v6 offset:18432
    ds_read_b128 v[112:115], v9 offset:18432
    ds_read_b128 v[116:119], v6 offset:19456
    ds_read_b128 v[120:123], v9 offset:19456
    ds_read_b128 v[124:127], v6 offset:20480
    ds_read_b128 v[128:131], v9 offset:20480
    s_waitcnt lgkmcnt(4)
    v_mfma_f32_16x16x32_bf16 v[142:145], v[48:51], v[108:111], 0
    v_mfma_f32_16x16x32_bf16 v[146:149], v[48:51], v[112:115], 0
    ds_read_b128 v[108:111], v6 offset:21504
    ds_read_b128 v[112:115], v9 offset:21504
    s_waitcnt lgkmcnt(4)
    v_mfma_f32_16x16x32_bf16 v[142:145], v[52:55], v[116:119], v[142:145]
    v_mfma_f32_16x16x32_bf16 v[146:149], v[52:55], v[120:123], v[146:149]
    ds_read_b128 v[116:119], v6 offset:22528
    ds_read_b128 v[120:123], v9 offset:22528
    s_waitcnt lgkmcnt(4)
    v_mfma_f32_16x16x32_bf16 v[142:145], v[56:59], v[124:127], v[142:145]
    v_mfma_f32_16x16x32_bf16 v[146:149], v[56:59], v[128:131], v[146:149]
    ds_read_b128 v[124:127], v6 offset:23552
    ds_read_b128 v[128:131], v9 offset:23552
    s_waitcnt lgkmcnt(4)
    v_mfma_f32_16x16x32_bf16 v[142:145], v[60:63], v[108:111], v[142:145]
    v_mfma_f32_16x16x32_bf16 v[146:149], v[60:63], v[112:115], v[146:149]
    ds_read_b128 v[108:111], v6 offset:24576
    ds_read_b128 v[112:115], v9 offset:24576
    s_waitcnt lgkmcnt(4)
    v_mfma_f32_16x16x32_bf16 v[142:145], v[64:67], v[116:119], v[142:145]
    v_mfma_f32_16x16x32_bf16 v[146:149], v[64:67], v[120:123], v[146:149]
    ds_read_b128 v[116:119], v6 offset:25600
    ds_read_b128 v[120:123], v9 offset:25600
    s_waitcnt lgkmcnt(4)
    v_mfma_f32_16x16x32_bf16 v[142:145], v[68:71], v[124:127], v[142:145]
    v_mfma_f32_16x16x32_bf16 v[146:149], v[68:71], v[128:131], v[146:149]
    ds_read_b128 v[124:127], v6 offset:26624
    ds_read_b128 v[128:131], v9 offset:26624
    s_waitcnt lgkmcnt(4)
    v_mfma_f32_16x16x32_bf16 v[142:145], v[72:75], v[108:111], v[142:145]
    v_mfma_f32_16x16x32_bf16 v[146:149], v[72:75], v[112:115], v[146:149]
    ds_read_b128 v[108:111], v6 offset:27648
    ds_read_b128 v[112:115], v9 offset:27648
    s_waitcnt lgkmcnt(4)
    v_mfma_f32_16x16x32_bf16 v[142:145], v[76:79], v[116:119], v[142:145]
    v_mfma_f32_16x16x32_bf16 v[146:149], v[76:79], v[120:123], v[146:149]
    ds_read_b128 v[116:119], v6 offset:28672
    ds_read_b128 v[120:123], v9 offset:28672
    s_waitcnt lgkmcnt(4)
    v_mfma_f32_16x16x32_bf16 v[142:145], v[80:83], v[124:127], v[142:145]
    v_mfma_f32_16x16x32_bf16 v[146:149], v[80:83], v[128:131], v[146:149]
    ds_read_b128 v[124:127], v6 offset:29696
    ds_read_b128 v[128:131], v9 offset:29696
    s_waitcnt lgkmcnt(4)
    v_mfma_f32_16x16x32_bf16 v[142:145], v[84:87], v[108:111], v[142:145]
    v_mfma_f32_16x16x32_bf16 v[146:149], v[84:87], v[112:115], v[146:149]
    ds_read_b128 v[108:111], v6 offset:30720
    ds_read_b128 v[112:115], v9 offset:30720
    s_waitcnt lgkmcnt(4)
    v_mfma_f32_16x16x32_bf16 v[142:145], v[88:91], v[116:119], v[142:145]
    v_mfma_f32_16x16x32_bf16 v[146:149], v[88:91], v[120:123], v[146:149]
    ds_read_b128 v[116:119], v6 offset:31744
    ds_read_b128 v[120:123], v9 offset:31744
    s_waitcnt lgkmcnt(4)
    v_mfma_f32_16x16x32_bf16 v[142:145], v[92:95], v[124:127], v[142:145]
    v_mfma_f32_16x16x32_bf16 v[146:149], v[92:95], v[128:131], v[146:149]
    ds_read_b128 v[124:127], v6 offset:32768
    ds_read_b128 v[128:131], v9 offset:32768
    s_waitcnt lgkmcnt(4)
    v_mfma_f32_16x16x32_bf16 v[142:145], v[96:99], v[108:111], v[142:145]
    v_mfma_f32_16x16x32_bf16 v[146:149], v[96:99], v[112:115], v[146:149]
    ds_read_b128 v[108:111], v6 offset:33792
    ds_read_b128 v[112:115], v9 offset:33792
    s_waitcnt lgkmcnt(4)
    v_mfma_f32_16x16x32_bf16 v[142:145], v[100:103], v[116:119], v[142:145]
    v_mfma_f32_16x16x32_bf16 v[146:149], v[100:103], v[120:123], v[146:149]
    ds_read_b128 v[116:119], v6 offset:34816
    ds_read_b128 v[120:123], v9 offset:34816
    s_waitcnt lgkmcnt(4)
    v_mfma_f32_16x16x32_bf16 v[142:145], v[104:107], v[124:127], v[142:145]
    v_mfma_f32_16x16x32_bf16 v[146:149], v[104:107], v[128:131], v[146:149]
    ds_read_b128 v[124:127], v6 offset:35840
    ds_read_b128 v[128:131], v9 offset:35840
    s_waitcnt lgkmcnt(4)
    v_mfma_f32_16x16x32_bf16 v[142:145], v[16:19], v[108:111], v[142:145]
    v_mfma_f32_16x16x32_bf16 v[146:149], v[16:19], v[112:115], v[146:149]
    s_waitcnt lgkmcnt(2)
    v_mfma_f32_16x16x32_bf16 v[142:145], v[20:23], v[116:119], v[142:145]
    v_mfma_f32_16x16x32_bf16 v[146:149], v[20:23], v[120:123], v[146:149]
    s_waitcnt lgkmcnt(0)
    v_mfma_f32_16x16x32_bf16 v[142:145], v[24:27], v[124:127], v[142:145]
    v_mfma_f32_16x16x32_bf16 v[146:149], v[24:27], v[128:131], v[146:149]
    ds_read_b128 v[108:111], v10 offset:18432
    ds_read_b128 v[112:115], v10 offset:55296
    ds_read_b128 v[116:119], v10 offset:26624
    ds_read_b128 v[120:123], v10 offset:63488
    ds_read_b128 v[124:127], v11 offset:18432
    ds_read_b128 v[128:131], v11 offset:55296
    s_waitcnt lgkmcnt(0)
    v_mfma_f32_16x16x32_bf16 v[150:153], v[28:31], v[108:111], 0
    v_mfma_f32_16x16x32_bf16 v[154:157], v[28:31], v[112:115], 0
    v_mfma_f32_16x16x32_bf16 v[150:153], v[32:35], v[116:119], v[150:153]
    v_mfma_f32_16x16x32_bf16 v[154:157], v[32:35], v[120:123], v[154:157]
    v_mfma_f32_16x16x32_bf16 v[150:153], v[36:39], v[124:127], v[150:153]
    v_mfma_f32_16x16x32_bf16 v[154:157], v[36:39], v[128:131], v[154:157]
    s_waitcnt vmcnt(0)
    s_barrier
    ds_read_b128 v[108:111], v6 offset:0
    ds_read_b128 v[112:115], v9 offset:0
    ds_read_b128 v[116:119], v6 offset:1024
    ds_read_b128 v[120:123], v9 offset:1024
    ds_read_b128 v[124:127], v6 offset:2048
    ds_read_b128 v[128:131], v9 offset:2048
    s_waitcnt lgkmcnt(4)
    v_mfma_f32_16x16x32_bf16 v[142:145], v[158:161], v[108:111], v[142:145]
    v_mfma_f32_16x16x32_bf16 v[146:149], v[158:161], v[112:115], v[146:149]
    ds_read_b128 v[108:111], v6 offset:3072
    ds_read_b128 v[112:115], v9 offset:3072
    s_waitcnt lgkmcnt(4)
    v_mfma_f32_16x16x32_bf16 v[142:145], v[162:165], v[116:119], v[142:145]
    v_mfma_f32_16x16x32_bf16 v[146:149], v[162:165], v[120:123], v[146:149]
    ds_read_b128 v[116:119], v6 offset:4096
    ds_read_b128 v[120:123], v9 offset:4096
    s_waitcnt lgkmcnt(4)
    v_mfma_f32_16x16x32_bf16 v[142:145], v[166:169], v[124:127], v[142:145]
    v_mfma_f32_16x16x32_bf16 v[146:149], v[166:169], v[128:131], v[146:149]
    ds_read_b128 v[124:127], v6 offset:5120
    ds_read_b128 v[128:131], v9 offset:5120
    s_waitcnt lgkmcnt(4)
    v_mfma_f32_16x16x32_bf16 v[142:145], v[170:173], v[108:111], v[142:145]
    v_mfma_f32_16x16x32_bf16 v[146:149], v[170:173], v[112:115], v[146:149]
    ds_read_b128 v[108:111], v6 offset:6144
    ds_read_b128 v[112:115], v9 offset:6144
    s_waitcnt lgkmcnt(4)
    v_mfma_f32_16x16x32_bf16 v[142:145], v[174:177], v[116:119], v[142:145]
    v_mfma_f32_16x16x32_bf16 v[146:149], v[174:177], v[120:123], v[146:149]
    ds_read_b128 v[116:119], v6 offset:7168
    ds_read_b128 v[120:123], v9 offset:7168
    s_waitcnt lgkmcnt(4)
    v_mfma_f32_16x16x32_bf16 v[142:145], v[178:181], v[124:127], v[142:145]
    v_mfma_f32_16x16x32_bf16 v[146:149], v[178:181], v[128:131], v[146:149]
    ds_read_b128 v[124:127], v6 offset:8192
    ds_read_b128 v[128:131], v9 offset:8192
    s_waitcnt lgkmcnt(4)
    v_mfma_f32_16x16x32_bf16 v[142:145], v[182:185], v[108:111], v[142:145]
    v_mfma_f32_16x16x32_bf16 v[146:149], v[182:185], v[112:115], v[146:149]
    ds_read_b128 v[108:111], v6 offset:9216
    ds_read_b128 v[112:115], v9 offset:9216
    s_waitcnt lgkmcnt(4)
    v_mfma_f32_16x16x32_bf16 v[142:145], v[186:189], v[116:119], v[142:145]
    v_mfma_f32_16x16x32_bf16 v[146:149], v[186:189], v[120:123], v[146:149]
    ds_read_b128 v[116:119], v6 offset:10240
    ds_read_b128 v[120:123], v9 offset:10240
    s_waitcnt lgkmcnt(4)
    v_mfma_f32_16x16x32_bf16 v[142:145], v[190:193], v[124:127], v[142:145]
    v_mfma_f32_16x16x32_bf16 v[146:149], v[190:193], v[128:131], v[146:149]
    ds_read_b128 v[124:127], v6 offset:11264
    ds_read_b128 v[128:131], v9 offset:11264
    s_waitcnt lgkmcnt(4)
    v_mfma_f32_16x16x32_bf16 v[142:145], v[194:197], v[108:111], v[142:145]
    v_mfma_f32_16x16x32_bf16 v[146:149], v[194:197], v[112:115], v[146:149]
    ds_read_b128 v[108:111], v6 offset:12288
    ds_read_b128 v[112:115], v9 offset:12288
    s_waitcnt lgkmcnt(4)
    v_mfma_f32_16x16x32_bf16 v[142:145], v[198:201], v[116:119], v[142:145]
    v_mfma_f32_16x16x32_bf16 v[146:149], v[198:201], v[120:123], v[146:149]
    ds_read_b128 v[116:119], v6 offset:13312
    ds_read_b128 v[120:123], v9 offset:13312
    s_waitcnt lgkmcnt(4)
    v_mfma_f32_16x16x32_bf16 v[142:145], v[202:205], v[124:127], v[142:145]
    v_mfma_f32_16x16x32_bf16 v[146:149], v[202:205], v[128:131], v[146:149]
    ds_read_b128 v[124:127], v6 offset:14336
    ds_read_b128 v[128:131], v9 offset:14336
    s_waitcnt lgkmcnt(4)
    v_mfma_f32_16x16x32_bf16 v[142:145], v[206:209], v[108:111], v[142:145]
    v_mfma_f32_16x16x32_bf16 v[146:149], v[206:209], v[112:115], v[146:149]
    ds_read_b128 v[108:111], v6 offset:15360
    ds_read_b128 v[112:115], v9 offset:15360
    s_waitcnt lgkmcnt(4)
    v_mfma_f32_16x16x32_bf16 v[142:145], v[210:213], v[116:119], v[142:145]
    v_mfma_f32_16x16x32_bf16 v[146:149], v[210:213], v[120:123], v[146:149]
    ds_read_b128 v[116:119], v6 offset:16384
    ds_read_b128 v[120:123], v9 offset:16384
    s_waitcnt lgkmcnt(4)
    v_mfma_f32_16x16x32_bf16 v[142:145], v[214:217], v[124:127], v[142:145]
    v_mfma_f32_16x16x32_bf16 v[146:149], v[214:217], v[128:131], v[146:149]
    ds_read_b128 v[124:127], v6 offset:17408
    ds_read_b128 v[128:131], v9 offset:17408
    s_waitcnt lgkmcnt(4)
    v_mfma_f32_16x16x32_bf16 v[142:145], v[218:221], v[108:111], v[142:145]
    v_mfma_f32_16x16x32_bf16 v[146:149], v[218:221], v[112:115], v[146:149]
    s_waitcnt lgkmcnt(2)
    v_mfma_f32_16x16x32_bf16 v[142:145], v[222:225], v[116:119], v[142:145]
    v_mfma_f32_16x16x32_bf16 v[146:149], v[222:225], v[120:123], v[146:149]
    s_waitcnt lgkmcnt(0)
    v_mfma_f32_16x16x32_bf16 v[142:145], v[226:229], v[124:127], v[142:145]
    v_mfma_f32_16x16x32_bf16 v[146:149], v[226:229], v[128:131], v[146:149]
    ds_read_b128 v[108:111], v10 offset:0
    ds_read_b128 v[112:115], v10 offset:36864
    ds_read_b128 v[116:119], v10 offset:8192
    ds_read_b128 v[120:123], v10 offset:45056
    ds_read_b128 v[124:127], v11 offset:0
    ds_read_b128 v[128:131], v11 offset:36864
    s_waitcnt lgkmcnt(0)
    v_mfma_f32_16x16x32_bf16 v[150:153], v[230:233], v[108:111], v[150:153]
    v_mfma_f32_16x16x32_bf16 v[154:157], v[230:233], v[112:115], v[154:157]
    v_mfma_f32_16x16x32_bf16 v[150:153], v[234:237], v[116:119], v[150:153]
    v_mfma_f32_16x16x32_bf16 v[154:157], v[234:237], v[120:123], v[154:157]
    v_mfma_f32_16x16x32_bf16 v[150:153], v[238:241], v[124:127], v[150:153]
    v_mfma_f32_16x16x32_bf16 v[154:157], v[238:241], v[128:131], v[154:157]
    s_lshl_b32 s16, s8, 11
    s_add_u32 s16, s16, 81920
    v_add_u32 v12, s16, v6
    s_nop 7
    ds_write_b128 v12, v[150:153]
    ds_write_b128 v12, v[154:157] offset:1024
    s_mul_i32 s16, s11, 36864
    s_mul_i32 s17, s12, 9
    s_add_u32 s18, s17, s8
    s_lshl_b32 s18, s18, 5
    s_add_u32 s18, s18, s16
    s_add_u32 s78, s76, s18
    s_addc_u32 s79, s77, 0
    v_cvt_pk_bf16_f32 v130, v142, v143
    v_cvt_pk_bf16_f32 v131, v144, v145
    v_cvt_pk_bf16_f32 v132, v146, v147
    v_cvt_pk_bf16_f32 v133, v148, v149
    global_store_dwordx2 v8, v[130:131], s[78:79]
    v_add_u32 v13, 18432, v8
    global_store_dwordx2 v13, v[132:133], s[78:79]
    s_waitcnt lgkmcnt(0)
    s_barrier
    s_cmp_ge_u32 s8, 2
    s_cbranch_scc1 L_tl_done
    s_lshl_b32 s19, s8, 10
    s_add_u32 s19, s19, 81920
    v_add_u32 v12, s19, v6
    ds_read_b128 v[16:19], v12 offset:0
    ds_read_b128 v[20:23], v12 offset:2048
    ds_read_b128 v[24:27], v12 offset:4096
    ds_read_b128 v[28:31], v12 offset:6144
    ds_read_b128 v[32:35], v12 offset:8192
    ds_read_b128 v[36:39], v12 offset:10240
    ds_read_b128 v[40:43], v12 offset:12288
    ds_read_b128 v[44:47], v12 offset:14336
    s_waitcnt lgkmcnt(0)
    v_add_f32 v16, v16, v20
    v_add_f32 v17, v17, v21
    v_add_f32 v18, v18, v22
    v_add_f32 v19, v19, v23
    v_add_f32 v16, v16, v24
    v_add_f32 v17, v17, v25
    v_add_f32 v18, v18, v26
    v_add_f32 v19, v19, v27
    v_add_f32 v16, v16, v28
    v_add_f32 v17, v17, v29
    v_add_f32 v18, v18, v30
    v_add_f32 v19, v19, v31
    v_add_f32 v16, v16, v32
    v_add_f32 v17, v17, v33
    v_add_f32 v18, v18, v34
    v_add_f32 v19, v19, v35
    v_add_f32 v16, v16, v36
    v_add_f32 v17, v17, v37
    v_add_f32 v18, v18, v38
    v_add_f32 v19, v19, v39
    v_add_f32 v16, v16, v40
    v_add_f32 v17, v17, v41
    v_add_f32 v18, v18, v42
    v_add_f32 v19, v19, v43
    v_add_f32 v16, v16, v44
    v_add_f32 v17, v17, v45
    v_add_f32 v18, v18, v46
    v_add_f32 v19, v19, v47
    v_cvt_pk_bf16_f32 v134, v16, v17
    v_cvt_pk_bf16_f32 v135, v18, v19
    s_add_u32 s18, s17, 8
    s_lshl_b32 s18, s18, 5
    s_add_u32 s18, s18, s16
    s_mul_i32 s19, s8, 18432
    s_add_u32 s18, s18, s19
    s_add_u32 s78, s76, s18
    s_addc_u32 s79, s77, 0
    global_store_dwordx2 v8, v[134:135], s[78:79]
L_tl_done:
L_f1_end:
    s_endpgm
L_at_fallback:
    s_waitcnt vmcnt(0)
    s_mul_i32 s16, s13, 19968
    v_subrev_u32 v114, s16, v114
    v_subrev_u32 v115, s16, v115
    v_subrev_u32 v116, s16, v116
    v_mov_b32 v249, 0
    v_mov_b32 v12, 0xff800000
    s_mov_b32 s53, 0
L_at_fb_loop0:
    s_lshr_b32 s16, s53, 3
    s_mul_i32 s16, s16, 19968
    s_and_b32 s17, s53, 7
    s_lshl_b32 s18, s17, 10
    s_add_u32 s18, s18, s16
    v_add_u32 v108, s18, v114
    s_lshl_b32 s18, s17, 8
    s_add_u32 s18, s18, s16
    v_add_u32 v109, s18, v115
    global_load_dwordx4 v[80:83], v108, s[32:33] sc1
    global_load_dwordx2 v[88:89], v109, s[32:33] sc1
    s_waitcnt vmcnt(0)
    v_mfma_f32_32x32x16_bf16 v[64:79], v[80:83], v[244:247], 0
    v_mfma_f32_32x32x8_bf16 v[64:79], v[88:89], v[248:249], v[64:79]
    s_nop 15
    s_nop 3
    v_max3_f32 v12, v64, v65, v12
    v_max3_f32 v12, v66, v67, v12
    v_max3_f32 v12, v68, v69, v12
    v_max3_f32 v12, v70, v71, v12
    v_max3_f32 v12, v72, v73, v12
    v_max3_f32 v12, v74, v75, v12
    v_max3_f32 v12, v76, v77, v12
    v_max3_f32 v12, v78, v79, v12
    s_add_u32 s53, s53, 1
    s_cmp_lt_u32 s53, 64
    s_cbranch_scc1 L_at_fb_loop0
    v_mov_b32 v13, v12
    s_nop 1
    v_permlane32_swap_b32 v12, v13
    s_nop 1
    v_max_f32 v12, v12, v13
    v_sub_f32 v12, 0, v12
    v_cmp_gt_u32 vcc, 32, v1
    v_cvt_pk_bf16_f32 v13, v12, v12
    v_lshlrev_b32 v13, 16, v13
    v_sub_f32 v13, v12, v13
    v_cvt_pk_bf16_f32 v13, v12, v13
    v_mov_b32 v14, 0
    v_cndmask_b32 v249, v14, v13, vcc
    s_mov_b32 s53, 0
    v_mov_b32 v16, 0
    v_mov_b32 v17, 0
    v_mov_b32 v18, 0
    v_mov_b32 v19, 0
    v_mov_b32 v20, 0
    v_mov_b32 v21, 0
    v_mov_b32 v22, 0
    v_mov_b32 v23, 0
    v_mov_b32 v24, 0
    v_mov_b32 v25, 0
    v_mov_b32 v26, 0
    v_mov_b32 v27, 0
    v_mov_b32 v28, 0
    v_mov_b32 v29, 0
    v_mov_b32 v30, 0
    v_mov_b32 v31, 0
L_at_fb_loop1:
    s_lshr_b32 s16, s53, 3
    s_mul_i32 s16, s16, 19968
    s_and_b32 s17, s53, 7
    s_lshl_b32 s18, s17, 10
    s_add_u32 s18, s18, s16
    v_add_u32 v108, s18, v114
    s_lshl_b32 s18, s17, 8
    s_add_u32 s18, s18, s16
    v_add_u32 v109, s18, v115
    global_load_dwordx4 v[80:83], v108, s[32:33] sc1
    global_load_dwordx2 v[88:89], v109, s[32:33] sc1
    s_mul_i32 s18, s17, 1216
    s_add_u32 s18, s18, s16
    v_add_u32 v110, s18, v116
    global_load_dwordx4 v[92:95], v110, s[32:33] sc1
    global_load_dwordx4 v[100:103], v110, s[32:33] offset:608 sc1
    s_waitcnt vmcnt(0)
    v_mfma_f32_32x32x16_bf16 v[64:79], v[80:83], v[244:247], 0
    v_mfma_f32_32x32x8_bf16 v[64:79], v[88:89], v[248:249], v[64:79]
    s_nop 15
    s_nop 3
    v_exp_f32 v64, v64
    v_exp_f32 v65, v65
    v_exp_f32 v66, v66
    v_exp_f32 v67, v67
    v_exp_f32 v68, v68
    v_exp_f32 v69, v69
    v_exp_f32 v70, v70
    v_exp_f32 v71, v71
    v_exp_f32 v72, v72
    v_exp_f32 v73, v73
    v_exp_f32 v74, v74
    v_exp_f32 v75, v75
    v_exp_f32 v76, v76
    v_exp_f32 v77, v77
    v_exp_f32 v78, v78
    v_exp_f32 v79, v79
    s_nop 0
    v_cvt_pk_bf16_f32 v64, v64, v65
    v_cvt_pk_bf16_f32 v65, v66, v67
    v_cvt_pk_bf16_f32 v66, v68, v69
    v_cvt_pk_bf16_f32 v67, v70, v71
    v_cvt_pk_bf16_f32 v68, v72, v73
    v_cvt_pk_bf16_f32 v69, v74, v75
    v_cvt_pk_bf16_f32 v70, v76, v77
    v_cvt_pk_bf16_f32 v71, v78, v79
    s_nop 1
    v_mfma_f32_32x32x16_bf16 v[16:31], v[92:95], v[64:67], v[16:31]
    v_mfma_f32_32x32x16_bf16 v[16:31], v[100:103], v[68:71], v[16:31]
    s_add_u32 s53, s53, 1
    s_cmp_lt_u32 s53, 64
    s_cbranch_scc1 L_at_fb_loop1
    s_nop 15
    s_nop 3
    v_mov_b32 v10, v26
    v_mov_b32 v11, v26
    s_nop 1
    v_permlane32_swap_b32 v10, v11
    s_nop 1
    s_mul_i32 s16, s12, 9
    s_add_u32 s17, s16, s8
    s_mul_i32 s17, s17, 18432
    s_add_u32 s17, s17, 0x7e2000
    s_add_u32 s22, s4, s17
    s_addc_u32 s23, s5, 0
    s_add_u32 s16, s16, 8
    s_mul_i32 s16, s16, 18432
    s_lshl_b32 s17, s8, 10
    s_add_u32 s16, s16, s17
    s_add_u32 s16, s16, 0x7e2000
    s_add_u32 s38, s4, s16
    s_addc_u32 s39, s5, 0
    s_add_u32 s22, s22, 4096
    s_addc_u32 s23, s23, 0
    s_add_u32 s22, s22, 4096
    s_addc_u32 s23, s23, 0
    global_load_dwordx4 v[84:87], v6, s[22:23] offset:1024 sc1
    global_load_dwordx4 v[88:91], v6, s[22:23] offset:2048 sc1
    global_load_dwordx4 v[92:95], v6, s[22:23] offset:3072 sc1
    s_add_u32 s22, s22, 4096
    s_addc_u32 s23, s23, 0
    global_load_dwordx4 v[96:99], v6, s[22:23] offset:0 sc1
    global_load_dwordx4 v[100:103], v6, s[22:23] offset:1024 sc1
    global_load_dwordx4 v[104:107], v6, s[22:23] offset:2048 sc1
    s_branch L_at_epi
.section .rodata,"a"
.p2align 6
.amdhsa_kernel gated_mix__grouped_kv_mqa__linear_attn_block__prompt_kernel
  .amdhsa_next_free_vgpr 256
  .amdhsa_next_free_sgpr 102
  .amdhsa_accum_offset 256
  .amdhsa_group_segment_fixed_size 0
  .amdhsa_kernarg_size 96
  .amdhsa_user_sgpr_count 2
  .amdhsa_user_sgpr_kernarg_segment_ptr 1
  .amdhsa_system_sgpr_workgroup_id_x 1
.end_amdhsa_kernel
.text
```
